```python
import torch

def _softmax(x, axis=-1):
    return torch.softmax(x, dim=axis)
def _gelu(x):
    return torch.nn.functional.gelu(x, approximate="tanh")
def _silu(x):
    return torch.nn.functional.silu(x)
def _sigmoid(x):
    return torch.sigmoid(x)
def _layernorm(x, axis=-1, eps=1e-5):
    m = x.mean(dim=axis, keepdim=True)
    v = x.var(dim=axis, keepdim=True, unbiased=False)
    return (x - m) / torch.sqrt(v + eps)
def _scatter_add(tgt, idx, src, axis=0):
    return tgt.clone().index_add_(axis, idx, src)
def _segment_sum(src, seg, n):
    out = torch.zeros((n,) + src.shape[1:], dtype=src.dtype)
    return out.index_add_(0, seg, src)
def _pad(x, pw):
    flat = tuple(v for pair in reversed(pw) for v in pair)
    return torch.nn.functional.pad(x, flat)

kernel_name = 'concat_heads__gqa_block_cached__gqa_block_cached__near_ridge'

def setup_inputs():

    _w = (lambda a: (lambda t: t.to(torch.bfloat16) if t.is_floating_point() else t)(torch.as_tensor(a)))
    def _A_setup():
        B, Sq, D = 16, 48, 448
        Hq, Hkv, Sk, Dh = 16, 8, 512, 256
        assert Hq % Hkv == 0, (Hq, Hkv)
        return {
            "x": _w((lambda *s: torch.randn(*s, dtype=torch.bfloat16) * 0.8)(B, Sq, D)),
            "k_cache": _w((lambda *s: torch.randn(*s, dtype=torch.bfloat16) * 0.8)(B, Hkv, Sk, Dh)),
            "v_cache": _w((lambda *s: torch.randn(*s, dtype=torch.bfloat16) * 0.05)(B, Hkv, Sk, Dh)),
            "wq": _w((lambda *s: torch.randn(*s, dtype=torch.bfloat16) * 0.8)(D, Hq * Dh) * (D ** -0.5)),
            "wo": _w((lambda *s: torch.randn(*s, dtype=torch.bfloat16) * 0.05)(Hq * Dh, D) * ((Hq * Dh) ** -0.5)),
        }
    _A_in = _A_setup()

    def _B_setup():
        B, Sq, D = 16, 48, 448
        Hq, Hkv, Sk, Dh = 16, 8, 512, 256
        assert Hq % Hkv == 0, (Hq, Hkv)
        return {
            "x": _w((lambda *s: torch.randn(*s, dtype=torch.bfloat16) * 0.8)(B, Sq, D)),
            "k_cache": _w((lambda *s: torch.randn(*s, dtype=torch.bfloat16) * 0.8)(B, Hkv, Sk, Dh)),
            "v_cache": _w((lambda *s: torch.randn(*s, dtype=torch.bfloat16) * 0.05)(B, Hkv, Sk, Dh)),
            "wq": _w((lambda *s: torch.randn(*s, dtype=torch.bfloat16) * 0.8)(D, Hq * Dh) * (D ** -0.5)),
            "wo": _w((lambda *s: torch.randn(*s, dtype=torch.bfloat16) * 0.05)(Hq * Dh, D) * ((Hq * Dh) ** -0.5)),
        }
    _B_in = _B_setup()

    return {
        "A_x": _A_in["x"],
        "A_k_cache": _A_in["k_cache"],
        "A_v_cache": _A_in["v_cache"],
        "A_wq": _A_in["wq"],
        "A_wo": _A_in["wo"],
        "B_x": _B_in["x"],
        "B_k_cache": _B_in["k_cache"],
        "B_v_cache": _B_in["v_cache"],
        "B_wq": _B_in["wq"],
        "B_wo": _B_in["wo"],
    }

def reference(A_x, A_k_cache, A_v_cache, A_wq, A_wo, B_x, B_k_cache, B_v_cache, B_wq, B_wo):
    def _A_ref(x, k_cache, v_cache, wq, wo):
        B, Sq, D = x.shape
        Hq, Dh = 16, 256
        Hkv = k_cache.shape[1]
        rep = Hq // Hkv
        q = (lambda x, *d: x.permute(*d))((x @ wq).reshape(B, Sq, Hq, Dh), 0, 2, 1, 3)
        k = (lambda x, n, axis: torch.repeat_interleave(x, n, dim=axis))(k_cache, rep, axis=1)
        v = (lambda x, n, axis: torch.repeat_interleave(x, n, dim=axis))(v_cache, rep, axis=1)
        scores = torch.einsum("bhqd,bhkd->bhqk", q, k) * (Dh ** -0.5)
        p = _softmax(scores, axis=-1)
        o = torch.einsum("bhqk,bhkd->bhqd", p, v)
        return (lambda x, *d: x.permute(*d))(o, 0, 2, 1, 3).reshape(B, Sq, Hq * Dh) @ wo

    def _B_ref(x, k_cache, v_cache, wq, wo):
        B, Sq, D = x.shape
        Hq, Dh = 16, 256
        Hkv = k_cache.shape[1]
        rep = Hq // Hkv
        q = (lambda x, *d: x.permute(*d))((x @ wq).reshape(B, Sq, Hq, Dh), 0, 2, 1, 3)
        k = (lambda x, n, axis: torch.repeat_interleave(x, n, dim=axis))(k_cache, rep, axis=1)
        v = (lambda x, n, axis: torch.repeat_interleave(x, n, dim=axis))(v_cache, rep, axis=1)
        scores = torch.einsum("bhqd,bhkd->bhqk", q, k) * (Dh ** -0.5)
        p = _softmax(scores, axis=-1)
        o = torch.einsum("bhqk,bhkd->bhqd", p, v)
        return (lambda x, *d: x.permute(*d))(o, 0, 2, 1, 3).reshape(B, Sq, Hq * Dh) @ wo

    a = _A_ref(A_x, A_k_cache, A_v_cache, A_wq, A_wo)
    b = _B_ref(B_x, B_k_cache, B_v_cache, B_wq, B_wo)
    return torch.concatenate([a, b], axis=-1)
```

```asm
; @launch grid=(256,1,1) block=(512,1,1) lds=163840
.amdgcn_target "amdgcn-amd-amdhsa--gfx950"
.text
.globl concat_heads__gqa_block_cached__gqa_block_cached__near_ridge_kernel
.p2align 8
.type concat_heads__gqa_block_cached__gqa_block_cached__near_ridge_kernel,@function
concat_heads__gqa_block_cached__gqa_block_cached__near_ridge_kernel:
  s_cmp_ge_u32 s2, 256
  s_cbranch_scc1 L_end
  s_load_dwordx16 s[36:51], s[0:1], 0
  s_load_dwordx4 s[52:55], s[0:1], 64
  s_load_dwordx4 s[56:59], s[0:1], 80
  s_load_dwordx2 s[60:61], s[0:1], 96
  v_and_b32 v44, 63, v0
  v_lshrrev_b32 v45, 6, v0
  v_and_b32 v46, 15, v44
  v_lshrrev_b32 v47, 4, v44
  v_readfirstlane_b32 s3, v45
  s_bfe_u32 s7, s2, 0x10002
  s_and_b32 s5, s2, 3
  s_lshl_b32 s5, s5, 1
  s_bfe_u32 s66, s2, 0x10003
  s_or_b32 s5, s5, s66
  s_lshr_b32 s6, s2, 4
  s_and_b32 s4, s3, 3
  s_lshl_b32 s76, s7, 4
  s_add_u32 s76, s76, s6
  s_mov_b32 s64, 0x3db8aa3b
  s_mov_b32 s65, s64
  s_cmp_lg_u32 s3, 3
  s_cbranch_scc1 L_icpf_skip
  s_getpc_b64 s[72:73]
L_icpf_pc:
  s_sub_u32 s72, s72, L_icpf_pc-concat_heads__gqa_block_cached__gqa_block_cached__near_ridge_kernel
  s_subb_u32 s73, s73, 0
  s_lshr_b32 s66, s2, 3
  s_lshl_b32 s66, s66, 11
  v_lshlrev_b32 v58, 7, v44
  v_add_u32 v58, s66, v58
  s_mov_b64 s[70:71], exec
  s_mov_b64 exec, 0xffff
  v_cmp_gt_u32 vcc, L_code_end-concat_heads__gqa_block_cached__gqa_block_cached__near_ridge_kernel, v58
  s_nop 1
  s_and_b64 exec, exec, vcc
  s_cbranch_execz L_icpf_rest
  global_load_dword v60, v58, s[72:73]
L_icpf_rest:
  s_mov_b64 exec, s[70:71]
L_icpf_skip:
  v_mbcnt_lo_u32_b32 v26, -1, 0
  v_mbcnt_hi_u32_b32 v26, -1, v26
  v_and_b32 v27, 15, v26
  v_lshrrev_b32 v28, 4, v26
  s_mul_i32 s77, s4, 896
  s_lshr_b32 s66, s4, 1
  v_xor_b32 v29, s66, v26
  v_lshlrev_b32 v29, 4, v29
  v_xor_b32 v30, 0, v29
  v_xor_b32 v31, 32, v29
  v_xor_b32 v32, 64, v29
  v_xor_b32 v33, 96, v29
  s_waitcnt lgkmcnt(0)
  s_cmp_eq_u32 s7, 0
  s_cselect_b64 s[36:37], s[36:37], s[46:47]
  s_mul_i32 s67, s6, 43008
  s_add_u32 s24, s36, s67
  s_addc_u32 s25, s37, 0
  s_and_b32 s25, s25, 0xffff
  s_mov_b32 s26, 43008
  s_mov_b32 s27, 0x20000
  s_cmp_lt_u32 s3, 4
  s_cbranch_scc1 L_nox
  s_mov_b64 s[70:71], exec
  s_mov_b32 exec_hi, 0x00ffffff
  s_add_u32 m0, s77, 32768
  s_add_u32 s67, s77, 0
  buffer_load_dwordx4 v30, s[24:27], s67 offen lds
  s_add_u32 m0, s77, 36352
  s_add_u32 s67, s77, 3584
  buffer_load_dwordx4 v31, s[24:27], s67 offen lds
  s_add_u32 m0, s77, 39936
  s_add_u32 s67, s77, 7168
  buffer_load_dwordx4 v32, s[24:27], s67 offen lds
  s_add_u32 m0, s77, 43520
  s_add_u32 s67, s77, 10752
  buffer_load_dwordx4 v33, s[24:27], s67 offen lds
  s_add_u32 m0, s77, 47104
  s_add_u32 s67, s77, 14336
  buffer_load_dwordx4 v30, s[24:27], s67 offen lds
  s_add_u32 m0, s77, 50688
  s_add_u32 s67, s77, 17920
  buffer_load_dwordx4 v31, s[24:27], s67 offen lds
  s_add_u32 m0, s77, 54272
  s_add_u32 s67, s77, 21504
  buffer_load_dwordx4 v32, s[24:27], s67 offen lds
  s_add_u32 m0, s77, 57856
  s_add_u32 s67, s77, 25088
  buffer_load_dwordx4 v33, s[24:27], s67 offen lds
  s_add_u32 m0, s77, 131072
  s_add_u32 s67, s77, 28672
  buffer_load_dwordx4 v30, s[24:27], s67 offen lds
  s_add_u32 m0, s77, 134656
  s_add_u32 s67, s77, 32256
  buffer_load_dwordx4 v31, s[24:27], s67 offen lds
  s_add_u32 m0, s77, 138240
  s_add_u32 s67, s77, 35840
  buffer_load_dwordx4 v32, s[24:27], s67 offen lds
  s_add_u32 m0, s77, 141824
  s_add_u32 s67, s77, 39424
  buffer_load_dwordx4 v33, s[24:27], s67 offen lds
  s_mov_b64 exec, s[70:71]
L_nox:
  s_cmp_eq_u32 s7, 0
  s_cselect_b64 s[38:39], s[38:39], s[48:49]
  s_cselect_b64 s[40:41], s[40:41], s[50:51]
  s_cselect_b64 s[42:43], s[42:43], s[52:53]
  s_cselect_b64 s[44:45], s[44:45], s[54:55]
  s_lshl_b32 s67, s5, 10
  s_add_u32 s16, s42, s67
  s_addc_u32 s17, s43, 0
  s_and_b32 s17, s17, 0xffff
  s_sub_u32 s18, 3670016, s67
  s_mov_b32 s19, 0x20000
  s_lshl_b32 s66, s6, 3
  s_add_u32 s66, s66, s5
  s_lshl_b32 s66, s66, 18
  s_add_u32 s8, s38, s66
  s_addc_u32 s9, s39, 0
  s_and_b32 s9, s9, 0xffff
  s_mov_b32 s10, 262144
  s_mov_b32 s11, 0x20000
  s_add_u32 s12, s40, s66
  s_addc_u32 s13, s41, 0
  s_and_b32 s13, s13, 0xffff
  s_mov_b32 s14, 262144
  s_mov_b32 s15, 0x20000
  s_mul_i32 s67, s5, 458752
  s_add_u32 s20, s44, s67
  s_addc_u32 s21, s45, 0
  s_and_b32 s21, s21, 0xffff
  s_mov_b32 s22, 458752
  s_mov_b32 s23, 0x20000
  s_mov_b32 s28, s56
  s_and_b32 s29, s57, 0xffff
  s_mov_b32 s30, 1376256
  s_mov_b32 s31, 0x20000
  s_mov_b32 s32, s60
  s_and_b32 s33, s61, 0xffff
  s_mov_b32 s34, 17047552
  s_mov_b32 s35, 0x20000
  s_movk_i32 s36, 0
  s_mov_b32 s40, 0
  s_movk_i32 s37, 128
  s_mov_b32 s41, 57344
  s_movk_i32 s38, 256
  s_mov_b32 s42, 114688
  s_movk_i32 s39, 384
  s_mov_b32 s43, 172032
  s_lshr_b32 s68, s4, 1
  s_lshl_b32 s44, s68, 7
  s_add_u32 s45, s44, 256
  s_cmp_ge_u32 s3, 4
  s_cbranch_scc1 L_P
  s_lshl_b32 s62, s4, 13
  s_lshl_b32 s63, s4, 14
  s_add_u32 s63, s63, 65536
  v_lshrrev_b32 v52, 3, v44
  v_lshlrev_b32 v52, 13, v52
  v_and_b32 v53, 7, v44
  v_lshl_add_u32 v56, v53, 7, v52
  s_mul_i32 s68, s6, 28
  s_lshl_b32 s69, s4, 3
  s_add_u32 s68, s68, s69
  s_lshl_b32 s68, s68, 13
  s_barrier
  s_cmp_eq_u32 s4, 3
  s_cselect_b32 exec_hi, 0, -1
  buffer_load_dword v63, v56, s[16:19], s68 offen
  s_mov_b32 exec_hi, -1
  v_lshrrev_b32 v52, 3, v44
  v_lshlrev_b32 v52, 13, v52
  v_bfe_u32 v53, v44, 1, 2
  v_xor_b32 v53, v53, v47
  v_lshl_add_u32 v52, v53, 5, v52
  v_and_b32 v53, 1, v44
  v_lshl_add_u32 v52, v53, 4, v52
  s_and_b32 s66, s4, 1
  s_lshl_b32 s66, s66, 9
  v_add_u32 v51, s66, v52
  v_lshrrev_b32 v52, 3, v44
  v_lshlrev_b32 v52, 9, v52
  s_lshl_b32 s67, s4, 15
  v_add_u32 v52, s67, v52
  v_and_b32 v53, 7, v44
  v_xor_b32 v54, v53, v47
  v_lshl_add_u32 v48, v54, 4, v52
  v_xor_b32 v54, 4, v54
  v_lshl_add_u32 v49, v54, 4, v52
  v_lshrrev_b32 v54, 1, v53
  v_xor_b32 v54, v54, v47
  v_lshl_add_u32 v54, v54, 5, v52
  v_and_b32 v55, 1, v44
  v_lshl_add_u32 v50, v55, 4, v54
  s_barrier
  s_or_b32 s66, s5, s4
  s_cmp_lg_u32 s66, 0
  s_cbranch_scc1 L_fz_skip
  s_mul_i32 s66, s76, 8448
  s_add_u32 s66, s66, 16777216
  v_lshlrev_b32 v58, 2, v44
  v_mov_b32 v59, 0
  s_mov_b64 s[70:71], exec
  s_mov_b32 exec_hi, 0
  buffer_store_dword v59, v58, s[32:35], s66 offen sc0 sc1
  s_mov_b64 exec, s[70:71]
L_fz_skip:
  s_add_u32 m0, s63, 0
  s_add_u32 s67, s44, 0
  buffer_load_dwordx4 v51, s[16:19], s67 offen  lds
  s_add_u32 m0, s63, 1024
  s_add_u32 s67, s44, 65536
  buffer_load_dwordx4 v51, s[16:19], s67 offen  lds
  s_add_u32 m0, s63, 2048
  s_add_u32 s67, s44, 131072
  buffer_load_dwordx4 v51, s[16:19], s67 offen  lds
  s_add_u32 m0, s63, 3072
  s_add_u32 s67, s44, 196608
  buffer_load_dwordx4 v51, s[16:19], s67 offen  lds
  s_add_u32 m0, s63, 4096
  s_add_u32 s67, s44, 262144
  buffer_load_dwordx4 v51, s[16:19], s67 offen  lds
  s_add_u32 m0, s63, 5120
  s_add_u32 s67, s44, 327680
  buffer_load_dwordx4 v51, s[16:19], s67 offen  lds
  s_add_u32 m0, s63, 6144
  s_add_u32 s67, s44, 393216
  buffer_load_dwordx4 v51, s[16:19], s67 offen  lds
  s_add_u32 m0, s63, 7168
  s_add_u32 s67, s44, 458752
  buffer_load_dwordx4 v51, s[16:19], s67 offen  lds
  s_add_u32 m0, s63, 8192
  s_add_u32 s67, s44, 524288
  buffer_load_dwordx4 v51, s[16:19], s67 offen  lds
  s_add_u32 m0, s63, 9216
  s_add_u32 s67, s44, 589824
  buffer_load_dwordx4 v51, s[16:19], s67 offen  lds
  s_add_u32 m0, s63, 10240
  s_add_u32 s67, s44, 655360
  buffer_load_dwordx4 v51, s[16:19], s67 offen  lds
  s_add_u32 m0, s63, 11264
  s_add_u32 s67, s44, 720896
  buffer_load_dwordx4 v51, s[16:19], s67 offen  lds
  s_add_u32 m0, s63, 12288
  s_add_u32 s67, s44, 786432
  buffer_load_dwordx4 v51, s[16:19], s67 offen  lds
  s_add_u32 m0, s63, 13312
  s_add_u32 s67, s44, 851968
  buffer_load_dwordx4 v51, s[16:19], s67 offen  lds
  s_add_u32 m0, s63, 14336
  s_add_u32 s67, s44, 917504
  buffer_load_dwordx4 v51, s[16:19], s67 offen  lds
  s_add_u32 m0, s63, 15360
  s_add_u32 s67, s44, 983040
  buffer_load_dwordx4 v51, s[16:19], s67 offen  lds
  s_add_u32 m0, s62, 0
  s_add_u32 s67, s36, 0
  buffer_load_dwordx4 v48, s[8:11], s67 offen nt lds
  s_add_u32 m0, s62, 1024
  s_add_u32 s67, s36, 4096
  buffer_load_dwordx4 v49, s[8:11], s67 offen nt lds
  s_add_u32 m0, s62, 2048
  s_add_u32 s67, s36, 8192
  buffer_load_dwordx4 v48, s[8:11], s67 offen nt lds
  s_add_u32 m0, s62, 3072
  s_add_u32 s67, s36, 12288
  buffer_load_dwordx4 v49, s[8:11], s67 offen nt lds
  s_add_u32 m0, s62, 4096
  s_add_u32 s67, s36, 16384
  buffer_load_dwordx4 v48, s[8:11], s67 offen nt lds
  s_add_u32 m0, s62, 5120
  s_add_u32 s67, s36, 20480
  buffer_load_dwordx4 v49, s[8:11], s67 offen nt lds
  s_add_u32 m0, s62, 6144
  s_add_u32 s67, s36, 24576
  buffer_load_dwordx4 v48, s[8:11], s67 offen nt lds
  s_add_u32 m0, s62, 7168
  s_add_u32 s67, s36, 28672
  buffer_load_dwordx4 v49, s[8:11], s67 offen nt lds
  s_lshr_b32 s66, s4, 1
  s_and_b32 s67, s4, 1
  v_lshrrev_b32 v52, 1, v46
  v_xor_b32 v53, v47, v52
  v_xor_b32 v54, 4, v53
  s_lshl_b32 s68, s67, 14
  v_lshlrev_b32 v55, 7, v46
  v_add_u32 v55, s68, v55
  v_lshl_add_u32 v40, v53, 4, v55
  v_lshl_add_u32 v41, v54, 4, v55
  s_mul_i32 s68, s66, 6144
  s_add_u32 s68, s68, 131072
  v_lshlrev_b32 v55, 7, v46
  v_add_u32 v55, s68, v55
  v_lshl_add_u32 v42, v53, 4, v55
  v_lshl_add_u32 v43, v54, 4, v55
  s_lshl_b32 s66, s4, 4
  s_add_u32 s66, s66, 161280
  v_mov_b32 v55, s66
  v_mov_b32 v56, 0
  ds_write_b32 v55, v56
  s_waitcnt lgkmcnt(0)
  s_waitcnt vmcnt(8)
  s_or_b32 s66, s5, s4
  s_cmp_lg_u32 s66, 0
  s_cbranch_scc1 L_fm_skip
  s_lshl_b32 s66, s76, 2
  v_mov_b32 v58, s66
  v_mov_b32 v59, 1
  s_mov_b64 s[70:71], exec
  s_mov_b64 exec, 1
  global_store_dword v58, v59, s[58:59] sc0 sc1
  s_mov_b64 exec, s[70:71]
L_fm_skip:
  s_barrier
  s_barrier
  s_add_u32 m0, s62, 32768
  s_add_u32 s67, s36, 131072
  buffer_load_dwordx4 v48, s[8:11], s67 offen nt lds
  s_add_u32 m0, s62, 33792
  s_add_u32 s67, s36, 135168
  buffer_load_dwordx4 v49, s[8:11], s67 offen nt lds
  s_add_u32 m0, s62, 34816
  s_add_u32 s67, s36, 139264
  buffer_load_dwordx4 v48, s[8:11], s67 offen nt lds
  s_add_u32 m0, s62, 35840
  s_add_u32 s67, s36, 143360
  buffer_load_dwordx4 v49, s[8:11], s67 offen nt lds
  s_add_u32 m0, s62, 36864
  s_add_u32 s67, s36, 147456
  buffer_load_dwordx4 v48, s[8:11], s67 offen nt lds
  s_add_u32 m0, s62, 37888
  s_add_u32 s67, s36, 151552
  buffer_load_dwordx4 v49, s[8:11], s67 offen nt lds
  s_add_u32 m0, s62, 38912
  s_add_u32 s67, s36, 155648
  buffer_load_dwordx4 v48, s[8:11], s67 offen nt lds
  s_add_u32 m0, s62, 39936
  s_add_u32 s67, s36, 159744
  buffer_load_dwordx4 v49, s[8:11], s67 offen nt lds
  s_waitcnt vmcnt(8)
  s_barrier
  ds_read_b128 v[0:3], v42 offset:0
  ds_read_b128 v[4:7], v42 offset:2048
  ds_read_b128 v[8:11], v42 offset:4096
  ds_read_b128 v[12:15], v43 offset:0
  ds_read_b128 v[16:19], v43 offset:2048
  ds_read_b128 v[20:23], v43 offset:4096
  ds_read_b128 v[24:27], v40 offset:0
  ds_read_b128 v[28:31], v41 offset:0
  ds_read_b128 v[32:35], v40 offset:2048
  ds_read_b128 v[36:39], v41 offset:2048
  s_waitcnt lgkmcnt(3)
  v_mfma_f32_16x16x32_bf16 v[64:67], v[24:27], v[0:3], 0
  v_mfma_f32_16x16x32_bf16 v[68:71], v[24:27], v[4:7], 0
  v_mfma_f32_16x16x32_bf16 v[72:75], v[24:27], v[8:11], 0
  ds_read_b128 v[24:27], v40 offset:4096
  s_waitcnt lgkmcnt(3)
  v_mfma_f32_16x16x32_bf16 v[64:67], v[28:31], v[12:15], v[64:67]
  v_mfma_f32_16x16x32_bf16 v[68:71], v[28:31], v[16:19], v[68:71]
  v_mfma_f32_16x16x32_bf16 v[72:75], v[28:31], v[20:23], v[72:75]
  ds_read_b128 v[28:31], v41 offset:4096
  s_waitcnt lgkmcnt(3)
  v_mfma_f32_16x16x32_bf16 v[76:79], v[32:35], v[0:3], 0
  v_mfma_f32_16x16x32_bf16 v[80:83], v[32:35], v[4:7], 0
  v_mfma_f32_16x16x32_bf16 v[84:87], v[32:35], v[8:11], 0
  ds_read_b128 v[32:35], v40 offset:6144
  s_waitcnt lgkmcnt(3)
  v_mfma_f32_16x16x32_bf16 v[76:79], v[36:39], v[12:15], v[76:79]
  v_mfma_f32_16x16x32_bf16 v[80:83], v[36:39], v[16:19], v[80:83]
  v_mfma_f32_16x16x32_bf16 v[84:87], v[36:39], v[20:23], v[84:87]
  ds_read_b128 v[36:39], v41 offset:6144
  s_waitcnt lgkmcnt(3)
  v_mfma_f32_16x16x32_bf16 v[88:91], v[24:27], v[0:3], 0
  v_mfma_f32_16x16x32_bf16 v[92:95], v[24:27], v[4:7], 0
  v_mfma_f32_16x16x32_bf16 v[96:99], v[24:27], v[8:11], 0
  ds_read_b128 v[24:27], v40 offset:8192
  s_waitcnt lgkmcnt(3)
  v_mfma_f32_16x16x32_bf16 v[88:91], v[28:31], v[12:15], v[88:91]
  v_mfma_f32_16x16x32_bf16 v[92:95], v[28:31], v[16:19], v[92:95]
  v_mfma_f32_16x16x32_bf16 v[96:99], v[28:31], v[20:23], v[96:99]
  ds_read_b128 v[28:31], v41 offset:8192
  s_waitcnt lgkmcnt(3)
  v_mfma_f32_16x16x32_bf16 v[100:103], v[32:35], v[0:3], 0
  v_mfma_f32_16x16x32_bf16 v[104:107], v[32:35], v[4:7], 0
  v_mfma_f32_16x16x32_bf16 v[108:111], v[32:35], v[8:11], 0
  ds_read_b128 v[32:35], v40 offset:10240
  s_waitcnt lgkmcnt(3)
  v_mfma_f32_16x16x32_bf16 v[100:103], v[36:39], v[12:15], v[100:103]
  v_mfma_f32_16x16x32_bf16 v[104:107], v[36:39], v[16:19], v[104:107]
  v_mfma_f32_16x16x32_bf16 v[108:111], v[36:39], v[20:23], v[108:111]
  ds_read_b128 v[36:39], v41 offset:10240
  s_waitcnt lgkmcnt(3)
  v_mfma_f32_16x16x32_bf16 v[112:115], v[24:27], v[0:3], 0
  v_mfma_f32_16x16x32_bf16 v[116:119], v[24:27], v[4:7], 0
  v_mfma_f32_16x16x32_bf16 v[120:123], v[24:27], v[8:11], 0
  ds_read_b128 v[24:27], v40 offset:12288
  s_waitcnt lgkmcnt(3)
  v_mfma_f32_16x16x32_bf16 v[112:115], v[28:31], v[12:15], v[112:115]
  v_mfma_f32_16x16x32_bf16 v[116:119], v[28:31], v[16:19], v[116:119]
  v_mfma_f32_16x16x32_bf16 v[120:123], v[28:31], v[20:23], v[120:123]
  ds_read_b128 v[28:31], v41 offset:12288
  s_waitcnt lgkmcnt(3)
  v_mfma_f32_16x16x32_bf16 v[124:127], v[32:35], v[0:3], 0
  v_mfma_f32_16x16x32_bf16 v[128:131], v[32:35], v[4:7], 0
  v_mfma_f32_16x16x32_bf16 v[132:135], v[32:35], v[8:11], 0
  ds_read_b128 v[32:35], v40 offset:14336
  s_waitcnt lgkmcnt(3)
  v_mfma_f32_16x16x32_bf16 v[124:127], v[36:39], v[12:15], v[124:127]
  v_mfma_f32_16x16x32_bf16 v[128:131], v[36:39], v[16:19], v[128:131]
  v_mfma_f32_16x16x32_bf16 v[132:135], v[36:39], v[20:23], v[132:135]
  ds_read_b128 v[36:39], v41 offset:14336
  s_waitcnt lgkmcnt(3)
  v_mfma_f32_16x16x32_bf16 v[136:139], v[24:27], v[0:3], 0
  v_mfma_f32_16x16x32_bf16 v[140:143], v[24:27], v[4:7], 0
  v_mfma_f32_16x16x32_bf16 v[144:147], v[24:27], v[8:11], 0
  s_waitcnt lgkmcnt(2)
  v_mfma_f32_16x16x32_bf16 v[136:139], v[28:31], v[12:15], v[136:139]
  v_mfma_f32_16x16x32_bf16 v[140:143], v[28:31], v[16:19], v[140:143]
  v_mfma_f32_16x16x32_bf16 v[144:147], v[28:31], v[20:23], v[144:147]
  s_waitcnt lgkmcnt(1)
  v_mfma_f32_16x16x32_bf16 v[148:151], v[32:35], v[0:3], 0
  v_mfma_f32_16x16x32_bf16 v[152:155], v[32:35], v[4:7], 0
  v_mfma_f32_16x16x32_bf16 v[156:159], v[32:35], v[8:11], 0
  s_waitcnt lgkmcnt(0)
  v_mfma_f32_16x16x32_bf16 v[148:151], v[36:39], v[12:15], v[148:151]
  v_mfma_f32_16x16x32_bf16 v[152:155], v[36:39], v[16:19], v[152:155]
  v_mfma_f32_16x16x32_bf16 v[156:159], v[36:39], v[20:23], v[156:159]
  s_waitcnt vmcnt(0)
  s_barrier
  ds_read_b128 v[24:27], v40 offset:32768
  ds_read_b128 v[28:31], v41 offset:32768
  ds_read_b128 v[32:35], v40 offset:34816
  s_add_u32 m0, s62, 0
  s_add_u32 s67, s37, 0
  buffer_load_dwordx4 v48, s[8:11], s67 offen nt lds
  s_add_u32 m0, s62, 1024
  s_add_u32 s67, s37, 4096
  buffer_load_dwordx4 v49, s[8:11], s67 offen nt lds
  s_add_u32 m0, s62, 2048
  s_add_u32 s67, s37, 8192
  buffer_load_dwordx4 v48, s[8:11], s67 offen nt lds
  s_add_u32 m0, s62, 3072
  s_add_u32 s67, s37, 12288
  buffer_load_dwordx4 v49, s[8:11], s67 offen nt lds
  s_add_u32 m0, s62, 4096
  s_add_u32 s67, s37, 16384
  buffer_load_dwordx4 v48, s[8:11], s67 offen nt lds
  s_add_u32 m0, s62, 5120
  s_add_u32 s67, s37, 20480
  buffer_load_dwordx4 v49, s[8:11], s67 offen nt lds
  s_add_u32 m0, s62, 6144
  s_add_u32 s67, s37, 24576
  buffer_load_dwordx4 v48, s[8:11], s67 offen nt lds
  s_add_u32 m0, s62, 7168
  s_add_u32 s67, s37, 28672
  buffer_load_dwordx4 v49, s[8:11], s67 offen nt lds
  ds_read_b128 v[36:39], v41 offset:34816
  s_waitcnt lgkmcnt(3)
  v_mfma_f32_16x16x32_bf16 v[160:163], v[24:27], v[0:3], 0
  v_mfma_f32_16x16x32_bf16 v[164:167], v[24:27], v[4:7], 0
  v_mfma_f32_16x16x32_bf16 v[168:171], v[24:27], v[8:11], 0
  ds_read_b128 v[24:27], v40 offset:36864
  s_waitcnt lgkmcnt(3)
  v_mfma_f32_16x16x32_bf16 v[160:163], v[28:31], v[12:15], v[160:163]
  v_mfma_f32_16x16x32_bf16 v[164:167], v[28:31], v[16:19], v[164:167]
  v_mfma_f32_16x16x32_bf16 v[168:171], v[28:31], v[20:23], v[168:171]
  ds_read_b128 v[28:31], v41 offset:36864
  s_waitcnt lgkmcnt(3)
  v_mfma_f32_16x16x32_bf16 v[172:175], v[32:35], v[0:3], 0
  v_mfma_f32_16x16x32_bf16 v[176:179], v[32:35], v[4:7], 0
  v_mfma_f32_16x16x32_bf16 v[180:183], v[32:35], v[8:11], 0
  ds_read_b128 v[32:35], v40 offset:38912
  s_waitcnt lgkmcnt(3)
  v_mfma_f32_16x16x32_bf16 v[172:175], v[36:39], v[12:15], v[172:175]
  v_mfma_f32_16x16x32_bf16 v[176:179], v[36:39], v[16:19], v[176:179]
  v_mfma_f32_16x16x32_bf16 v[180:183], v[36:39], v[20:23], v[180:183]
  ds_read_b128 v[36:39], v41 offset:38912
  s_waitcnt lgkmcnt(3)
  v_mfma_f32_16x16x32_bf16 v[184:187], v[24:27], v[0:3], 0
  v_mfma_f32_16x16x32_bf16 v[188:191], v[24:27], v[4:7], 0
  v_mfma_f32_16x16x32_bf16 v[192:195], v[24:27], v[8:11], 0
  ds_read_b128 v[24:27], v40 offset:40960
  s_waitcnt lgkmcnt(3)
  v_mfma_f32_16x16x32_bf16 v[184:187], v[28:31], v[12:15], v[184:187]
  v_mfma_f32_16x16x32_bf16 v[188:191], v[28:31], v[16:19], v[188:191]
  v_mfma_f32_16x16x32_bf16 v[192:195], v[28:31], v[20:23], v[192:195]
  ds_read_b128 v[28:31], v41 offset:40960
  s_waitcnt lgkmcnt(3)
  v_mfma_f32_16x16x32_bf16 v[196:199], v[32:35], v[0:3], 0
  v_mfma_f32_16x16x32_bf16 v[200:203], v[32:35], v[4:7], 0
  v_mfma_f32_16x16x32_bf16 v[204:207], v[32:35], v[8:11], 0
  ds_read_b128 v[32:35], v40 offset:43008
  s_waitcnt lgkmcnt(3)
  v_mfma_f32_16x16x32_bf16 v[196:199], v[36:39], v[12:15], v[196:199]
  v_mfma_f32_16x16x32_bf16 v[200:203], v[36:39], v[16:19], v[200:203]
  v_mfma_f32_16x16x32_bf16 v[204:207], v[36:39], v[20:23], v[204:207]
  ds_read_b128 v[36:39], v41 offset:43008
  s_waitcnt lgkmcnt(3)
  v_mfma_f32_16x16x32_bf16 v[208:211], v[24:27], v[0:3], 0
  v_mfma_f32_16x16x32_bf16 v[212:215], v[24:27], v[4:7], 0
  v_mfma_f32_16x16x32_bf16 v[216:219], v[24:27], v[8:11], 0
  ds_read_b128 v[24:27], v40 offset:45056
  s_waitcnt lgkmcnt(3)
  v_mfma_f32_16x16x32_bf16 v[208:211], v[28:31], v[12:15], v[208:211]
  v_mfma_f32_16x16x32_bf16 v[212:215], v[28:31], v[16:19], v[212:215]
  v_mfma_f32_16x16x32_bf16 v[216:219], v[28:31], v[20:23], v[216:219]
  ds_read_b128 v[28:31], v41 offset:45056
  s_waitcnt lgkmcnt(3)
  v_mfma_f32_16x16x32_bf16 v[220:223], v[32:35], v[0:3], 0
  v_mfma_f32_16x16x32_bf16 v[224:227], v[32:35], v[4:7], 0
  v_mfma_f32_16x16x32_bf16 v[228:231], v[32:35], v[8:11], 0
  ds_read_b128 v[32:35], v40 offset:47104
  s_waitcnt lgkmcnt(3)
  v_mfma_f32_16x16x32_bf16 v[220:223], v[36:39], v[12:15], v[220:223]
  v_mfma_f32_16x16x32_bf16 v[224:227], v[36:39], v[16:19], v[224:227]
  v_mfma_f32_16x16x32_bf16 v[228:231], v[36:39], v[20:23], v[228:231]
  ds_read_b128 v[36:39], v41 offset:47104
  s_waitcnt lgkmcnt(3)
  v_mfma_f32_16x16x32_bf16 v[232:235], v[24:27], v[0:3], 0
  v_mfma_f32_16x16x32_bf16 v[236:239], v[24:27], v[4:7], 0
  v_mfma_f32_16x16x32_bf16 v[240:243], v[24:27], v[8:11], 0
  s_waitcnt lgkmcnt(2)
  v_mfma_f32_16x16x32_bf16 v[232:235], v[28:31], v[12:15], v[232:235]
  v_mfma_f32_16x16x32_bf16 v[236:239], v[28:31], v[16:19], v[236:239]
  v_mfma_f32_16x16x32_bf16 v[240:243], v[28:31], v[20:23], v[240:243]
  s_waitcnt lgkmcnt(1)
  v_mfma_f32_16x16x32_bf16 v[244:247], v[32:35], v[0:3], 0
  v_mfma_f32_16x16x32_bf16 v[248:251], v[32:35], v[4:7], 0
  v_mfma_f32_16x16x32_bf16 v[252:255], v[32:35], v[8:11], 0
  s_waitcnt lgkmcnt(0)
  v_mfma_f32_16x16x32_bf16 v[244:247], v[36:39], v[12:15], v[244:247]
  v_mfma_f32_16x16x32_bf16 v[248:251], v[36:39], v[16:19], v[248:251]
  v_mfma_f32_16x16x32_bf16 v[252:255], v[36:39], v[20:23], v[252:255]
  s_waitcnt vmcnt(0)
  s_barrier
  s_lshl_b32 s66, s76, 2
  v_mov_b32 v58, s66
  global_load_dword v59, v58, s[58:59] sc0 sc1
  ds_read_b128 v[0:3], v42 offset:12288
  ds_read_b128 v[4:7], v42 offset:14336
  ds_read_b128 v[8:11], v42 offset:16384
  ds_read_b128 v[12:15], v43 offset:12288
  ds_read_b128 v[16:19], v43 offset:14336
  ds_read_b128 v[20:23], v43 offset:16384
  ds_read_b128 v[24:27], v40 offset:0
  ds_read_b128 v[28:31], v41 offset:0
  ds_read_b128 v[32:35], v40 offset:2048
  s_add_u32 m0, s62, 32768
  s_add_u32 s67, s37, 131072
  buffer_load_dwordx4 v48, s[8:11], s67 offen nt lds
  s_add_u32 m0, s62, 33792
  s_add_u32 s67, s37, 135168
  buffer_load_dwordx4 v49, s[8:11], s67 offen nt lds
  s_add_u32 m0, s62, 34816
  s_add_u32 s67, s37, 139264
  buffer_load_dwordx4 v48, s[8:11], s67 offen nt lds
  s_add_u32 m0, s62, 35840
  s_add_u32 s67, s37, 143360
  buffer_load_dwordx4 v49, s[8:11], s67 offen nt lds
  s_add_u32 m0, s62, 36864
  s_add_u32 s67, s37, 147456
  buffer_load_dwordx4 v48, s[8:11], s67 offen nt lds
  s_add_u32 m0, s62, 37888
  s_add_u32 s67, s37, 151552
  buffer_load_dwordx4 v49, s[8:11], s67 offen nt lds
  s_add_u32 m0, s62, 38912
  s_add_u32 s67, s37, 155648
  buffer_load_dwordx4 v48, s[8:11], s67 offen nt lds
  s_add_u32 m0, s62, 39936
  s_add_u32 s67, s37, 159744
  buffer_load_dwordx4 v49, s[8:11], s67 offen nt lds
  ds_read_b128 v[36:39], v41 offset:2048
  s_waitcnt lgkmcnt(3)
  v_mfma_f32_16x16x32_bf16 v[64:67], v[24:27], v[0:3], v[64:67]
  v_mfma_f32_16x16x32_bf16 v[68:71], v[24:27], v[4:7], v[68:71]
  v_mfma_f32_16x16x32_bf16 v[72:75], v[24:27], v[8:11], v[72:75]
  ds_read_b128 v[24:27], v40 offset:4096
  s_waitcnt lgkmcnt(3)
  v_mfma_f32_16x16x32_bf16 v[64:67], v[28:31], v[12:15], v[64:67]
  v_mfma_f32_16x16x32_bf16 v[68:71], v[28:31], v[16:19], v[68:71]
  v_mfma_f32_16x16x32_bf16 v[72:75], v[28:31], v[20:23], v[72:75]
  ds_read_b128 v[28:31], v41 offset:4096
  s_waitcnt lgkmcnt(3)
  v_mfma_f32_16x16x32_bf16 v[76:79], v[32:35], v[0:3], v[76:79]
  v_mfma_f32_16x16x32_bf16 v[80:83], v[32:35], v[4:7], v[80:83]
  v_mfma_f32_16x16x32_bf16 v[84:87], v[32:35], v[8:11], v[84:87]
  ds_read_b128 v[32:35], v40 offset:6144
  s_waitcnt lgkmcnt(3)
  v_mfma_f32_16x16x32_bf16 v[76:79], v[36:39], v[12:15], v[76:79]
  v_mfma_f32_16x16x32_bf16 v[80:83], v[36:39], v[16:19], v[80:83]
  v_mfma_f32_16x16x32_bf16 v[84:87], v[36:39], v[20:23], v[84:87]
  ds_read_b128 v[36:39], v41 offset:6144
  s_waitcnt lgkmcnt(3)
  v_mfma_f32_16x16x32_bf16 v[88:91], v[24:27], v[0:3], v[88:91]
  v_mfma_f32_16x16x32_bf16 v[92:95], v[24:27], v[4:7], v[92:95]
  v_mfma_f32_16x16x32_bf16 v[96:99], v[24:27], v[8:11], v[96:99]
  ds_read_b128 v[24:27], v40 offset:8192
  s_waitcnt lgkmcnt(3)
  v_mfma_f32_16x16x32_bf16 v[88:91], v[28:31], v[12:15], v[88:91]
  v_mfma_f32_16x16x32_bf16 v[92:95], v[28:31], v[16:19], v[92:95]
  v_mfma_f32_16x16x32_bf16 v[96:99], v[28:31], v[20:23], v[96:99]
  ds_read_b128 v[28:31], v41 offset:8192
  s_waitcnt lgkmcnt(3)
  v_mfma_f32_16x16x32_bf16 v[100:103], v[32:35], v[0:3], v[100:103]
  v_mfma_f32_16x16x32_bf16 v[104:107], v[32:35], v[4:7], v[104:107]
  v_mfma_f32_16x16x32_bf16 v[108:111], v[32:35], v[8:11], v[108:111]
  ds_read_b128 v[32:35], v40 offset:10240
  s_waitcnt lgkmcnt(3)
  v_mfma_f32_16x16x32_bf16 v[100:103], v[36:39], v[12:15], v[100:103]
  v_mfma_f32_16x16x32_bf16 v[104:107], v[36:39], v[16:19], v[104:107]
  v_mfma_f32_16x16x32_bf16 v[108:111], v[36:39], v[20:23], v[108:111]
  ds_read_b128 v[36:39], v41 offset:10240
  s_waitcnt lgkmcnt(3)
  v_mfma_f32_16x16x32_bf16 v[112:115], v[24:27], v[0:3], v[112:115]
  v_mfma_f32_16x16x32_bf16 v[116:119], v[24:27], v[4:7], v[116:119]
  v_mfma_f32_16x16x32_bf16 v[120:123], v[24:27], v[8:11], v[120:123]
  ds_read_b128 v[24:27], v40 offset:12288
  s_waitcnt lgkmcnt(3)
  v_mfma_f32_16x16x32_bf16 v[112:115], v[28:31], v[12:15], v[112:115]
  v_mfma_f32_16x16x32_bf16 v[116:119], v[28:31], v[16:19], v[116:119]
  v_mfma_f32_16x16x32_bf16 v[120:123], v[28:31], v[20:23], v[120:123]
  ds_read_b128 v[28:31], v41 offset:12288
  s_waitcnt lgkmcnt(3)
  v_mfma_f32_16x16x32_bf16 v[124:127], v[32:35], v[0:3], v[124:127]
  v_mfma_f32_16x16x32_bf16 v[128:131], v[32:35], v[4:7], v[128:131]
  v_mfma_f32_16x16x32_bf16 v[132:135], v[32:35], v[8:11], v[132:135]
  ds_read_b128 v[32:35], v40 offset:14336
  s_waitcnt lgkmcnt(3)
  v_mfma_f32_16x16x32_bf16 v[124:127], v[36:39], v[12:15], v[124:127]
  v_mfma_f32_16x16x32_bf16 v[128:131], v[36:39], v[16:19], v[128:131]
  v_mfma_f32_16x16x32_bf16 v[132:135], v[36:39], v[20:23], v[132:135]
  ds_read_b128 v[36:39], v41 offset:14336
  s_waitcnt lgkmcnt(3)
  v_mfma_f32_16x16x32_bf16 v[136:139], v[24:27], v[0:3], v[136:139]
  v_mfma_f32_16x16x32_bf16 v[140:143], v[24:27], v[4:7], v[140:143]
  v_mfma_f32_16x16x32_bf16 v[144:147], v[24:27], v[8:11], v[144:147]
  s_waitcnt lgkmcnt(2)
  v_mfma_f32_16x16x32_bf16 v[136:139], v[28:31], v[12:15], v[136:139]
  v_mfma_f32_16x16x32_bf16 v[140:143], v[28:31], v[16:19], v[140:143]
  v_mfma_f32_16x16x32_bf16 v[144:147], v[28:31], v[20:23], v[144:147]
  s_waitcnt lgkmcnt(1)
  v_mfma_f32_16x16x32_bf16 v[148:151], v[32:35], v[0:3], v[148:151]
  v_mfma_f32_16x16x32_bf16 v[152:155], v[32:35], v[4:7], v[152:155]
  v_mfma_f32_16x16x32_bf16 v[156:159], v[32:35], v[8:11], v[156:159]
  s_waitcnt lgkmcnt(0)
  v_mfma_f32_16x16x32_bf16 v[148:151], v[36:39], v[12:15], v[148:151]
  v_mfma_f32_16x16x32_bf16 v[152:155], v[36:39], v[16:19], v[152:155]
  v_mfma_f32_16x16x32_bf16 v[156:159], v[36:39], v[20:23], v[156:159]
  s_waitcnt vmcnt(0)
  s_mov_b32 s68, 0
L_fc_poll:
  v_readfirstlane_b32 s67, v59
  s_nop 1
  s_cmp_eq_u32 s67, 1
  s_cbranch_scc1 L_fc_skip
  s_add_u32 s68, s68, 1
  s_cmp_ge_u32 s68, 400000
  s_cbranch_scc1 L_fc_skip
  s_sleep 2
  global_load_dword v59, v58, s[58:59] sc0 sc1
  s_waitcnt vmcnt(0)
  s_branch L_fc_poll
L_fc_skip:
  s_barrier
  ds_read_b128 v[24:27], v40 offset:32768
  ds_read_b128 v[28:31], v41 offset:32768
  ds_read_b128 v[32:35], v40 offset:34816
  s_add_u32 m0, s62, 0
  s_add_u32 s67, s38, 0
  buffer_load_dwordx4 v48, s[8:11], s67 offen nt lds
  s_add_u32 m0, s62, 1024
  s_add_u32 s67, s38, 4096
  buffer_load_dwordx4 v49, s[8:11], s67 offen nt lds
  s_add_u32 m0, s62, 2048
  s_add_u32 s67, s38, 8192
  buffer_load_dwordx4 v48, s[8:11], s67 offen nt lds
  s_add_u32 m0, s62, 3072
  s_add_u32 s67, s38, 12288
  buffer_load_dwordx4 v49, s[8:11], s67 offen nt lds
  s_add_u32 m0, s62, 4096
  s_add_u32 s67, s38, 16384
  buffer_load_dwordx4 v48, s[8:11], s67 offen nt lds
  s_add_u32 m0, s62, 5120
  s_add_u32 s67, s38, 20480
  buffer_load_dwordx4 v49, s[8:11], s67 offen nt lds
  s_add_u32 m0, s62, 6144
  s_add_u32 s67, s38, 24576
  buffer_load_dwordx4 v48, s[8:11], s67 offen nt lds
  s_add_u32 m0, s62, 7168
  s_add_u32 s67, s38, 28672
  buffer_load_dwordx4 v49, s[8:11], s67 offen nt lds
  ds_read_b128 v[36:39], v41 offset:34816
  s_waitcnt lgkmcnt(3)
  v_mfma_f32_16x16x32_bf16 v[160:163], v[24:27], v[0:3], v[160:163]
  v_mfma_f32_16x16x32_bf16 v[164:167], v[24:27], v[4:7], v[164:167]
  v_mfma_f32_16x16x32_bf16 v[168:171], v[24:27], v[8:11], v[168:171]
  ds_read_b128 v[24:27], v40 offset:36864
  s_waitcnt lgkmcnt(3)
  v_mfma_f32_16x16x32_bf16 v[160:163], v[28:31], v[12:15], v[160:163]
  v_mfma_f32_16x16x32_bf16 v[164:167], v[28:31], v[16:19], v[164:167]
  v_mfma_f32_16x16x32_bf16 v[168:171], v[28:31], v[20:23], v[168:171]
  ds_read_b128 v[28:31], v41 offset:36864
  s_waitcnt lgkmcnt(3)
  v_mfma_f32_16x16x32_bf16 v[172:175], v[32:35], v[0:3], v[172:175]
  v_mfma_f32_16x16x32_bf16 v[176:179], v[32:35], v[4:7], v[176:179]
  v_mfma_f32_16x16x32_bf16 v[180:183], v[32:35], v[8:11], v[180:183]
  ds_read_b128 v[32:35], v40 offset:38912
  s_waitcnt lgkmcnt(3)
  v_mfma_f32_16x16x32_bf16 v[172:175], v[36:39], v[12:15], v[172:175]
  v_mfma_f32_16x16x32_bf16 v[176:179], v[36:39], v[16:19], v[176:179]
  v_mfma_f32_16x16x32_bf16 v[180:183], v[36:39], v[20:23], v[180:183]
  ds_read_b128 v[36:39], v41 offset:38912
  s_waitcnt lgkmcnt(3)
  v_mfma_f32_16x16x32_bf16 v[184:187], v[24:27], v[0:3], v[184:187]
  v_mfma_f32_16x16x32_bf16 v[188:191], v[24:27], v[4:7], v[188:191]
  v_mfma_f32_16x16x32_bf16 v[192:195], v[24:27], v[8:11], v[192:195]
  ds_read_b128 v[24:27], v40 offset:40960
  s_waitcnt lgkmcnt(3)
  v_mfma_f32_16x16x32_bf16 v[184:187], v[28:31], v[12:15], v[184:187]
  v_mfma_f32_16x16x32_bf16 v[188:191], v[28:31], v[16:19], v[188:191]
  v_mfma_f32_16x16x32_bf16 v[192:195], v[28:31], v[20:23], v[192:195]
  ds_read_b128 v[28:31], v41 offset:40960
  s_waitcnt lgkmcnt(3)
  v_mfma_f32_16x16x32_bf16 v[196:199], v[32:35], v[0:3], v[196:199]
  v_mfma_f32_16x16x32_bf16 v[200:203], v[32:35], v[4:7], v[200:203]
  v_mfma_f32_16x16x32_bf16 v[204:207], v[32:35], v[8:11], v[204:207]
  ds_read_b128 v[32:35], v40 offset:43008
  s_waitcnt lgkmcnt(3)
  v_mfma_f32_16x16x32_bf16 v[196:199], v[36:39], v[12:15], v[196:199]
  v_mfma_f32_16x16x32_bf16 v[200:203], v[36:39], v[16:19], v[200:203]
  v_mfma_f32_16x16x32_bf16 v[204:207], v[36:39], v[20:23], v[204:207]
  ds_read_b128 v[36:39], v41 offset:43008
  s_waitcnt lgkmcnt(3)
  v_mfma_f32_16x16x32_bf16 v[208:211], v[24:27], v[0:3], v[208:211]
  v_mfma_f32_16x16x32_bf16 v[212:215], v[24:27], v[4:7], v[212:215]
  v_mfma_f32_16x16x32_bf16 v[216:219], v[24:27], v[8:11], v[216:219]
  ds_read_b128 v[24:27], v40 offset:45056
  s_waitcnt lgkmcnt(3)
  v_mfma_f32_16x16x32_bf16 v[208:211], v[28:31], v[12:15], v[208:211]
  v_mfma_f32_16x16x32_bf16 v[212:215], v[28:31], v[16:19], v[212:215]
  v_mfma_f32_16x16x32_bf16 v[216:219], v[28:31], v[20:23], v[216:219]
  ds_read_b128 v[28:31], v41 offset:45056
  s_waitcnt lgkmcnt(3)
  v_mfma_f32_16x16x32_bf16 v[220:223], v[32:35], v[0:3], v[220:223]
  v_mfma_f32_16x16x32_bf16 v[224:227], v[32:35], v[4:7], v[224:227]
  v_mfma_f32_16x16x32_bf16 v[228:231], v[32:35], v[8:11], v[228:231]
  ds_read_b128 v[32:35], v40 offset:47104
  s_waitcnt lgkmcnt(3)
  v_mfma_f32_16x16x32_bf16 v[220:223], v[36:39], v[12:15], v[220:223]
  v_mfma_f32_16x16x32_bf16 v[224:227], v[36:39], v[16:19], v[224:227]
  v_mfma_f32_16x16x32_bf16 v[228:231], v[36:39], v[20:23], v[228:231]
  ds_read_b128 v[36:39], v41 offset:47104
  s_waitcnt lgkmcnt(3)
  v_mfma_f32_16x16x32_bf16 v[232:235], v[24:27], v[0:3], v[232:235]
  v_mfma_f32_16x16x32_bf16 v[236:239], v[24:27], v[4:7], v[236:239]
  v_mfma_f32_16x16x32_bf16 v[240:243], v[24:27], v[8:11], v[240:243]
  s_waitcnt lgkmcnt(2)
  v_mfma_f32_16x16x32_bf16 v[232:235], v[28:31], v[12:15], v[232:235]
  v_mfma_f32_16x16x32_bf16 v[236:239], v[28:31], v[16:19], v[236:239]
  v_mfma_f32_16x16x32_bf16 v[240:243], v[28:31], v[20:23], v[240:243]
  s_waitcnt lgkmcnt(1)
  v_mfma_f32_16x16x32_bf16 v[244:247], v[32:35], v[0:3], v[244:247]
  v_mfma_f32_16x16x32_bf16 v[248:251], v[32:35], v[4:7], v[248:251]
  v_mfma_f32_16x16x32_bf16 v[252:255], v[32:35], v[8:11], v[252:255]
  s_waitcnt lgkmcnt(0)
  v_mfma_f32_16x16x32_bf16 v[244:247], v[36:39], v[12:15], v[244:247]
  v_mfma_f32_16x16x32_bf16 v[248:251], v[36:39], v[16:19], v[248:251]
  v_mfma_f32_16x16x32_bf16 v[252:255], v[36:39], v[20:23], v[252:255]
  s_waitcnt vmcnt(0)
  s_barrier
  s_add_u32 m0, s62, 32768
  s_add_u32 s67, s38, 131072
  buffer_load_dwordx4 v48, s[8:11], s67 offen nt lds
  s_add_u32 m0, s62, 33792
  s_add_u32 s67, s38, 135168
  buffer_load_dwordx4 v49, s[8:11], s67 offen nt lds
  s_add_u32 m0, s62, 34816
  s_add_u32 s67, s38, 139264
  buffer_load_dwordx4 v48, s[8:11], s67 offen nt lds
  s_add_u32 m0, s62, 35840
  s_add_u32 s67, s38, 143360
  buffer_load_dwordx4 v49, s[8:11], s67 offen nt lds
  s_add_u32 m0, s62, 36864
  s_add_u32 s67, s38, 147456
  buffer_load_dwordx4 v48, s[8:11], s67 offen nt lds
  s_add_u32 m0, s62, 37888
  s_add_u32 s67, s38, 151552
  buffer_load_dwordx4 v49, s[8:11], s67 offen nt lds
  s_add_u32 m0, s62, 38912
  s_add_u32 s67, s38, 155648
  buffer_load_dwordx4 v48, s[8:11], s67 offen nt lds
  s_add_u32 m0, s62, 39936
  s_add_u32 s67, s38, 159744
  buffer_load_dwordx4 v49, s[8:11], s67 offen nt lds
  s_barrier
  ds_read_b128 v[0:3], v42 offset:0
  ds_read_b128 v[4:7], v42 offset:2048
  ds_read_b128 v[8:11], v42 offset:4096
  ds_read_b128 v[12:15], v43 offset:0
  ds_read_b128 v[16:19], v43 offset:2048
  ds_read_b128 v[20:23], v43 offset:4096
  ds_read_b128 v[24:27], v40 offset:0
  ds_read_b128 v[28:31], v41 offset:0
  ds_read_b128 v[32:35], v40 offset:2048
  ds_read_b128 v[36:39], v41 offset:2048
  s_waitcnt lgkmcnt(3)
  v_mfma_f32_16x16x32_bf16 v[64:67], v[24:27], v[0:3], v[64:67]
  v_mfma_f32_16x16x32_bf16 v[68:71], v[24:27], v[4:7], v[68:71]
  v_mfma_f32_16x16x32_bf16 v[72:75], v[24:27], v[8:11], v[72:75]
  ds_read_b128 v[24:27], v40 offset:4096
  s_waitcnt lgkmcnt(3)
  v_mfma_f32_16x16x32_bf16 v[64:67], v[28:31], v[12:15], v[64:67]
  v_mfma_f32_16x16x32_bf16 v[68:71], v[28:31], v[16:19], v[68:71]
  v_mfma_f32_16x16x32_bf16 v[72:75], v[28:31], v[20:23], v[72:75]
  ds_read_b128 v[28:31], v41 offset:4096
  s_waitcnt lgkmcnt(3)
  v_mfma_f32_16x16x32_bf16 v[76:79], v[32:35], v[0:3], v[76:79]
  v_mfma_f32_16x16x32_bf16 v[80:83], v[32:35], v[4:7], v[80:83]
  v_mfma_f32_16x16x32_bf16 v[84:87], v[32:35], v[8:11], v[84:87]
  ds_read_b128 v[32:35], v40 offset:6144
  s_waitcnt lgkmcnt(3)
  v_mfma_f32_16x16x32_bf16 v[76:79], v[36:39], v[12:15], v[76:79]
  v_mfma_f32_16x16x32_bf16 v[80:83], v[36:39], v[16:19], v[80:83]
  v_mfma_f32_16x16x32_bf16 v[84:87], v[36:39], v[20:23], v[84:87]
  ds_read_b128 v[36:39], v41 offset:6144
  s_waitcnt lgkmcnt(3)
  v_mfma_f32_16x16x32_bf16 v[88:91], v[24:27], v[0:3], v[88:91]
  v_mfma_f32_16x16x32_bf16 v[92:95], v[24:27], v[4:7], v[92:95]
  v_mfma_f32_16x16x32_bf16 v[96:99], v[24:27], v[8:11], v[96:99]
  ds_read_b128 v[24:27], v40 offset:8192
  s_waitcnt lgkmcnt(3)
  v_mfma_f32_16x16x32_bf16 v[88:91], v[28:31], v[12:15], v[88:91]
  v_mfma_f32_16x16x32_bf16 v[92:95], v[28:31], v[16:19], v[92:95]
  v_mfma_f32_16x16x32_bf16 v[96:99], v[28:31], v[20:23], v[96:99]
  ds_read_b128 v[28:31], v41 offset:8192
  s_waitcnt lgkmcnt(3)
  v_mfma_f32_16x16x32_bf16 v[100:103], v[32:35], v[0:3], v[100:103]
  v_mfma_f32_16x16x32_bf16 v[104:107], v[32:35], v[4:7], v[104:107]
  v_mfma_f32_16x16x32_bf16 v[108:111], v[32:35], v[8:11], v[108:111]
  ds_read_b128 v[32:35], v40 offset:10240
  s_waitcnt lgkmcnt(3)
  v_mfma_f32_16x16x32_bf16 v[100:103], v[36:39], v[12:15], v[100:103]
  v_mfma_f32_16x16x32_bf16 v[104:107], v[36:39], v[16:19], v[104:107]
  v_mfma_f32_16x16x32_bf16 v[108:111], v[36:39], v[20:23], v[108:111]
  ds_read_b128 v[36:39], v41 offset:10240
  s_waitcnt lgkmcnt(3)
  v_mfma_f32_16x16x32_bf16 v[112:115], v[24:27], v[0:3], v[112:115]
  v_mfma_f32_16x16x32_bf16 v[116:119], v[24:27], v[4:7], v[116:119]
  v_mfma_f32_16x16x32_bf16 v[120:123], v[24:27], v[8:11], v[120:123]
  ds_read_b128 v[24:27], v40 offset:12288
  s_waitcnt lgkmcnt(3)
  v_mfma_f32_16x16x32_bf16 v[112:115], v[28:31], v[12:15], v[112:115]
  v_mfma_f32_16x16x32_bf16 v[116:119], v[28:31], v[16:19], v[116:119]
  v_mfma_f32_16x16x32_bf16 v[120:123], v[28:31], v[20:23], v[120:123]
  ds_read_b128 v[28:31], v41 offset:12288
  s_waitcnt lgkmcnt(3)
  v_mfma_f32_16x16x32_bf16 v[124:127], v[32:35], v[0:3], v[124:127]
  v_mfma_f32_16x16x32_bf16 v[128:131], v[32:35], v[4:7], v[128:131]
  v_mfma_f32_16x16x32_bf16 v[132:135], v[32:35], v[8:11], v[132:135]
  ds_read_b128 v[32:35], v40 offset:14336
  s_waitcnt lgkmcnt(3)
  v_mfma_f32_16x16x32_bf16 v[124:127], v[36:39], v[12:15], v[124:127]
  v_mfma_f32_16x16x32_bf16 v[128:131], v[36:39], v[16:19], v[128:131]
  v_mfma_f32_16x16x32_bf16 v[132:135], v[36:39], v[20:23], v[132:135]
  ds_read_b128 v[36:39], v41 offset:14336
  s_waitcnt lgkmcnt(3)
  v_mfma_f32_16x16x32_bf16 v[136:139], v[24:27], v[0:3], v[136:139]
  v_mfma_f32_16x16x32_bf16 v[140:143], v[24:27], v[4:7], v[140:143]
  v_mfma_f32_16x16x32_bf16 v[144:147], v[24:27], v[8:11], v[144:147]
  s_waitcnt lgkmcnt(2)
  v_mfma_f32_16x16x32_bf16 v[136:139], v[28:31], v[12:15], v[136:139]
  v_mfma_f32_16x16x32_bf16 v[140:143], v[28:31], v[16:19], v[140:143]
  v_mfma_f32_16x16x32_bf16 v[144:147], v[28:31], v[20:23], v[144:147]
  s_waitcnt lgkmcnt(1)
  v_mfma_f32_16x16x32_bf16 v[148:151], v[32:35], v[0:3], v[148:151]
  v_mfma_f32_16x16x32_bf16 v[152:155], v[32:35], v[4:7], v[152:155]
  v_mfma_f32_16x16x32_bf16 v[156:159], v[32:35], v[8:11], v[156:159]
  s_waitcnt lgkmcnt(0)
  v_mfma_f32_16x16x32_bf16 v[148:151], v[36:39], v[12:15], v[148:151]
  v_mfma_f32_16x16x32_bf16 v[152:155], v[36:39], v[16:19], v[152:155]
  v_mfma_f32_16x16x32_bf16 v[156:159], v[36:39], v[20:23], v[156:159]
  s_waitcnt vmcnt(0)
  s_barrier
  ds_read_b128 v[24:27], v40 offset:32768
  ds_read_b128 v[28:31], v41 offset:32768
  ds_read_b128 v[32:35], v40 offset:34816
  ds_read_b128 v[36:39], v41 offset:34816
  s_waitcnt lgkmcnt(3)
  v_mfma_f32_16x16x32_bf16 v[160:163], v[24:27], v[0:3], v[160:163]
  v_mfma_f32_16x16x32_bf16 v[164:167], v[24:27], v[4:7], v[164:167]
  v_mfma_f32_16x16x32_bf16 v[168:171], v[24:27], v[8:11], v[168:171]
  ds_read_b128 v[24:27], v40 offset:36864
  s_waitcnt lgkmcnt(3)
  v_mfma_f32_16x16x32_bf16 v[160:163], v[28:31], v[12:15], v[160:163]
  v_mfma_f32_16x16x32_bf16 v[164:167], v[28:31], v[16:19], v[164:167]
  v_mfma_f32_16x16x32_bf16 v[168:171], v[28:31], v[20:23], v[168:171]
  ds_read_b128 v[28:31], v41 offset:36864
  s_waitcnt lgkmcnt(3)
  v_mfma_f32_16x16x32_bf16 v[172:175], v[32:35], v[0:3], v[172:175]
  v_mfma_f32_16x16x32_bf16 v[176:179], v[32:35], v[4:7], v[176:179]
  v_mfma_f32_16x16x32_bf16 v[180:183], v[32:35], v[8:11], v[180:183]
  ds_read_b128 v[32:35], v40 offset:38912
  s_waitcnt lgkmcnt(3)
  v_mfma_f32_16x16x32_bf16 v[172:175], v[36:39], v[12:15], v[172:175]
  v_mfma_f32_16x16x32_bf16 v[176:179], v[36:39], v[16:19], v[176:179]
  v_mfma_f32_16x16x32_bf16 v[180:183], v[36:39], v[20:23], v[180:183]
  ds_read_b128 v[36:39], v41 offset:38912
  s_waitcnt lgkmcnt(3)
  v_mfma_f32_16x16x32_bf16 v[184:187], v[24:27], v[0:3], v[184:187]
  v_mfma_f32_16x16x32_bf16 v[188:191], v[24:27], v[4:7], v[188:191]
  v_mfma_f32_16x16x32_bf16 v[192:195], v[24:27], v[8:11], v[192:195]
  ds_read_b128 v[24:27], v40 offset:40960
  s_waitcnt lgkmcnt(3)
  v_mfma_f32_16x16x32_bf16 v[184:187], v[28:31], v[12:15], v[184:187]
  v_mfma_f32_16x16x32_bf16 v[188:191], v[28:31], v[16:19], v[188:191]
  v_mfma_f32_16x16x32_bf16 v[192:195], v[28:31], v[20:23], v[192:195]
  ds_read_b128 v[28:31], v41 offset:40960
  s_waitcnt lgkmcnt(3)
  v_mfma_f32_16x16x32_bf16 v[196:199], v[32:35], v[0:3], v[196:199]
  v_mfma_f32_16x16x32_bf16 v[200:203], v[32:35], v[4:7], v[200:203]
  v_mfma_f32_16x16x32_bf16 v[204:207], v[32:35], v[8:11], v[204:207]
  ds_read_b128 v[32:35], v40 offset:43008
  s_waitcnt lgkmcnt(3)
  v_mfma_f32_16x16x32_bf16 v[196:199], v[36:39], v[12:15], v[196:199]
  v_mfma_f32_16x16x32_bf16 v[200:203], v[36:39], v[16:19], v[200:203]
  v_mfma_f32_16x16x32_bf16 v[204:207], v[36:39], v[20:23], v[204:207]
  ds_read_b128 v[36:39], v41 offset:43008
  s_waitcnt lgkmcnt(3)
  v_mfma_f32_16x16x32_bf16 v[208:211], v[24:27], v[0:3], v[208:211]
  v_mfma_f32_16x16x32_bf16 v[212:215], v[24:27], v[4:7], v[212:215]
  v_mfma_f32_16x16x32_bf16 v[216:219], v[24:27], v[8:11], v[216:219]
  ds_read_b128 v[24:27], v40 offset:45056
  s_waitcnt lgkmcnt(3)
  v_mfma_f32_16x16x32_bf16 v[208:211], v[28:31], v[12:15], v[208:211]
  v_mfma_f32_16x16x32_bf16 v[212:215], v[28:31], v[16:19], v[212:215]
  v_mfma_f32_16x16x32_bf16 v[216:219], v[28:31], v[20:23], v[216:219]
  ds_read_b128 v[28:31], v41 offset:45056
  s_waitcnt lgkmcnt(3)
  v_mfma_f32_16x16x32_bf16 v[220:223], v[32:35], v[0:3], v[220:223]
  v_mfma_f32_16x16x32_bf16 v[224:227], v[32:35], v[4:7], v[224:227]
  v_mfma_f32_16x16x32_bf16 v[228:231], v[32:35], v[8:11], v[228:231]
  ds_read_b128 v[32:35], v40 offset:47104
  s_waitcnt lgkmcnt(3)
  v_mfma_f32_16x16x32_bf16 v[220:223], v[36:39], v[12:15], v[220:223]
  v_mfma_f32_16x16x32_bf16 v[224:227], v[36:39], v[16:19], v[224:227]
  v_mfma_f32_16x16x32_bf16 v[228:231], v[36:39], v[20:23], v[228:231]
  ds_read_b128 v[36:39], v41 offset:47104
  s_waitcnt lgkmcnt(3)
  v_mfma_f32_16x16x32_bf16 v[232:235], v[24:27], v[0:3], v[232:235]
  v_mfma_f32_16x16x32_bf16 v[236:239], v[24:27], v[4:7], v[236:239]
  v_mfma_f32_16x16x32_bf16 v[240:243], v[24:27], v[8:11], v[240:243]
  s_waitcnt lgkmcnt(2)
  v_mfma_f32_16x16x32_bf16 v[232:235], v[28:31], v[12:15], v[232:235]
  v_mfma_f32_16x16x32_bf16 v[236:239], v[28:31], v[16:19], v[236:239]
  v_mfma_f32_16x16x32_bf16 v[240:243], v[28:31], v[20:23], v[240:243]
  s_waitcnt lgkmcnt(1)
  v_mfma_f32_16x16x32_bf16 v[244:247], v[32:35], v[0:3], v[244:247]
  v_mfma_f32_16x16x32_bf16 v[248:251], v[32:35], v[4:7], v[248:251]
  v_mfma_f32_16x16x32_bf16 v[252:255], v[32:35], v[8:11], v[252:255]
  s_waitcnt lgkmcnt(0)
  v_mfma_f32_16x16x32_bf16 v[244:247], v[36:39], v[12:15], v[244:247]
  v_mfma_f32_16x16x32_bf16 v[248:251], v[36:39], v[16:19], v[248:251]
  v_mfma_f32_16x16x32_bf16 v[252:255], v[36:39], v[20:23], v[252:255]
  s_barrier
  v_add_u32 v40, 65536, v40
  v_add_u32 v41, 65536, v41
  ds_read_b128 v[0:3], v42 offset:12288
  ds_read_b128 v[4:7], v42 offset:14336
  ds_read_b128 v[8:11], v42 offset:16384
  ds_read_b128 v[12:15], v43 offset:12288
  ds_read_b128 v[16:19], v43 offset:14336
  ds_read_b128 v[20:23], v43 offset:16384
  ds_read_b128 v[24:27], v40 offset:0
  ds_read_b128 v[28:31], v41 offset:0
  ds_read_b128 v[32:35], v40 offset:2048
  ds_read_b128 v[36:39], v41 offset:2048
  s_waitcnt lgkmcnt(3)
  v_mfma_f32_16x16x32_bf16 v[64:67], v[24:27], v[0:3], v[64:67]
  v_mfma_f32_16x16x32_bf16 v[68:71], v[24:27], v[4:7], v[68:71]
  v_mfma_f32_16x16x32_bf16 v[72:75], v[24:27], v[8:11], v[72:75]
  ds_read_b128 v[24:27], v40 offset:4096
  s_waitcnt lgkmcnt(3)
  v_mfma_f32_16x16x32_bf16 v[64:67], v[28:31], v[12:15], v[64:67]
  v_mfma_f32_16x16x32_bf16 v[68:71], v[28:31], v[16:19], v[68:71]
  v_mfma_f32_16x16x32_bf16 v[72:75], v[28:31], v[20:23], v[72:75]
  ds_read_b128 v[28:31], v41 offset:4096
  s_waitcnt lgkmcnt(3)
  v_mfma_f32_16x16x32_bf16 v[76:79], v[32:35], v[0:3], v[76:79]
  v_mfma_f32_16x16x32_bf16 v[80:83], v[32:35], v[4:7], v[80:83]
  v_mfma_f32_16x16x32_bf16 v[84:87], v[32:35], v[8:11], v[84:87]
  ds_read_b128 v[32:35], v40 offset:6144
  s_waitcnt lgkmcnt(3)
  v_mfma_f32_16x16x32_bf16 v[76:79], v[36:39], v[12:15], v[76:79]
  v_mfma_f32_16x16x32_bf16 v[80:83], v[36:39], v[16:19], v[80:83]
  v_mfma_f32_16x16x32_bf16 v[84:87], v[36:39], v[20:23], v[84:87]
  ds_read_b128 v[36:39], v41 offset:6144
  s_waitcnt lgkmcnt(3)
  v_mfma_f32_16x16x32_bf16 v[88:91], v[24:27], v[0:3], v[88:91]
  v_mfma_f32_16x16x32_bf16 v[92:95], v[24:27], v[4:7], v[92:95]
  v_mfma_f32_16x16x32_bf16 v[96:99], v[24:27], v[8:11], v[96:99]
  ds_read_b128 v[24:27], v40 offset:8192
  s_waitcnt lgkmcnt(3)
  v_mfma_f32_16x16x32_bf16 v[88:91], v[28:31], v[12:15], v[88:91]
  v_mfma_f32_16x16x32_bf16 v[92:95], v[28:31], v[16:19], v[92:95]
  v_mfma_f32_16x16x32_bf16 v[96:99], v[28:31], v[20:23], v[96:99]
  ds_read_b128 v[28:31], v41 offset:8192
  s_waitcnt lgkmcnt(3)
  v_mfma_f32_16x16x32_bf16 v[100:103], v[32:35], v[0:3], v[100:103]
  v_mfma_f32_16x16x32_bf16 v[104:107], v[32:35], v[4:7], v[104:107]
  v_mfma_f32_16x16x32_bf16 v[108:111], v[32:35], v[8:11], v[108:111]
  ds_read_b128 v[32:35], v40 offset:10240
  s_waitcnt lgkmcnt(3)
  v_mfma_f32_16x16x32_bf16 v[100:103], v[36:39], v[12:15], v[100:103]
  v_mfma_f32_16x16x32_bf16 v[104:107], v[36:39], v[16:19], v[104:107]
  v_mfma_f32_16x16x32_bf16 v[108:111], v[36:39], v[20:23], v[108:111]
  ds_read_b128 v[36:39], v41 offset:10240
  s_waitcnt lgkmcnt(3)
  v_mfma_f32_16x16x32_bf16 v[112:115], v[24:27], v[0:3], v[112:115]
  v_mfma_f32_16x16x32_bf16 v[116:119], v[24:27], v[4:7], v[116:119]
  v_mfma_f32_16x16x32_bf16 v[120:123], v[24:27], v[8:11], v[120:123]
  ds_read_b128 v[24:27], v40 offset:12288
  s_waitcnt lgkmcnt(3)
  v_mfma_f32_16x16x32_bf16 v[112:115], v[28:31], v[12:15], v[112:115]
  v_mfma_f32_16x16x32_bf16 v[116:119], v[28:31], v[16:19], v[116:119]
  v_mfma_f32_16x16x32_bf16 v[120:123], v[28:31], v[20:23], v[120:123]
  ds_read_b128 v[28:31], v41 offset:12288
  s_waitcnt lgkmcnt(3)
  v_mfma_f32_16x16x32_bf16 v[124:127], v[32:35], v[0:3], v[124:127]
  v_mfma_f32_16x16x32_bf16 v[128:131], v[32:35], v[4:7], v[128:131]
  v_mfma_f32_16x16x32_bf16 v[132:135], v[32:35], v[8:11], v[132:135]
  ds_read_b128 v[32:35], v40 offset:14336
  s_waitcnt lgkmcnt(3)
  v_mfma_f32_16x16x32_bf16 v[124:127], v[36:39], v[12:15], v[124:127]
  v_mfma_f32_16x16x32_bf16 v[128:131], v[36:39], v[16:19], v[128:131]
  v_mfma_f32_16x16x32_bf16 v[132:135], v[36:39], v[20:23], v[132:135]
  ds_read_b128 v[36:39], v41 offset:14336
  s_waitcnt lgkmcnt(3)
  v_mfma_f32_16x16x32_bf16 v[136:139], v[24:27], v[0:3], v[136:139]
  v_mfma_f32_16x16x32_bf16 v[140:143], v[24:27], v[4:7], v[140:143]
  v_mfma_f32_16x16x32_bf16 v[144:147], v[24:27], v[8:11], v[144:147]
  s_waitcnt lgkmcnt(2)
  v_mfma_f32_16x16x32_bf16 v[136:139], v[28:31], v[12:15], v[136:139]
  v_mfma_f32_16x16x32_bf16 v[140:143], v[28:31], v[16:19], v[140:143]
  v_mfma_f32_16x16x32_bf16 v[144:147], v[28:31], v[20:23], v[144:147]
  s_waitcnt lgkmcnt(1)
  v_mfma_f32_16x16x32_bf16 v[148:151], v[32:35], v[0:3], v[148:151]
  v_mfma_f32_16x16x32_bf16 v[152:155], v[32:35], v[4:7], v[152:155]
  v_mfma_f32_16x16x32_bf16 v[156:159], v[32:35], v[8:11], v[156:159]
  s_waitcnt lgkmcnt(0)
  v_mfma_f32_16x16x32_bf16 v[148:151], v[36:39], v[12:15], v[148:151]
  v_mfma_f32_16x16x32_bf16 v[152:155], v[36:39], v[16:19], v[152:155]
  v_mfma_f32_16x16x32_bf16 v[156:159], v[36:39], v[20:23], v[156:159]
  v_max3_f32 v52, v64, v65, v66
  v_max3_f32 v24, v67, v76, v77
  v_max3_f32 v52, v52, v78, v79
  v_max3_f32 v24, v24, v88, v89
  v_max3_f32 v52, v52, v90, v91
  v_max3_f32 v24, v24, v100, v101
  v_max3_f32 v52, v52, v102, v103
  v_max3_f32 v24, v24, v112, v113
  v_max3_f32 v52, v52, v114, v115
  v_max3_f32 v24, v24, v124, v125
  v_max3_f32 v52, v52, v126, v127
  v_max3_f32 v24, v24, v136, v137
  v_max3_f32 v52, v52, v138, v139
  v_max3_f32 v24, v24, v148, v149
  v_max3_f32 v52, v52, v150, v151
  v_max_f32 v52, v52, v24
  v_max3_f32 v54, v68, v69, v70
  v_max3_f32 v24, v71, v80, v81
  v_max3_f32 v54, v54, v82, v83
  v_max3_f32 v24, v24, v92, v93
  v_max3_f32 v54, v54, v94, v95
  v_max3_f32 v24, v24, v104, v105
  v_max3_f32 v54, v54, v106, v107
  v_max3_f32 v24, v24, v116, v117
  v_max3_f32 v54, v54, v118, v119
  v_max3_f32 v24, v24, v128, v129
  v_max3_f32 v54, v54, v130, v131
  v_max3_f32 v24, v24, v140, v141
  v_max3_f32 v54, v54, v142, v143
  v_max3_f32 v24, v24, v152, v153
  v_max3_f32 v54, v54, v154, v155
  v_max_f32 v54, v54, v24
  v_max3_f32 v56, v72, v73, v74
  v_max3_f32 v24, v75, v84, v85
  v_max3_f32 v56, v56, v86, v87
  v_max3_f32 v24, v24, v96, v97
  v_max3_f32 v56, v56, v98, v99
  v_max3_f32 v24, v24, v108, v109
  v_max3_f32 v56, v56, v110, v111
  v_max3_f32 v24, v24, v120, v121
  v_max3_f32 v56, v56, v122, v123
  v_max3_f32 v24, v24, v132, v133
  v_max3_f32 v56, v56, v134, v135
  v_max3_f32 v24, v24, v144, v145
  v_max3_f32 v56, v56, v146, v147
  v_max3_f32 v24, v24, v156, v157
  v_max3_f32 v56, v56, v158, v159
  v_max_f32 v56, v56, v24
  v_mov_b32 v24, v52
  v_mov_b32 v25, v54
  v_mov_b32 v26, v56
  v_permlane32_swap_b32 v24, v52
  v_permlane32_swap_b32 v25, v54
  v_permlane32_swap_b32 v26, v56
  v_max_f32 v52, v24, v52
  v_max_f32 v54, v25, v54
  v_max_f32 v56, v26, v56
  v_mov_b32 v24, v52
  v_mov_b32 v25, v54
  v_mov_b32 v26, v56
  v_permlane16_swap_b32 v24, v52
  v_permlane16_swap_b32 v25, v54
  v_permlane16_swap_b32 v26, v56
  v_max_f32 v52, v24, v52
  v_mul_f32 v52, s64, v52
  v_max_f32 v54, v25, v54
  v_mul_f32 v54, s64, v54
  v_max_f32 v56, v26, v56
  v_mul_f32 v56, s64, v56
  v_pk_fma_f32 v[64:65], v[64:65], s[64:65], v[52:53] op_sel_hi:[1,1,0] neg_lo:[0,0,1] neg_hi:[0,0,1]
  v_pk_fma_f32 v[66:67], v[66:67], s[64:65], v[52:53] op_sel_hi:[1,1,0] neg_lo:[0,0,1] neg_hi:[0,0,1]
  v_pk_fma_f32 v[76:77], v[76:77], s[64:65], v[52:53] op_sel_hi:[1,1,0] neg_lo:[0,0,1] neg_hi:[0,0,1]
  v_pk_fma_f32 v[78:79], v[78:79], s[64:65], v[52:53] op_sel_hi:[1,1,0] neg_lo:[0,0,1] neg_hi:[0,0,1]
  v_exp_f32 v64, v64
  v_exp_f32 v65, v65
  v_exp_f32 v66, v66
  v_exp_f32 v67, v67
  v_exp_f32 v76, v76
  v_exp_f32 v77, v77
  v_exp_f32 v78, v78
  v_exp_f32 v79, v79
  v_cvt_pk_bf16_f32 v64, v64, v65
  v_cvt_pk_bf16_f32 v65, v66, v67
  v_cvt_pk_bf16_f32 v66, v76, v77
  v_cvt_pk_bf16_f32 v67, v78, v79
  v_pk_fma_f32 v[68:69], v[68:69], s[64:65], v[54:55] op_sel_hi:[1,1,0] neg_lo:[0,0,1] neg_hi:[0,0,1]
  v_pk_fma_f32 v[70:71], v[70:71], s[64:65], v[54:55] op_sel_hi:[1,1,0] neg_lo:[0,0,1] neg_hi:[0,0,1]
  v_pk_fma_f32 v[80:81], v[80:81], s[64:65], v[54:55] op_sel_hi:[1,1,0] neg_lo:[0,0,1] neg_hi:[0,0,1]
  v_pk_fma_f32 v[82:83], v[82:83], s[64:65], v[54:55] op_sel_hi:[1,1,0] neg_lo:[0,0,1] neg_hi:[0,0,1]
  v_exp_f32 v68, v68
  v_exp_f32 v69, v69
  v_exp_f32 v70, v70
  v_exp_f32 v71, v71
  v_exp_f32 v80, v80
  v_exp_f32 v81, v81
  v_exp_f32 v82, v82
  v_exp_f32 v83, v83
  v_cvt_pk_bf16_f32 v68, v68, v69
  v_cvt_pk_bf16_f32 v69, v70, v71
  v_cvt_pk_bf16_f32 v70, v80, v81
  v_cvt_pk_bf16_f32 v71, v82, v83
  v_pk_fma_f32 v[72:73], v[72:73], s[64:65], v[56:57] op_sel_hi:[1,1,0] neg_lo:[0,0,1] neg_hi:[0,0,1]
  v_pk_fma_f32 v[74:75], v[74:75], s[64:65], v[56:57] op_sel_hi:[1,1,0] neg_lo:[0,0,1] neg_hi:[0,0,1]
  v_pk_fma_f32 v[84:85], v[84:85], s[64:65], v[56:57] op_sel_hi:[1,1,0] neg_lo:[0,0,1] neg_hi:[0,0,1]
  v_pk_fma_f32 v[86:87], v[86:87], s[64:65], v[56:57] op_sel_hi:[1,1,0] neg_lo:[0,0,1] neg_hi:[0,0,1]
  v_exp_f32 v72, v72
  v_exp_f32 v73, v73
  v_exp_f32 v74, v74
  v_exp_f32 v75, v75
  v_exp_f32 v84, v84
  v_exp_f32 v85, v85
  v_exp_f32 v86, v86
  v_exp_f32 v87, v87
  v_cvt_pk_bf16_f32 v72, v72, v73
  v_cvt_pk_bf16_f32 v73, v74, v75
  v_cvt_pk_bf16_f32 v74, v84, v85
  v_cvt_pk_bf16_f32 v75, v86, v87
  v_pk_fma_f32 v[88:89], v[88:89], s[64:65], v[52:53] op_sel_hi:[1,1,0] neg_lo:[0,0,1] neg_hi:[0,0,1]
  v_pk_fma_f32 v[90:91], v[90:91], s[64:65], v[52:53] op_sel_hi:[1,1,0] neg_lo:[0,0,1] neg_hi:[0,0,1]
  v_pk_fma_f32 v[100:101], v[100:101], s[64:65], v[52:53] op_sel_hi:[1,1,0] neg_lo:[0,0,1] neg_hi:[0,0,1]
  v_pk_fma_f32 v[102:103], v[102:103], s[64:65], v[52:53] op_sel_hi:[1,1,0] neg_lo:[0,0,1] neg_hi:[0,0,1]
  v_exp_f32 v88, v88
  v_exp_f32 v89, v89
  v_exp_f32 v90, v90
  v_exp_f32 v91, v91
  v_exp_f32 v100, v100
  v_exp_f32 v101, v101
  v_exp_f32 v102, v102
  v_exp_f32 v103, v103
  v_cvt_pk_bf16_f32 v88, v88, v89
  v_cvt_pk_bf16_f32 v89, v90, v91
  v_cvt_pk_bf16_f32 v90, v100, v101
  v_cvt_pk_bf16_f32 v91, v102, v103
  v_pk_fma_f32 v[92:93], v[92:93], s[64:65], v[54:55] op_sel_hi:[1,1,0] neg_lo:[0,0,1] neg_hi:[0,0,1]
  v_pk_fma_f32 v[94:95], v[94:95], s[64:65], v[54:55] op_sel_hi:[1,1,0] neg_lo:[0,0,1] neg_hi:[0,0,1]
  v_pk_fma_f32 v[104:105], v[104:105], s[64:65], v[54:55] op_sel_hi:[1,1,0] neg_lo:[0,0,1] neg_hi:[0,0,1]
  v_pk_fma_f32 v[106:107], v[106:107], s[64:65], v[54:55] op_sel_hi:[1,1,0] neg_lo:[0,0,1] neg_hi:[0,0,1]
  v_exp_f32 v92, v92
  v_exp_f32 v93, v93
  v_exp_f32 v94, v94
  v_exp_f32 v95, v95
  v_exp_f32 v104, v104
  v_exp_f32 v105, v105
  v_exp_f32 v106, v106
  v_exp_f32 v107, v107
  v_cvt_pk_bf16_f32 v92, v92, v93
  v_cvt_pk_bf16_f32 v93, v94, v95
  v_cvt_pk_bf16_f32 v94, v104, v105
  v_cvt_pk_bf16_f32 v95, v106, v107
  v_pk_fma_f32 v[96:97], v[96:97], s[64:65], v[56:57] op_sel_hi:[1,1,0] neg_lo:[0,0,1] neg_hi:[0,0,1]
  v_pk_fma_f32 v[98:99], v[98:99], s[64:65], v[56:57] op_sel_hi:[1,1,0] neg_lo:[0,0,1] neg_hi:[0,0,1]
  v_pk_fma_f32 v[108:109], v[108:109], s[64:65], v[56:57] op_sel_hi:[1,1,0] neg_lo:[0,0,1] neg_hi:[0,0,1]
  v_pk_fma_f32 v[110:111], v[110:111], s[64:65], v[56:57] op_sel_hi:[1,1,0] neg_lo:[0,0,1] neg_hi:[0,0,1]
  v_exp_f32 v96, v96
  v_exp_f32 v97, v97
  v_exp_f32 v98, v98
  v_exp_f32 v99, v99
  v_exp_f32 v108, v108
  v_exp_f32 v109, v109
  v_exp_f32 v110, v110
  v_exp_f32 v111, v111
  v_cvt_pk_bf16_f32 v96, v96, v97
  v_cvt_pk_bf16_f32 v97, v98, v99
  v_cvt_pk_bf16_f32 v98, v108, v109
  v_cvt_pk_bf16_f32 v99, v110, v111
  v_pk_fma_f32 v[112:113], v[112:113], s[64:65], v[52:53] op_sel_hi:[1,1,0] neg_lo:[0,0,1] neg_hi:[0,0,1]
  v_pk_fma_f32 v[114:115], v[114:115], s[64:65], v[52:53] op_sel_hi:[1,1,0] neg_lo:[0,0,1] neg_hi:[0,0,1]
  v_pk_fma_f32 v[124:125], v[124:125], s[64:65], v[52:53] op_sel_hi:[1,1,0] neg_lo:[0,0,1] neg_hi:[0,0,1]
  v_pk_fma_f32 v[126:127], v[126:127], s[64:65], v[52:53] op_sel_hi:[1,1,0] neg_lo:[0,0,1] neg_hi:[0,0,1]
  v_exp_f32 v112, v112
  v_exp_f32 v113, v113
  v_exp_f32 v114, v114
  v_exp_f32 v115, v115
  v_exp_f32 v124, v124
  v_exp_f32 v125, v125
  v_exp_f32 v126, v126
  v_exp_f32 v127, v127
  v_cvt_pk_bf16_f32 v112, v112, v113
  v_cvt_pk_bf16_f32 v113, v114, v115
  v_cvt_pk_bf16_f32 v114, v124, v125
  v_cvt_pk_bf16_f32 v115, v126, v127
  v_pk_fma_f32 v[116:117], v[116:117], s[64:65], v[54:55] op_sel_hi:[1,1,0] neg_lo:[0,0,1] neg_hi:[0,0,1]
  v_pk_fma_f32 v[118:119], v[118:119], s[64:65], v[54:55] op_sel_hi:[1,1,0] neg_lo:[0,0,1] neg_hi:[0,0,1]
  v_pk_fma_f32 v[128:129], v[128:129], s[64:65], v[54:55] op_sel_hi:[1,1,0] neg_lo:[0,0,1] neg_hi:[0,0,1]
  v_pk_fma_f32 v[130:131], v[130:131], s[64:65], v[54:55] op_sel_hi:[1,1,0] neg_lo:[0,0,1] neg_hi:[0,0,1]
  v_exp_f32 v116, v116
  v_exp_f32 v117, v117
  v_exp_f32 v118, v118
  v_exp_f32 v119, v119
  v_exp_f32 v128, v128
  v_exp_f32 v129, v129
  v_exp_f32 v130, v130
  v_exp_f32 v131, v131
  v_cvt_pk_bf16_f32 v116, v116, v117
  v_cvt_pk_bf16_f32 v117, v118, v119
  v_cvt_pk_bf16_f32 v118, v128, v129
  v_cvt_pk_bf16_f32 v119, v130, v131
  v_pk_fma_f32 v[120:121], v[120:121], s[64:65], v[56:57] op_sel_hi:[1,1,0] neg_lo:[0,0,1] neg_hi:[0,0,1]
  v_pk_fma_f32 v[122:123], v[122:123], s[64:65], v[56:57] op_sel_hi:[1,1,0] neg_lo:[0,0,1] neg_hi:[0,0,1]
  v_pk_fma_f32 v[132:133], v[132:133], s[64:65], v[56:57] op_sel_hi:[1,1,0] neg_lo:[0,0,1] neg_hi:[0,0,1]
  v_pk_fma_f32 v[134:135], v[134:135], s[64:65], v[56:57] op_sel_hi:[1,1,0] neg_lo:[0,0,1] neg_hi:[0,0,1]
  v_exp_f32 v120, v120
  v_exp_f32 v121, v121
  v_exp_f32 v122, v122
  v_exp_f32 v123, v123
  v_exp_f32 v132, v132
  v_exp_f32 v133, v133
  v_exp_f32 v134, v134
  v_exp_f32 v135, v135
  v_cvt_pk_bf16_f32 v120, v120, v121
  v_cvt_pk_bf16_f32 v121, v122, v123
  v_cvt_pk_bf16_f32 v122, v132, v133
  v_cvt_pk_bf16_f32 v123, v134, v135
  v_pk_fma_f32 v[136:137], v[136:137], s[64:65], v[52:53] op_sel_hi:[1,1,0] neg_lo:[0,0,1] neg_hi:[0,0,1]
  v_pk_fma_f32 v[138:139], v[138:139], s[64:65], v[52:53] op_sel_hi:[1,1,0] neg_lo:[0,0,1] neg_hi:[0,0,1]
  v_pk_fma_f32 v[148:149], v[148:149], s[64:65], v[52:53] op_sel_hi:[1,1,0] neg_lo:[0,0,1] neg_hi:[0,0,1]
  v_pk_fma_f32 v[150:151], v[150:151], s[64:65], v[52:53] op_sel_hi:[1,1,0] neg_lo:[0,0,1] neg_hi:[0,0,1]
  v_exp_f32 v136, v136
  v_exp_f32 v137, v137
  v_exp_f32 v138, v138
  v_exp_f32 v139, v139
  v_exp_f32 v148, v148
  v_exp_f32 v149, v149
  v_exp_f32 v150, v150
  v_exp_f32 v151, v151
  v_cvt_pk_bf16_f32 v136, v136, v137
  v_cvt_pk_bf16_f32 v137, v138, v139
  v_cvt_pk_bf16_f32 v138, v148, v149
  v_cvt_pk_bf16_f32 v139, v150, v151
  v_pk_fma_f32 v[140:141], v[140:141], s[64:65], v[54:55] op_sel_hi:[1,1,0] neg_lo:[0,0,1] neg_hi:[0,0,1]
  v_pk_fma_f32 v[142:143], v[142:143], s[64:65], v[54:55] op_sel_hi:[1,1,0] neg_lo:[0,0,1] neg_hi:[0,0,1]
  v_pk_fma_f32 v[152:153], v[152:153], s[64:65], v[54:55] op_sel_hi:[1,1,0] neg_lo:[0,0,1] neg_hi:[0,0,1]
  v_pk_fma_f32 v[154:155], v[154:155], s[64:65], v[54:55] op_sel_hi:[1,1,0] neg_lo:[0,0,1] neg_hi:[0,0,1]
  v_exp_f32 v140, v140
  v_exp_f32 v141, v141
  v_exp_f32 v142, v142
  v_exp_f32 v143, v143
  v_exp_f32 v152, v152
  v_exp_f32 v153, v153
  v_exp_f32 v154, v154
  v_exp_f32 v155, v155
  v_cvt_pk_bf16_f32 v140, v140, v141
  v_cvt_pk_bf16_f32 v141, v142, v143
  v_cvt_pk_bf16_f32 v142, v152, v153
  v_cvt_pk_bf16_f32 v143, v154, v155
  v_pk_fma_f32 v[144:145], v[144:145], s[64:65], v[56:57] op_sel_hi:[1,1,0] neg_lo:[0,0,1] neg_hi:[0,0,1]
  v_pk_fma_f32 v[146:147], v[146:147], s[64:65], v[56:57] op_sel_hi:[1,1,0] neg_lo:[0,0,1] neg_hi:[0,0,1]
  v_pk_fma_f32 v[156:157], v[156:157], s[64:65], v[56:57] op_sel_hi:[1,1,0] neg_lo:[0,0,1] neg_hi:[0,0,1]
  v_pk_fma_f32 v[158:159], v[158:159], s[64:65], v[56:57] op_sel_hi:[1,1,0] neg_lo:[0,0,1] neg_hi:[0,0,1]
  v_exp_f32 v144, v144
  v_exp_f32 v145, v145
  v_exp_f32 v146, v146
  v_exp_f32 v147, v147
  v_exp_f32 v156, v156
  v_exp_f32 v157, v157
  v_exp_f32 v158, v158
  v_exp_f32 v159, v159
  v_cvt_pk_bf16_f32 v144, v144, v145
  v_cvt_pk_bf16_f32 v145, v146, v147
  v_cvt_pk_bf16_f32 v146, v156, v157
  v_cvt_pk_bf16_f32 v147, v158, v159
  v_mov_b32 v36, 0x3f803f80
  v_mov_b32 v37, 0x3f803f80
  v_mov_b32 v38, 0x3f803f80
  v_mov_b32 v39, 0x3f803f80
  s_nop 1
  v_mfma_f32_16x16x32_bf16 v[76:79], v[36:39], v[64:67], 0
  v_mfma_f32_16x16x32_bf16 v[80:83], v[36:39], v[68:71], 0
  v_mfma_f32_16x16x32_bf16 v[84:87], v[36:39], v[72:75], 0
  v_mfma_f32_16x16x32_bf16 v[76:79], v[36:39], v[88:91], v[76:79]
  v_mfma_f32_16x16x32_bf16 v[80:83], v[36:39], v[92:95], v[80:83]
  v_mfma_f32_16x16x32_bf16 v[84:87], v[36:39], v[96:99], v[84:87]
  v_mfma_f32_16x16x32_bf16 v[76:79], v[36:39], v[112:115], v[76:79]
  v_mfma_f32_16x16x32_bf16 v[80:83], v[36:39], v[116:119], v[80:83]
  v_mfma_f32_16x16x32_bf16 v[84:87], v[36:39], v[120:123], v[84:87]
  v_mfma_f32_16x16x32_bf16 v[76:79], v[36:39], v[136:139], v[76:79]
  v_mfma_f32_16x16x32_bf16 v[80:83], v[36:39], v[140:143], v[80:83]
  v_mfma_f32_16x16x32_bf16 v[84:87], v[36:39], v[144:147], v[84:87]
  s_nop 5
  v_mov_b32 v53, v76
  v_mov_b32 v55, v80
  v_mov_b32 v57, v84
  s_barrier
  ds_read_b128 v[24:27], v40 offset:32768
  ds_read_b128 v[28:31], v41 offset:32768
  ds_read_b128 v[32:35], v40 offset:34816
  ds_read_b128 v[36:39], v41 offset:34816
  s_waitcnt lgkmcnt(3)
  v_mfma_f32_16x16x32_bf16 v[160:163], v[24:27], v[0:3], v[160:163]
  v_mfma_f32_16x16x32_bf16 v[164:167], v[24:27], v[4:7], v[164:167]
  v_mfma_f32_16x16x32_bf16 v[168:171], v[24:27], v[8:11], v[168:171]
  ds_read_b128 v[24:27], v40 offset:36864
  s_waitcnt lgkmcnt(3)
  v_mfma_f32_16x16x32_bf16 v[160:163], v[28:31], v[12:15], v[160:163]
  v_mfma_f32_16x16x32_bf16 v[164:167], v[28:31], v[16:19], v[164:167]
  v_mfma_f32_16x16x32_bf16 v[168:171], v[28:31], v[20:23], v[168:171]
  ds_read_b128 v[28:31], v41 offset:36864
  s_waitcnt lgkmcnt(3)
  v_mfma_f32_16x16x32_bf16 v[172:175], v[32:35], v[0:3], v[172:175]
  v_mfma_f32_16x16x32_bf16 v[176:179], v[32:35], v[4:7], v[176:179]
  v_mfma_f32_16x16x32_bf16 v[180:183], v[32:35], v[8:11], v[180:183]
  ds_read_b128 v[32:35], v40 offset:38912
  s_waitcnt lgkmcnt(3)
  v_mfma_f32_16x16x32_bf16 v[172:175], v[36:39], v[12:15], v[172:175]
  v_mfma_f32_16x16x32_bf16 v[176:179], v[36:39], v[16:19], v[176:179]
  v_mfma_f32_16x16x32_bf16 v[180:183], v[36:39], v[20:23], v[180:183]
  ds_read_b128 v[36:39], v41 offset:38912
  s_waitcnt lgkmcnt(3)
  v_mfma_f32_16x16x32_bf16 v[184:187], v[24:27], v[0:3], v[184:187]
  v_mfma_f32_16x16x32_bf16 v[188:191], v[24:27], v[4:7], v[188:191]
  v_mfma_f32_16x16x32_bf16 v[192:195], v[24:27], v[8:11], v[192:195]
  ds_read_b128 v[24:27], v40 offset:40960
  s_waitcnt lgkmcnt(3)
  v_mfma_f32_16x16x32_bf16 v[184:187], v[28:31], v[12:15], v[184:187]
  v_mfma_f32_16x16x32_bf16 v[188:191], v[28:31], v[16:19], v[188:191]
  v_mfma_f32_16x16x32_bf16 v[192:195], v[28:31], v[20:23], v[192:195]
  ds_read_b128 v[28:31], v41 offset:40960
  s_waitcnt lgkmcnt(3)
  v_mfma_f32_16x16x32_bf16 v[196:199], v[32:35], v[0:3], v[196:199]
  v_mfma_f32_16x16x32_bf16 v[200:203], v[32:35], v[4:7], v[200:203]
  v_mfma_f32_16x16x32_bf16 v[204:207], v[32:35], v[8:11], v[204:207]
  ds_read_b128 v[32:35], v40 offset:43008
  s_waitcnt lgkmcnt(3)
  v_mfma_f32_16x16x32_bf16 v[196:199], v[36:39], v[12:15], v[196:199]
  v_mfma_f32_16x16x32_bf16 v[200:203], v[36:39], v[16:19], v[200:203]
  v_mfma_f32_16x16x32_bf16 v[204:207], v[36:39], v[20:23], v[204:207]
  ds_read_b128 v[36:39], v41 offset:43008
  s_waitcnt lgkmcnt(3)
  v_mfma_f32_16x16x32_bf16 v[208:211], v[24:27], v[0:3], v[208:211]
  v_mfma_f32_16x16x32_bf16 v[212:215], v[24:27], v[4:7], v[212:215]
  v_mfma_f32_16x16x32_bf16 v[216:219], v[24:27], v[8:11], v[216:219]
  ds_read_b128 v[24:27], v40 offset:45056
  s_waitcnt lgkmcnt(3)
  v_mfma_f32_16x16x32_bf16 v[208:211], v[28:31], v[12:15], v[208:211]
  v_mfma_f32_16x16x32_bf16 v[212:215], v[28:31], v[16:19], v[212:215]
  v_mfma_f32_16x16x32_bf16 v[216:219], v[28:31], v[20:23], v[216:219]
  ds_read_b128 v[28:31], v41 offset:45056
  s_waitcnt lgkmcnt(3)
  v_mfma_f32_16x16x32_bf16 v[220:223], v[32:35], v[0:3], v[220:223]
  v_mfma_f32_16x16x32_bf16 v[224:227], v[32:35], v[4:7], v[224:227]
  v_mfma_f32_16x16x32_bf16 v[228:231], v[32:35], v[8:11], v[228:231]
  ds_read_b128 v[32:35], v40 offset:47104
  s_waitcnt lgkmcnt(3)
  v_mfma_f32_16x16x32_bf16 v[220:223], v[36:39], v[12:15], v[220:223]
  v_mfma_f32_16x16x32_bf16 v[224:227], v[36:39], v[16:19], v[224:227]
  v_mfma_f32_16x16x32_bf16 v[228:231], v[36:39], v[20:23], v[228:231]
  ds_read_b128 v[36:39], v41 offset:47104
  s_waitcnt lgkmcnt(3)
  v_mfma_f32_16x16x32_bf16 v[232:235], v[24:27], v[0:3], v[232:235]
  v_mfma_f32_16x16x32_bf16 v[236:239], v[24:27], v[4:7], v[236:239]
  v_mfma_f32_16x16x32_bf16 v[240:243], v[24:27], v[8:11], v[240:243]
  s_waitcnt lgkmcnt(2)
  v_mfma_f32_16x16x32_bf16 v[232:235], v[28:31], v[12:15], v[232:235]
  v_mfma_f32_16x16x32_bf16 v[236:239], v[28:31], v[16:19], v[236:239]
  v_mfma_f32_16x16x32_bf16 v[240:243], v[28:31], v[20:23], v[240:243]
  s_waitcnt lgkmcnt(1)
  v_mfma_f32_16x16x32_bf16 v[244:247], v[32:35], v[0:3], v[244:247]
  v_mfma_f32_16x16x32_bf16 v[248:251], v[32:35], v[4:7], v[248:251]
  v_mfma_f32_16x16x32_bf16 v[252:255], v[32:35], v[8:11], v[252:255]
  s_waitcnt lgkmcnt(0)
  v_mfma_f32_16x16x32_bf16 v[244:247], v[36:39], v[12:15], v[244:247]
  v_mfma_f32_16x16x32_bf16 v[248:251], v[36:39], v[16:19], v[248:251]
  v_mfma_f32_16x16x32_bf16 v[252:255], v[36:39], v[20:23], v[252:255]
  v_max3_f32 v24, v160, v161, v162
  v_max3_f32 v30, v163, v172, v173
  v_max3_f32 v24, v24, v174, v175
  v_max3_f32 v30, v30, v184, v185
  v_max3_f32 v24, v24, v186, v187
  v_max3_f32 v30, v30, v196, v197
  v_max3_f32 v24, v24, v198, v199
  v_max3_f32 v30, v30, v208, v209
  v_max3_f32 v24, v24, v210, v211
  v_max3_f32 v30, v30, v220, v221
  v_max3_f32 v24, v24, v222, v223
  v_max3_f32 v30, v30, v232, v233
  v_max3_f32 v24, v24, v234, v235
  v_max3_f32 v30, v30, v244, v245
  v_max3_f32 v24, v24, v246, v247
  v_max_f32 v24, v24, v30
  v_max3_f32 v26, v164, v165, v166
  v_max3_f32 v30, v167, v176, v177
  v_max3_f32 v26, v26, v178, v179
  v_max3_f32 v30, v30, v188, v189
  v_max3_f32 v26, v26, v190, v191
  v_max3_f32 v30, v30, v200, v201
  v_max3_f32 v26, v26, v202, v203
  v_max3_f32 v30, v30, v212, v213
  v_max3_f32 v26, v26, v214, v215
  v_max3_f32 v30, v30, v224, v225
  v_max3_f32 v26, v26, v226, v227
  v_max3_f32 v30, v30, v236, v237
  v_max3_f32 v26, v26, v238, v239
  v_max3_f32 v30, v30, v248, v249
  v_max3_f32 v26, v26, v250, v251
  v_max_f32 v26, v26, v30
  v_max3_f32 v28, v168, v169, v170
  v_max3_f32 v30, v171, v180, v181
  v_max3_f32 v28, v28, v182, v183
  v_max3_f32 v30, v30, v192, v193
  v_max3_f32 v28, v28, v194, v195
  v_max3_f32 v30, v30, v204, v205
  v_max3_f32 v28, v28, v206, v207
  v_max3_f32 v30, v30, v216, v217
  v_max3_f32 v28, v28, v218, v219
  v_max3_f32 v30, v30, v228, v229
  v_max3_f32 v28, v28, v230, v231
  v_max3_f32 v30, v30, v240, v241
  v_max3_f32 v28, v28, v242, v243
  v_max3_f32 v30, v30, v252, v253
  v_max3_f32 v28, v28, v254, v255
  v_max_f32 v28, v28, v30
  v_mov_b32 v30, v24
  v_mov_b32 v31, v26
  v_mov_b32 v32, v28
  v_permlane32_swap_b32 v30, v24
  v_permlane32_swap_b32 v31, v26
  v_permlane32_swap_b32 v32, v28
  v_max_f32 v24, v30, v24
  v_max_f32 v26, v31, v26
  v_max_f32 v28, v32, v28
  v_mov_b32 v30, v24
  v_mov_b32 v31, v26
  v_mov_b32 v32, v28
  v_permlane16_swap_b32 v30, v24
  v_permlane16_swap_b32 v31, v26
  v_permlane16_swap_b32 v32, v28
  v_max_f32 v24, v30, v24
  v_mul_f32 v24, s64, v24
  v_max_f32 v26, v31, v26
  v_mul_f32 v26, s64, v26
  v_max_f32 v28, v32, v28
  v_mul_f32 v28, s64, v28
  v_max_f32 v24, v24, v52
  v_sub_f32 v0, v52, v24
  v_max_f32 v26, v26, v54
  v_sub_f32 v2, v54, v26
  v_max_f32 v28, v28, v56
  v_sub_f32 v4, v56, v28
  v_exp_f32 v0, v0
  v_exp_f32 v2, v2
  v_exp_f32 v4, v4
  v_pk_fma_f32 v[160:161], v[160:161], s[64:65], v[24:25] op_sel_hi:[1,1,0] neg_lo:[0,0,1] neg_hi:[0,0,1]
  v_pk_fma_f32 v[162:163], v[162:163], s[64:65], v[24:25] op_sel_hi:[1,1,0] neg_lo:[0,0,1] neg_hi:[0,0,1]
  v_pk_fma_f32 v[172:173], v[172:173], s[64:65], v[24:25] op_sel_hi:[1,1,0] neg_lo:[0,0,1] neg_hi:[0,0,1]
  v_pk_fma_f32 v[174:175], v[174:175], s[64:65], v[24:25] op_sel_hi:[1,1,0] neg_lo:[0,0,1] neg_hi:[0,0,1]
  v_exp_f32 v160, v160
  v_exp_f32 v161, v161
  v_exp_f32 v162, v162
  v_exp_f32 v163, v163
  v_exp_f32 v172, v172
  v_exp_f32 v173, v173
  v_exp_f32 v174, v174
  v_exp_f32 v175, v175
  v_cvt_pk_bf16_f32 v160, v160, v161
  v_cvt_pk_bf16_f32 v161, v162, v163
  v_cvt_pk_bf16_f32 v162, v172, v173
  v_cvt_pk_bf16_f32 v163, v174, v175
  v_pk_fma_f32 v[164:165], v[164:165], s[64:65], v[26:27] op_sel_hi:[1,1,0] neg_lo:[0,0,1] neg_hi:[0,0,1]
  v_pk_fma_f32 v[166:167], v[166:167], s[64:65], v[26:27] op_sel_hi:[1,1,0] neg_lo:[0,0,1] neg_hi:[0,0,1]
  v_pk_fma_f32 v[176:177], v[176:177], s[64:65], v[26:27] op_sel_hi:[1,1,0] neg_lo:[0,0,1] neg_hi:[0,0,1]
  v_pk_fma_f32 v[178:179], v[178:179], s[64:65], v[26:27] op_sel_hi:[1,1,0] neg_lo:[0,0,1] neg_hi:[0,0,1]
  v_exp_f32 v164, v164
  v_exp_f32 v165, v165
  v_exp_f32 v166, v166
  v_exp_f32 v167, v167
  v_exp_f32 v176, v176
  v_exp_f32 v177, v177
  v_exp_f32 v178, v178
  v_exp_f32 v179, v179
  v_cvt_pk_bf16_f32 v164, v164, v165
  v_cvt_pk_bf16_f32 v165, v166, v167
  v_cvt_pk_bf16_f32 v166, v176, v177
  v_cvt_pk_bf16_f32 v167, v178, v179
  v_pk_fma_f32 v[168:169], v[168:169], s[64:65], v[28:29] op_sel_hi:[1,1,0] neg_lo:[0,0,1] neg_hi:[0,0,1]
  v_pk_fma_f32 v[170:171], v[170:171], s[64:65], v[28:29] op_sel_hi:[1,1,0] neg_lo:[0,0,1] neg_hi:[0,0,1]
  v_pk_fma_f32 v[180:181], v[180:181], s[64:65], v[28:29] op_sel_hi:[1,1,0] neg_lo:[0,0,1] neg_hi:[0,0,1]
  v_pk_fma_f32 v[182:183], v[182:183], s[64:65], v[28:29] op_sel_hi:[1,1,0] neg_lo:[0,0,1] neg_hi:[0,0,1]
  v_exp_f32 v168, v168
  v_exp_f32 v169, v169
  v_exp_f32 v170, v170
  v_exp_f32 v171, v171
  v_exp_f32 v180, v180
  v_exp_f32 v181, v181
  v_exp_f32 v182, v182
  v_exp_f32 v183, v183
  v_cvt_pk_bf16_f32 v168, v168, v169
  v_cvt_pk_bf16_f32 v169, v170, v171
  v_cvt_pk_bf16_f32 v170, v180, v181
  v_cvt_pk_bf16_f32 v171, v182, v183
  v_pk_fma_f32 v[184:185], v[184:185], s[64:65], v[24:25] op_sel_hi:[1,1,0] neg_lo:[0,0,1] neg_hi:[0,0,1]
  v_pk_fma_f32 v[186:187], v[186:187], s[64:65], v[24:25] op_sel_hi:[1,1,0] neg_lo:[0,0,1] neg_hi:[0,0,1]
  v_pk_fma_f32 v[196:197], v[196:197], s[64:65], v[24:25] op_sel_hi:[1,1,0] neg_lo:[0,0,1] neg_hi:[0,0,1]
  v_pk_fma_f32 v[198:199], v[198:199], s[64:65], v[24:25] op_sel_hi:[1,1,0] neg_lo:[0,0,1] neg_hi:[0,0,1]
  v_exp_f32 v184, v184
  v_exp_f32 v185, v185
  v_exp_f32 v186, v186
  v_exp_f32 v187, v187
  v_exp_f32 v196, v196
  v_exp_f32 v197, v197
  v_exp_f32 v198, v198
  v_exp_f32 v199, v199
  v_cvt_pk_bf16_f32 v184, v184, v185
  v_cvt_pk_bf16_f32 v185, v186, v187
  v_cvt_pk_bf16_f32 v186, v196, v197
  v_cvt_pk_bf16_f32 v187, v198, v199
  v_pk_fma_f32 v[188:189], v[188:189], s[64:65], v[26:27] op_sel_hi:[1,1,0] neg_lo:[0,0,1] neg_hi:[0,0,1]
  v_pk_fma_f32 v[190:191], v[190:191], s[64:65], v[26:27] op_sel_hi:[1,1,0] neg_lo:[0,0,1] neg_hi:[0,0,1]
  v_pk_fma_f32 v[200:201], v[200:201], s[64:65], v[26:27] op_sel_hi:[1,1,0] neg_lo:[0,0,1] neg_hi:[0,0,1]
  v_pk_fma_f32 v[202:203], v[202:203], s[64:65], v[26:27] op_sel_hi:[1,1,0] neg_lo:[0,0,1] neg_hi:[0,0,1]
  v_exp_f32 v188, v188
  v_exp_f32 v189, v189
  v_exp_f32 v190, v190
  v_exp_f32 v191, v191
  v_exp_f32 v200, v200
  v_exp_f32 v201, v201
  v_exp_f32 v202, v202
  v_exp_f32 v203, v203
  v_cvt_pk_bf16_f32 v188, v188, v189
  v_cvt_pk_bf16_f32 v189, v190, v191
  v_cvt_pk_bf16_f32 v190, v200, v201
  v_cvt_pk_bf16_f32 v191, v202, v203
  v_pk_fma_f32 v[192:193], v[192:193], s[64:65], v[28:29] op_sel_hi:[1,1,0] neg_lo:[0,0,1] neg_hi:[0,0,1]
  v_pk_fma_f32 v[194:195], v[194:195], s[64:65], v[28:29] op_sel_hi:[1,1,0] neg_lo:[0,0,1] neg_hi:[0,0,1]
  v_pk_fma_f32 v[204:205], v[204:205], s[64:65], v[28:29] op_sel_hi:[1,1,0] neg_lo:[0,0,1] neg_hi:[0,0,1]
  v_pk_fma_f32 v[206:207], v[206:207], s[64:65], v[28:29] op_sel_hi:[1,1,0] neg_lo:[0,0,1] neg_hi:[0,0,1]
  v_exp_f32 v192, v192
  v_exp_f32 v193, v193
  v_exp_f32 v194, v194
  v_exp_f32 v195, v195
  v_exp_f32 v204, v204
  v_exp_f32 v205, v205
  v_exp_f32 v206, v206
  v_exp_f32 v207, v207
  v_cvt_pk_bf16_f32 v192, v192, v193
  v_cvt_pk_bf16_f32 v193, v194, v195
  v_cvt_pk_bf16_f32 v194, v204, v205
  v_cvt_pk_bf16_f32 v195, v206, v207
  v_pk_fma_f32 v[208:209], v[208:209], s[64:65], v[24:25] op_sel_hi:[1,1,0] neg_lo:[0,0,1] neg_hi:[0,0,1]
  v_pk_fma_f32 v[210:211], v[210:211], s[64:65], v[24:25] op_sel_hi:[1,1,0] neg_lo:[0,0,1] neg_hi:[0,0,1]
  v_pk_fma_f32 v[220:221], v[220:221], s[64:65], v[24:25] op_sel_hi:[1,1,0] neg_lo:[0,0,1] neg_hi:[0,0,1]
  v_pk_fma_f32 v[222:223], v[222:223], s[64:65], v[24:25] op_sel_hi:[1,1,0] neg_lo:[0,0,1] neg_hi:[0,0,1]
  v_exp_f32 v208, v208
  v_exp_f32 v209, v209
  v_exp_f32 v210, v210
  v_exp_f32 v211, v211
  v_exp_f32 v220, v220
  v_exp_f32 v221, v221
  v_exp_f32 v222, v222
  v_exp_f32 v223, v223
  v_cvt_pk_bf16_f32 v208, v208, v209
  v_cvt_pk_bf16_f32 v209, v210, v211
  v_cvt_pk_bf16_f32 v210, v220, v221
  v_cvt_pk_bf16_f32 v211, v222, v223
  v_pk_fma_f32 v[212:213], v[212:213], s[64:65], v[26:27] op_sel_hi:[1,1,0] neg_lo:[0,0,1] neg_hi:[0,0,1]
  v_pk_fma_f32 v[214:215], v[214:215], s[64:65], v[26:27] op_sel_hi:[1,1,0] neg_lo:[0,0,1] neg_hi:[0,0,1]
  v_pk_fma_f32 v[224:225], v[224:225], s[64:65], v[26:27] op_sel_hi:[1,1,0] neg_lo:[0,0,1] neg_hi:[0,0,1]
  v_pk_fma_f32 v[226:227], v[226:227], s[64:65], v[26:27] op_sel_hi:[1,1,0] neg_lo:[0,0,1] neg_hi:[0,0,1]
  v_exp_f32 v212, v212
  v_exp_f32 v213, v213
  v_exp_f32 v214, v214
  v_exp_f32 v215, v215
  v_exp_f32 v224, v224
  v_exp_f32 v225, v225
  v_exp_f32 v226, v226
  v_exp_f32 v227, v227
  v_cvt_pk_bf16_f32 v212, v212, v213
  v_cvt_pk_bf16_f32 v213, v214, v215
  v_cvt_pk_bf16_f32 v214, v224, v225
  v_cvt_pk_bf16_f32 v215, v226, v227
  v_pk_fma_f32 v[216:217], v[216:217], s[64:65], v[28:29] op_sel_hi:[1,1,0] neg_lo:[0,0,1] neg_hi:[0,0,1]
  v_pk_fma_f32 v[218:219], v[218:219], s[64:65], v[28:29] op_sel_hi:[1,1,0] neg_lo:[0,0,1] neg_hi:[0,0,1]
  v_pk_fma_f32 v[228:229], v[228:229], s[64:65], v[28:29] op_sel_hi:[1,1,0] neg_lo:[0,0,1] neg_hi:[0,0,1]
  v_pk_fma_f32 v[230:231], v[230:231], s[64:65], v[28:29] op_sel_hi:[1,1,0] neg_lo:[0,0,1] neg_hi:[0,0,1]
  v_exp_f32 v216, v216
  v_exp_f32 v217, v217
  v_exp_f32 v218, v218
  v_exp_f32 v219, v219
  v_exp_f32 v228, v228
  v_exp_f32 v229, v229
  v_exp_f32 v230, v230
  v_exp_f32 v231, v231
  v_cvt_pk_bf16_f32 v216, v216, v217
  v_cvt_pk_bf16_f32 v217, v218, v219
  v_cvt_pk_bf16_f32 v218, v228, v229
  v_cvt_pk_bf16_f32 v219, v230, v231
  v_pk_fma_f32 v[232:233], v[232:233], s[64:65], v[24:25] op_sel_hi:[1,1,0] neg_lo:[0,0,1] neg_hi:[0,0,1]
  v_pk_fma_f32 v[234:235], v[234:235], s[64:65], v[24:25] op_sel_hi:[1,1,0] neg_lo:[0,0,1] neg_hi:[0,0,1]
  v_pk_fma_f32 v[244:245], v[244:245], s[64:65], v[24:25] op_sel_hi:[1,1,0] neg_lo:[0,0,1] neg_hi:[0,0,1]
  v_pk_fma_f32 v[246:247], v[246:247], s[64:65], v[24:25] op_sel_hi:[1,1,0] neg_lo:[0,0,1] neg_hi:[0,0,1]
  v_exp_f32 v232, v232
  v_exp_f32 v233, v233
  v_exp_f32 v234, v234
  v_exp_f32 v235, v235
  v_exp_f32 v244, v244
  v_exp_f32 v245, v245
  v_exp_f32 v246, v246
  v_exp_f32 v247, v247
  v_cvt_pk_bf16_f32 v232, v232, v233
  v_cvt_pk_bf16_f32 v233, v234, v235
  v_cvt_pk_bf16_f32 v234, v244, v245
  v_cvt_pk_bf16_f32 v235, v246, v247
  v_pk_fma_f32 v[236:237], v[236:237], s[64:65], v[26:27] op_sel_hi:[1,1,0] neg_lo:[0,0,1] neg_hi:[0,0,1]
  v_pk_fma_f32 v[238:239], v[238:239], s[64:65], v[26:27] op_sel_hi:[1,1,0] neg_lo:[0,0,1] neg_hi:[0,0,1]
  v_pk_fma_f32 v[248:249], v[248:249], s[64:65], v[26:27] op_sel_hi:[1,1,0] neg_lo:[0,0,1] neg_hi:[0,0,1]
  v_pk_fma_f32 v[250:251], v[250:251], s[64:65], v[26:27] op_sel_hi:[1,1,0] neg_lo:[0,0,1] neg_hi:[0,0,1]
  v_exp_f32 v236, v236
  v_exp_f32 v237, v237
  v_exp_f32 v238, v238
  v_exp_f32 v239, v239
  v_exp_f32 v248, v248
  v_exp_f32 v249, v249
  v_exp_f32 v250, v250
  v_exp_f32 v251, v251
  v_cvt_pk_bf16_f32 v236, v236, v237
  v_cvt_pk_bf16_f32 v237, v238, v239
  v_cvt_pk_bf16_f32 v238, v248, v249
  v_cvt_pk_bf16_f32 v239, v250, v251
  v_pk_fma_f32 v[240:241], v[240:241], s[64:65], v[28:29] op_sel_hi:[1,1,0] neg_lo:[0,0,1] neg_hi:[0,0,1]
  v_pk_fma_f32 v[242:243], v[242:243], s[64:65], v[28:29] op_sel_hi:[1,1,0] neg_lo:[0,0,1] neg_hi:[0,0,1]
  v_pk_fma_f32 v[252:253], v[252:253], s[64:65], v[28:29] op_sel_hi:[1,1,0] neg_lo:[0,0,1] neg_hi:[0,0,1]
  v_pk_fma_f32 v[254:255], v[254:255], s[64:65], v[28:29] op_sel_hi:[1,1,0] neg_lo:[0,0,1] neg_hi:[0,0,1]
  v_exp_f32 v240, v240
  v_exp_f32 v241, v241
  v_exp_f32 v242, v242
  v_exp_f32 v243, v243
  v_exp_f32 v252, v252
  v_exp_f32 v253, v253
  v_exp_f32 v254, v254
  v_exp_f32 v255, v255
  v_cvt_pk_bf16_f32 v240, v240, v241
  v_cvt_pk_bf16_f32 v241, v242, v243
  v_cvt_pk_bf16_f32 v242, v252, v253
  v_cvt_pk_bf16_f32 v243, v254, v255
  v_mov_b32 v20, 0x3f803f80
  v_mov_b32 v21, 0x3f803f80
  v_mov_b32 v22, 0x3f803f80
  v_mov_b32 v23, 0x3f803f80
  s_nop 1
  v_mfma_f32_16x16x32_bf16 v[220:223], v[20:23], v[160:163], 0
  v_mfma_f32_16x16x32_bf16 v[224:227], v[20:23], v[164:167], 0
  v_mfma_f32_16x16x32_bf16 v[228:231], v[20:23], v[168:171], 0
  v_mfma_f32_16x16x32_bf16 v[220:223], v[20:23], v[184:187], v[220:223]
  v_mfma_f32_16x16x32_bf16 v[224:227], v[20:23], v[188:191], v[224:227]
  v_mfma_f32_16x16x32_bf16 v[228:231], v[20:23], v[192:195], v[228:231]
  v_mfma_f32_16x16x32_bf16 v[220:223], v[20:23], v[208:211], v[220:223]
  v_mfma_f32_16x16x32_bf16 v[224:227], v[20:23], v[212:215], v[224:227]
  v_mfma_f32_16x16x32_bf16 v[228:231], v[20:23], v[216:219], v[228:231]
  v_mfma_f32_16x16x32_bf16 v[220:223], v[20:23], v[232:235], v[220:223]
  v_mfma_f32_16x16x32_bf16 v[224:227], v[20:23], v[236:239], v[224:227]
  v_mfma_f32_16x16x32_bf16 v[228:231], v[20:23], v[240:243], v[228:231]
  s_and_b32 s67, s4, 1
  v_lshrrev_b32 v32, 2, v44
  v_lshrrev_b32 v33, 1, v32
  v_and_b32 v33, 3, v33
  s_lshl_b32 s68, s67, 14
  v_lshlrev_b32 v34, 7, v32
  v_add_u32 v34, s68, v34
  v_and_b32 v35, 3, v44
  v_lshl_add_u32 v34, v35, 3, v34
  s_lshl_b32 s68, s67, 1
  v_xor_b32 v33, s68, v33
  v_xor_b32 v35, 0, v33
  v_lshl_add_u32 v40, v35, 5, v34
  v_xor_b32 v35, 1, v33
  v_lshl_add_u32 v41, v35, 5, v34
  v_xor_b32 v35, 2, v33
  v_lshl_add_u32 v42, v35, 5, v34
  v_xor_b32 v35, 3, v33
  v_lshl_add_u32 v43, v35, 5, v34
  s_mul_i32 s66, s4, 384
  s_add_u32 s66, s66, 159744
  v_lshlrev_b32 v59, 3, v46
  v_add_u32 v59, s66, v59
  s_xor_b32 s67, s4, 1
  s_mul_i32 s67, s67, 384
  s_add_u32 s67, s67, 159744
  v_lshlrev_b32 v60, 3, v46
  v_add_u32 v60, s67, v60
  v_fma_f32 v25, v0, v53, v220
  v_fma_f32 v27, v2, v55, v224
  v_fma_f32 v29, v4, v57, v228
  ds_write_b64 v59, v[24:25] offset:0
  ds_write_b64 v59, v[26:27] offset:128
  ds_write_b64 v59, v[28:29] offset:256
  v_mov_b32 v18, v24
  v_mov_b32 v19, v25
  v_mov_b32 v20, v26
  v_mov_b32 v21, v27
  v_mov_b32 v22, v28
  v_mov_b32 v23, v29
  s_waitcnt lgkmcnt(0)
  s_barrier
  ds_read_b64_tr_b16 v[24:25], v40 offset:0
  ds_read_b64_tr_b16 v[26:27], v40 offset:2048
  ds_read_b64_tr_b16 v[28:29], v41 offset:0
  ds_read_b64_tr_b16 v[30:31], v41 offset:2048
  ds_read_b64_tr_b16 v[32:33], v42 offset:0
  ds_read_b64_tr_b16 v[34:35], v42 offset:2048
  ds_read_b64_tr_b16 v[36:37], v43 offset:0
  ds_read_b64_tr_b16 v[38:39], v43 offset:2048
  s_waitcnt lgkmcnt(6)
  v_mfma_f32_16x16x32_bf16 v[76:79], v[24:27], v[64:67], 0
  v_mfma_f32_16x16x32_bf16 v[80:83], v[24:27], v[68:71], 0
  v_mfma_f32_16x16x32_bf16 v[84:87], v[24:27], v[72:75], 0
  ds_read_b64_tr_b16 v[24:25], v40 offset:4096
  ds_read_b64_tr_b16 v[26:27], v40 offset:6144
  s_waitcnt lgkmcnt(6)
  v_mfma_f32_16x16x32_bf16 v[100:103], v[28:31], v[64:67], 0
  v_mfma_f32_16x16x32_bf16 v[104:107], v[28:31], v[68:71], 0
  v_mfma_f32_16x16x32_bf16 v[108:111], v[28:31], v[72:75], 0
  ds_read_b64_tr_b16 v[28:29], v41 offset:4096
  ds_read_b64_tr_b16 v[30:31], v41 offset:6144
  s_waitcnt lgkmcnt(6)
  v_mfma_f32_16x16x32_bf16 v[124:127], v[32:35], v[64:67], 0
  v_mfma_f32_16x16x32_bf16 v[128:131], v[32:35], v[68:71], 0
  v_mfma_f32_16x16x32_bf16 v[132:135], v[32:35], v[72:75], 0
  ds_read_b64_tr_b16 v[32:33], v42 offset:4096
  ds_read_b64_tr_b16 v[34:35], v42 offset:6144
  s_waitcnt lgkmcnt(6)
  v_mfma_f32_16x16x32_bf16 v[148:151], v[36:39], v[64:67], 0
  v_mfma_f32_16x16x32_bf16 v[152:155], v[36:39], v[68:71], 0
  v_mfma_f32_16x16x32_bf16 v[156:159], v[36:39], v[72:75], 0
  ds_read_b64_tr_b16 v[36:37], v43 offset:4096
  ds_read_b64_tr_b16 v[38:39], v43 offset:6144
  s_waitcnt lgkmcnt(6)
  v_mfma_f32_16x16x32_bf16 v[76:79], v[24:27], v[88:91], v[76:79]
  v_mfma_f32_16x16x32_bf16 v[80:83], v[24:27], v[92:95], v[80:83]
  v_mfma_f32_16x16x32_bf16 v[84:87], v[24:27], v[96:99], v[84:87]
  ds_read_b64_tr_b16 v[24:25], v40 offset:8192
  ds_read_b64_tr_b16 v[26:27], v40 offset:10240
  s_waitcnt lgkmcnt(6)
  v_mfma_f32_16x16x32_bf16 v[100:103], v[28:31], v[88:91], v[100:103]
  v_mfma_f32_16x16x32_bf16 v[104:107], v[28:31], v[92:95], v[104:107]
  v_mfma_f32_16x16x32_bf16 v[108:111], v[28:31], v[96:99], v[108:111]
  ds_read_b64_tr_b16 v[28:29], v41 offset:8192
  ds_read_b64_tr_b16 v[30:31], v41 offset:10240
  s_waitcnt lgkmcnt(6)
  v_mfma_f32_16x16x32_bf16 v[124:127], v[32:35], v[88:91], v[124:127]
  v_mfma_f32_16x16x32_bf16 v[128:131], v[32:35], v[92:95], v[128:131]
  v_mfma_f32_16x16x32_bf16 v[132:135], v[32:35], v[96:99], v[132:135]
  ds_read_b64_tr_b16 v[32:33], v42 offset:8192
  ds_read_b64_tr_b16 v[34:35], v42 offset:10240
  s_waitcnt lgkmcnt(6)
  v_mfma_f32_16x16x32_bf16 v[148:151], v[36:39], v[88:91], v[148:151]
  v_mfma_f32_16x16x32_bf16 v[152:155], v[36:39], v[92:95], v[152:155]
  v_mfma_f32_16x16x32_bf16 v[156:159], v[36:39], v[96:99], v[156:159]
  ds_read_b64_tr_b16 v[36:37], v43 offset:8192
  ds_read_b64_tr_b16 v[38:39], v43 offset:10240
  s_waitcnt lgkmcnt(6)
  v_mfma_f32_16x16x32_bf16 v[76:79], v[24:27], v[112:115], v[76:79]
  v_mfma_f32_16x16x32_bf16 v[80:83], v[24:27], v[116:119], v[80:83]
  v_mfma_f32_16x16x32_bf16 v[84:87], v[24:27], v[120:123], v[84:87]
  ds_read_b64_tr_b16 v[24:25], v40 offset:12288
  ds_read_b64_tr_b16 v[26:27], v40 offset:14336
  s_waitcnt lgkmcnt(6)
  v_mfma_f32_16x16x32_bf16 v[100:103], v[28:31], v[112:115], v[100:103]
  v_mfma_f32_16x16x32_bf16 v[104:107], v[28:31], v[116:119], v[104:107]
  v_mfma_f32_16x16x32_bf16 v[108:111], v[28:31], v[120:123], v[108:111]
  ds_read_b64_tr_b16 v[28:29], v41 offset:12288
  ds_read_b64_tr_b16 v[30:31], v41 offset:14336
  s_waitcnt lgkmcnt(6)
  v_mfma_f32_16x16x32_bf16 v[124:127], v[32:35], v[112:115], v[124:127]
  v_mfma_f32_16x16x32_bf16 v[128:131], v[32:35], v[116:119], v[128:131]
  v_mfma_f32_16x16x32_bf16 v[132:135], v[32:35], v[120:123], v[132:135]
  ds_read_b64_tr_b16 v[32:33], v42 offset:12288
  ds_read_b64_tr_b16 v[34:35], v42 offset:14336
  s_waitcnt lgkmcnt(6)
  v_mfma_f32_16x16x32_bf16 v[148:151], v[36:39], v[112:115], v[148:151]
  v_mfma_f32_16x16x32_bf16 v[152:155], v[36:39], v[116:119], v[152:155]
  v_mfma_f32_16x16x32_bf16 v[156:159], v[36:39], v[120:123], v[156:159]
  ds_read_b64_tr_b16 v[36:37], v43 offset:12288
  ds_read_b64_tr_b16 v[38:39], v43 offset:14336
  s_waitcnt lgkmcnt(6)
  v_mfma_f32_16x16x32_bf16 v[76:79], v[24:27], v[136:139], v[76:79]
  v_mfma_f32_16x16x32_bf16 v[80:83], v[24:27], v[140:143], v[80:83]
  v_mfma_f32_16x16x32_bf16 v[84:87], v[24:27], v[144:147], v[84:87]
  s_waitcnt lgkmcnt(4)
  v_mfma_f32_16x16x32_bf16 v[100:103], v[28:31], v[136:139], v[100:103]
  v_mfma_f32_16x16x32_bf16 v[104:107], v[28:31], v[140:143], v[104:107]
  v_mfma_f32_16x16x32_bf16 v[108:111], v[28:31], v[144:147], v[108:111]
  s_waitcnt lgkmcnt(2)
  v_mfma_f32_16x16x32_bf16 v[124:127], v[32:35], v[136:139], v[124:127]
  v_mfma_f32_16x16x32_bf16 v[128:131], v[32:35], v[140:143], v[128:131]
  v_mfma_f32_16x16x32_bf16 v[132:135], v[32:35], v[144:147], v[132:135]
  s_waitcnt lgkmcnt(0)
  v_mfma_f32_16x16x32_bf16 v[148:151], v[36:39], v[136:139], v[148:151]
  v_mfma_f32_16x16x32_bf16 v[152:155], v[36:39], v[140:143], v[152:155]
  v_mfma_f32_16x16x32_bf16 v[156:159], v[36:39], v[144:147], v[156:159]
  ds_read_b64 v[32:33], v60 offset:0
  ds_read_b64 v[34:35], v60 offset:128
  ds_read_b64 v[36:37], v60 offset:256
  s_mul_i32 s68, s4, 6144
  s_add_u32 s68, s68, 135168
  v_lshlrev_b32 v55, 4, v44
  v_add_u32 v52, s68, v55
  s_xor_b32 s68, s4, 1
  s_mul_i32 s68, s68, 6144
  s_add_u32 s68, s68, 135168
  v_add_u32 v53, s68, v55
  s_and_b32 s67, s4, 1
  s_lshr_b32 s66, s4, 1
  s_mul_i32 s68, s66, 6144
  s_add_u32 s68, s68, 122880
  v_lshlrev_b32 v54, 7, v46
  v_add_u32 v54, s68, v54
  s_lshl_b32 s69, s67, 2
  v_or_b32 v55, s69, v47
  v_lshrrev_b32 v56, 1, v46
  v_xor_b32 v55, v55, v56
  v_lshl_add_u32 v54, v55, 4, v54
  s_waitcnt lgkmcnt(0)
  v_max_f32 v38, v18, v32
  v_sub_f32 v6, v18, v38
  v_sub_f32 v12, v32, v38
  v_exp_f32 v6, v6
  v_exp_f32 v12, v12
  v_mul_f32 v38, v19, v6
  v_fma_f32 v38, v33, v12, v38
  v_rcp_f32 v38, v38
  s_nop 0
  v_mul_f32 v6, v6, v38
  v_mul_f32 v12, v12, v38
  v_max_f32 v38, v20, v34
  v_sub_f32 v8, v20, v38
  v_sub_f32 v14, v34, v38
  v_exp_f32 v8, v8
  v_exp_f32 v14, v14
  v_mul_f32 v38, v21, v8
  v_fma_f32 v38, v35, v14, v38
  v_rcp_f32 v38, v38
  s_nop 0
  v_mul_f32 v8, v8, v38
  v_mul_f32 v14, v14, v38
  v_max_f32 v38, v22, v36
  v_sub_f32 v10, v22, v38
  v_sub_f32 v16, v36, v38
  v_exp_f32 v10, v10
  v_exp_f32 v16, v16
  v_mul_f32 v38, v23, v10
  v_fma_f32 v38, v37, v16, v38
  v_rcp_f32 v38, v38
  s_nop 0
  v_mul_f32 v10, v10, v38
  v_mul_f32 v16, v16, v38
  s_lshl_b32 s66, s4, 4
  s_add_u32 s66, s66, 161280
  v_mov_b32 v55, s66
  s_xor_b32 s66, s66, 16
  v_mov_b32 v56, s66
  v_mul_f32 v76, v0, v76
  v_mul_f32 v77, v0, v77
  v_mul_f32 v78, v0, v78
  v_mul_f32 v79, v0, v79
  v_mul_f32 v80, v2, v80
  v_mul_f32 v81, v2, v81
  v_mul_f32 v82, v2, v82
  v_mul_f32 v83, v2, v83
  v_mul_f32 v84, v4, v84
  v_mul_f32 v85, v4, v85
  v_mul_f32 v86, v4, v86
  v_mul_f32 v87, v4, v87
  v_mul_f32 v100, v0, v100
  v_mul_f32 v101, v0, v101
  v_mul_f32 v102, v0, v102
  v_mul_f32 v103, v0, v103
  v_mul_f32 v104, v2, v104
  v_mul_f32 v105, v2, v105
  v_mul_f32 v106, v2, v106
  v_mul_f32 v107, v2, v107
  v_mul_f32 v108, v4, v108
  v_mul_f32 v109, v4, v109
  v_mul_f32 v110, v4, v110
  v_mul_f32 v111, v4, v111
  v_mul_f32 v124, v0, v124
  v_mul_f32 v125, v0, v125
  v_mul_f32 v126, v0, v126
  v_mul_f32 v127, v0, v127
  v_mul_f32 v128, v2, v128
  v_mul_f32 v129, v2, v129
  v_mul_f32 v130, v2, v130
  v_mul_f32 v131, v2, v131
  v_mul_f32 v132, v4, v132
  v_mul_f32 v133, v4, v133
  v_mul_f32 v134, v4, v134
  v_mul_f32 v135, v4, v135
  v_mul_f32 v148, v0, v148
  v_mul_f32 v149, v0, v149
  v_mul_f32 v150, v0, v150
  v_mul_f32 v151, v0, v151
  v_mul_f32 v152, v2, v152
  v_mul_f32 v153, v2, v153
  v_mul_f32 v154, v2, v154
  v_mul_f32 v155, v2, v155
  v_mul_f32 v156, v4, v156
  v_mul_f32 v157, v4, v157
  v_mul_f32 v158, v4, v158
  v_mul_f32 v159, v4, v159
  s_waitcnt lgkmcnt(0)
  s_barrier
  s_setprio 2
  ds_read_b64_tr_b16 v[24:25], v42 offset:32768
  ds_read_b64_tr_b16 v[26:27], v42 offset:34816
  ds_read_b64_tr_b16 v[28:29], v43 offset:32768
  ds_read_b64_tr_b16 v[30:31], v43 offset:34816
  ds_read_b64_tr_b16 v[32:33], v42 offset:36864
  ds_read_b64_tr_b16 v[34:35], v42 offset:38912
  ds_read_b64_tr_b16 v[36:37], v43 offset:36864
  ds_read_b64_tr_b16 v[38:39], v43 offset:38912
  s_waitcnt lgkmcnt(6)
  v_mfma_f32_16x16x32_bf16 v[124:127], v[24:27], v[160:163], v[124:127]
  v_mfma_f32_16x16x32_bf16 v[128:131], v[24:27], v[164:167], v[128:131]
  v_mfma_f32_16x16x32_bf16 v[132:135], v[24:27], v[168:171], v[132:135]
  ds_read_b64_tr_b16 v[24:25], v42 offset:40960
  ds_read_b64_tr_b16 v[26:27], v42 offset:43008
  s_waitcnt lgkmcnt(6)
  v_mfma_f32_16x16x32_bf16 v[148:151], v[28:31], v[160:163], v[148:151]
  v_mfma_f32_16x16x32_bf16 v[152:155], v[28:31], v[164:167], v[152:155]
  v_mfma_f32_16x16x32_bf16 v[156:159], v[28:31], v[168:171], v[156:159]
  ds_read_b64_tr_b16 v[28:29], v43 offset:40960
  ds_read_b64_tr_b16 v[30:31], v43 offset:43008
  s_waitcnt lgkmcnt(6)
  v_mfma_f32_16x16x32_bf16 v[124:127], v[32:35], v[184:187], v[124:127]
  v_mfma_f32_16x16x32_bf16 v[128:131], v[32:35], v[188:191], v[128:131]
  v_mfma_f32_16x16x32_bf16 v[132:135], v[32:35], v[192:195], v[132:135]
  ds_read_b64_tr_b16 v[32:33], v42 offset:45056
  ds_read_b64_tr_b16 v[34:35], v42 offset:47104
  s_waitcnt lgkmcnt(6)
  v_mfma_f32_16x16x32_bf16 v[148:151], v[36:39], v[184:187], v[148:151]
  v_mfma_f32_16x16x32_bf16 v[152:155], v[36:39], v[188:191], v[152:155]
  v_mfma_f32_16x16x32_bf16 v[156:159], v[36:39], v[192:195], v[156:159]
  ds_read_b64_tr_b16 v[36:37], v43 offset:45056
  ds_read_b64_tr_b16 v[38:39], v43 offset:47104
  s_waitcnt lgkmcnt(6)
  v_mfma_f32_16x16x32_bf16 v[124:127], v[24:27], v[208:211], v[124:127]
  v_mfma_f32_16x16x32_bf16 v[128:131], v[24:27], v[212:215], v[128:131]
  v_mfma_f32_16x16x32_bf16 v[132:135], v[24:27], v[216:219], v[132:135]
  ds_read_b64_tr_b16 v[24:25], v40 offset:32768
  ds_read_b64_tr_b16 v[26:27], v40 offset:34816
  s_waitcnt lgkmcnt(6)
  v_mfma_f32_16x16x32_bf16 v[148:151], v[28:31], v[208:211], v[148:151]
  v_mfma_f32_16x16x32_bf16 v[152:155], v[28:31], v[212:215], v[152:155]
  v_mfma_f32_16x16x32_bf16 v[156:159], v[28:31], v[216:219], v[156:159]
  ds_read_b64_tr_b16 v[28:29], v41 offset:32768
  ds_read_b64_tr_b16 v[30:31], v41 offset:34816
  s_waitcnt lgkmcnt(6)
  v_mfma_f32_16x16x32_bf16 v[124:127], v[32:35], v[232:235], v[124:127]
  v_mfma_f32_16x16x32_bf16 v[128:131], v[32:35], v[236:239], v[128:131]
  v_mfma_f32_16x16x32_bf16 v[132:135], v[32:35], v[240:243], v[132:135]
  ds_read_b64_tr_b16 v[32:33], v40 offset:36864
  ds_read_b64_tr_b16 v[34:35], v40 offset:38912
  s_waitcnt lgkmcnt(6)
  v_mfma_f32_16x16x32_bf16 v[148:151], v[36:39], v[232:235], v[148:151]
  v_mfma_f32_16x16x32_bf16 v[152:155], v[36:39], v[236:239], v[152:155]
  v_mfma_f32_16x16x32_bf16 v[156:159], v[36:39], v[240:243], v[156:159]
  ds_read_b64_tr_b16 v[36:37], v41 offset:36864
  ds_read_b64_tr_b16 v[38:39], v41 offset:38912
  s_waitcnt lgkmcnt(6)
  v_mfma_f32_16x16x32_bf16 v[76:79], v[24:27], v[160:163], v[76:79]
  v_mfma_f32_16x16x32_bf16 v[80:83], v[24:27], v[164:167], v[80:83]
  v_mfma_f32_16x16x32_bf16 v[84:87], v[24:27], v[168:171], v[84:87]
  ds_write_b128 v52, v[124:127] offset:0
  ds_write_b128 v52, v[128:131] offset:1024
  ds_write_b128 v52, v[132:135] offset:2048
  ds_read_b64_tr_b16 v[24:25], v40 offset:40960
  ds_read_b64_tr_b16 v[26:27], v40 offset:43008
  s_waitcnt lgkmcnt(9)
  v_mfma_f32_16x16x32_bf16 v[100:103], v[28:31], v[160:163], v[100:103]
  v_mfma_f32_16x16x32_bf16 v[104:107], v[28:31], v[164:167], v[104:107]
  v_mfma_f32_16x16x32_bf16 v[108:111], v[28:31], v[168:171], v[108:111]
  ds_write_b128 v52, v[148:151] offset:3072
  ds_write_b128 v52, v[152:155] offset:4096
  ds_write_b128 v52, v[156:159] offset:5120
  v_mov_b32 v57, 1
  ds_write_b32 v55, v57
  ds_read_b64_tr_b16 v[28:29], v41 offset:40960
  ds_read_b64_tr_b16 v[30:31], v41 offset:43008
  s_waitcnt lgkmcnt(13)
  v_mfma_f32_16x16x32_bf16 v[76:79], v[32:35], v[184:187], v[76:79]
  v_mfma_f32_16x16x32_bf16 v[80:83], v[32:35], v[188:191], v[80:83]
  v_mfma_f32_16x16x32_bf16 v[84:87], v[32:35], v[192:195], v[84:87]
  ds_read_b64_tr_b16 v[32:33], v40 offset:45056
  ds_read_b64_tr_b16 v[34:35], v40 offset:47104
  s_waitcnt lgkmcnt(13)
  v_mfma_f32_16x16x32_bf16 v[100:103], v[36:39], v[184:187], v[100:103]
  v_mfma_f32_16x16x32_bf16 v[104:107], v[36:39], v[188:191], v[104:107]
  v_mfma_f32_16x16x32_bf16 v[108:111], v[36:39], v[192:195], v[108:111]
  ds_read_b64_tr_b16 v[36:37], v41 offset:45056
  ds_read_b64_tr_b16 v[38:39], v41 offset:47104
  s_waitcnt lgkmcnt(10)
  v_mfma_f32_16x16x32_bf16 v[76:79], v[24:27], v[208:211], v[76:79]
  v_mfma_f32_16x16x32_bf16 v[80:83], v[24:27], v[212:215], v[80:83]
  v_mfma_f32_16x16x32_bf16 v[84:87], v[24:27], v[216:219], v[84:87]
  s_waitcnt lgkmcnt(4)
  v_mfma_f32_16x16x32_bf16 v[100:103], v[28:31], v[208:211], v[100:103]
  v_mfma_f32_16x16x32_bf16 v[104:107], v[28:31], v[212:215], v[104:107]
  v_mfma_f32_16x16x32_bf16 v[108:111], v[28:31], v[216:219], v[108:111]
  s_waitcnt lgkmcnt(2)
  v_mfma_f32_16x16x32_bf16 v[76:79], v[32:35], v[232:235], v[76:79]
  v_mfma_f32_16x16x32_bf16 v[80:83], v[32:35], v[236:239], v[80:83]
  v_mfma_f32_16x16x32_bf16 v[84:87], v[32:35], v[240:243], v[84:87]
  s_waitcnt lgkmcnt(0)
  v_mfma_f32_16x16x32_bf16 v[100:103], v[36:39], v[232:235], v[100:103]
  v_mfma_f32_16x16x32_bf16 v[104:107], v[36:39], v[236:239], v[104:107]
  v_mfma_f32_16x16x32_bf16 v[108:111], v[36:39], v[240:243], v[108:111]
  s_setprio 0
  s_waitcnt lgkmcnt(0)
L_ps0:
  ds_read_b32 v57, v56
  s_waitcnt lgkmcnt(0)
  v_readfirstlane_b32 s66, v57
  s_nop 1
  s_cmp_lt_u32 s66, 1
  s_cbranch_scc1 L_ps0
  ds_read_b128 v[172:175], v53 offset:0
  ds_read_b128 v[196:199], v53 offset:3072
  ds_read_b128 v[176:179], v53 offset:1024
  ds_read_b128 v[200:203], v53 offset:4096
  ds_read_b128 v[180:183], v53 offset:2048
  ds_read_b128 v[204:207], v53 offset:5120
  v_mul_f32 v76, v6, v76
  v_mul_f32 v77, v6, v77
  v_mul_f32 v78, v6, v78
  v_mul_f32 v79, v6, v79
  v_mul_f32 v100, v6, v100
  v_mul_f32 v101, v6, v101
  v_mul_f32 v102, v6, v102
  v_mul_f32 v103, v6, v103
  v_mul_f32 v80, v8, v80
  v_mul_f32 v81, v8, v81
  v_mul_f32 v82, v8, v82
  v_mul_f32 v83, v8, v83
  v_mul_f32 v104, v8, v104
  v_mul_f32 v105, v8, v105
  v_mul_f32 v106, v8, v106
  v_mul_f32 v107, v8, v107
  v_mul_f32 v84, v10, v84
  v_mul_f32 v85, v10, v85
  v_mul_f32 v86, v10, v86
  v_mul_f32 v87, v10, v87
  v_mul_f32 v108, v10, v108
  v_mul_f32 v109, v10, v109
  v_mul_f32 v110, v10, v110
  v_mul_f32 v111, v10, v111
  s_waitcnt lgkmcnt(4)
  v_fma_f32 v76, v172, v12, v76
  v_fma_f32 v77, v173, v12, v77
  v_fma_f32 v78, v174, v12, v78
  v_fma_f32 v79, v175, v12, v79
  v_fma_f32 v100, v196, v12, v100
  v_fma_f32 v101, v197, v12, v101
  v_fma_f32 v102, v198, v12, v102
  v_fma_f32 v103, v199, v12, v103
  v_cvt_pk_bf16_f32 v172, v76, v77
  v_cvt_pk_bf16_f32 v173, v78, v79
  v_cvt_pk_bf16_f32 v174, v100, v101
  v_cvt_pk_bf16_f32 v175, v102, v103
  ds_write_b128 v54, v[172:175] offset:0
  s_waitcnt lgkmcnt(3)
  v_fma_f32 v80, v176, v14, v80
  v_fma_f32 v81, v177, v14, v81
  v_fma_f32 v82, v178, v14, v82
  v_fma_f32 v83, v179, v14, v83
  v_fma_f32 v104, v200, v14, v104
  v_fma_f32 v105, v201, v14, v105
  v_fma_f32 v106, v202, v14, v106
  v_fma_f32 v107, v203, v14, v107
  v_cvt_pk_bf16_f32 v176, v80, v81
  v_cvt_pk_bf16_f32 v177, v82, v83
  v_cvt_pk_bf16_f32 v178, v104, v105
  v_cvt_pk_bf16_f32 v179, v106, v107
  ds_write_b128 v54, v[176:179] offset:2048
  s_waitcnt lgkmcnt(2)
  v_fma_f32 v84, v180, v16, v84
  v_fma_f32 v85, v181, v16, v85
  v_fma_f32 v86, v182, v16, v86
  v_fma_f32 v87, v183, v16, v87
  v_fma_f32 v108, v204, v16, v108
  v_fma_f32 v109, v205, v16, v109
  v_fma_f32 v110, v206, v16, v110
  v_fma_f32 v111, v207, v16, v111
  v_cvt_pk_bf16_f32 v180, v84, v85
  v_cvt_pk_bf16_f32 v181, v86, v87
  v_cvt_pk_bf16_f32 v182, v108, v109
  v_cvt_pk_bf16_f32 v183, v110, v111
  ds_write_b128 v54, v[180:183] offset:4096
  s_waitcnt lgkmcnt(0)
  s_barrier
  ds_read_b64_tr_b16 v[24:25], v40 offset:0
  ds_read_b64_tr_b16 v[26:27], v40 offset:2048
  ds_read_b64_tr_b16 v[28:29], v41 offset:0
  ds_read_b64_tr_b16 v[30:31], v41 offset:2048
  ds_read_b64_tr_b16 v[32:33], v42 offset:0
  ds_read_b64_tr_b16 v[34:35], v42 offset:2048
  ds_read_b64_tr_b16 v[36:37], v43 offset:0
  ds_read_b64_tr_b16 v[38:39], v43 offset:2048
  s_waitcnt lgkmcnt(6)
  v_mfma_f32_16x16x32_bf16 v[76:79], v[24:27], v[64:67], 0
  v_mfma_f32_16x16x32_bf16 v[80:83], v[24:27], v[68:71], 0
  v_mfma_f32_16x16x32_bf16 v[84:87], v[24:27], v[72:75], 0
  ds_read_b64_tr_b16 v[24:25], v40 offset:4096
  ds_read_b64_tr_b16 v[26:27], v40 offset:6144
  s_waitcnt lgkmcnt(6)
  v_mfma_f32_16x16x32_bf16 v[100:103], v[28:31], v[64:67], 0
  v_mfma_f32_16x16x32_bf16 v[104:107], v[28:31], v[68:71], 0
  v_mfma_f32_16x16x32_bf16 v[108:111], v[28:31], v[72:75], 0
  ds_read_b64_tr_b16 v[28:29], v41 offset:4096
  ds_read_b64_tr_b16 v[30:31], v41 offset:6144
  s_waitcnt lgkmcnt(6)
  v_mfma_f32_16x16x32_bf16 v[124:127], v[32:35], v[64:67], 0
  v_mfma_f32_16x16x32_bf16 v[128:131], v[32:35], v[68:71], 0
  v_mfma_f32_16x16x32_bf16 v[132:135], v[32:35], v[72:75], 0
  ds_read_b64_tr_b16 v[32:33], v42 offset:4096
  ds_read_b64_tr_b16 v[34:35], v42 offset:6144
  s_waitcnt lgkmcnt(6)
  v_mfma_f32_16x16x32_bf16 v[148:151], v[36:39], v[64:67], 0
  v_mfma_f32_16x16x32_bf16 v[152:155], v[36:39], v[68:71], 0
  v_mfma_f32_16x16x32_bf16 v[156:159], v[36:39], v[72:75], 0
  ds_read_b64_tr_b16 v[36:37], v43 offset:4096
  ds_read_b64_tr_b16 v[38:39], v43 offset:6144
  s_waitcnt lgkmcnt(6)
  v_mfma_f32_16x16x32_bf16 v[76:79], v[24:27], v[88:91], v[76:79]
  v_mfma_f32_16x16x32_bf16 v[80:83], v[24:27], v[92:95], v[80:83]
  v_mfma_f32_16x16x32_bf16 v[84:87], v[24:27], v[96:99], v[84:87]
  ds_read_b64_tr_b16 v[24:25], v40 offset:8192
  ds_read_b64_tr_b16 v[26:27], v40 offset:10240
  s_waitcnt lgkmcnt(6)
  v_mfma_f32_16x16x32_bf16 v[100:103], v[28:31], v[88:91], v[100:103]
  v_mfma_f32_16x16x32_bf16 v[104:107], v[28:31], v[92:95], v[104:107]
  v_mfma_f32_16x16x32_bf16 v[108:111], v[28:31], v[96:99], v[108:111]
  ds_read_b64_tr_b16 v[28:29], v41 offset:8192
  ds_read_b64_tr_b16 v[30:31], v41 offset:10240
  s_waitcnt lgkmcnt(6)
  v_mfma_f32_16x16x32_bf16 v[124:127], v[32:35], v[88:91], v[124:127]
  v_mfma_f32_16x16x32_bf16 v[128:131], v[32:35], v[92:95], v[128:131]
  v_mfma_f32_16x16x32_bf16 v[132:135], v[32:35], v[96:99], v[132:135]
  ds_read_b64_tr_b16 v[32:33], v42 offset:8192
  ds_read_b64_tr_b16 v[34:35], v42 offset:10240
  s_waitcnt lgkmcnt(6)
  v_mfma_f32_16x16x32_bf16 v[148:151], v[36:39], v[88:91], v[148:151]
  v_mfma_f32_16x16x32_bf16 v[152:155], v[36:39], v[92:95], v[152:155]
  v_mfma_f32_16x16x32_bf16 v[156:159], v[36:39], v[96:99], v[156:159]
  ds_read_b64_tr_b16 v[36:37], v43 offset:8192
  ds_read_b64_tr_b16 v[38:39], v43 offset:10240
  s_waitcnt lgkmcnt(6)
  v_mfma_f32_16x16x32_bf16 v[76:79], v[24:27], v[112:115], v[76:79]
  v_mfma_f32_16x16x32_bf16 v[80:83], v[24:27], v[116:119], v[80:83]
  v_mfma_f32_16x16x32_bf16 v[84:87], v[24:27], v[120:123], v[84:87]
  ds_read_b64_tr_b16 v[24:25], v40 offset:12288
  ds_read_b64_tr_b16 v[26:27], v40 offset:14336
  s_waitcnt lgkmcnt(6)
  v_mfma_f32_16x16x32_bf16 v[100:103], v[28:31], v[112:115], v[100:103]
  v_mfma_f32_16x16x32_bf16 v[104:107], v[28:31], v[116:119], v[104:107]
  v_mfma_f32_16x16x32_bf16 v[108:111], v[28:31], v[120:123], v[108:111]
  ds_read_b64_tr_b16 v[28:29], v41 offset:12288
  ds_read_b64_tr_b16 v[30:31], v41 offset:14336
  s_waitcnt lgkmcnt(6)
  v_mfma_f32_16x16x32_bf16 v[124:127], v[32:35], v[112:115], v[124:127]
  v_mfma_f32_16x16x32_bf16 v[128:131], v[32:35], v[116:119], v[128:131]
  v_mfma_f32_16x16x32_bf16 v[132:135], v[32:35], v[120:123], v[132:135]
  ds_read_b64_tr_b16 v[32:33], v42 offset:12288
  ds_read_b64_tr_b16 v[34:35], v42 offset:14336
  s_waitcnt lgkmcnt(6)
  v_mfma_f32_16x16x32_bf16 v[148:151], v[36:39], v[112:115], v[148:151]
  v_mfma_f32_16x16x32_bf16 v[152:155], v[36:39], v[116:119], v[152:155]
  v_mfma_f32_16x16x32_bf16 v[156:159], v[36:39], v[120:123], v[156:159]
  ds_read_b64_tr_b16 v[36:37], v43 offset:12288
  ds_read_b64_tr_b16 v[38:39], v43 offset:14336
  s_waitcnt lgkmcnt(6)
  v_mfma_f32_16x16x32_bf16 v[76:79], v[24:27], v[136:139], v[76:79]
  v_mfma_f32_16x16x32_bf16 v[80:83], v[24:27], v[140:143], v[80:83]
  v_mfma_f32_16x16x32_bf16 v[84:87], v[24:27], v[144:147], v[84:87]
  s_waitcnt lgkmcnt(4)
  v_mfma_f32_16x16x32_bf16 v[100:103], v[28:31], v[136:139], v[100:103]
  v_mfma_f32_16x16x32_bf16 v[104:107], v[28:31], v[140:143], v[104:107]
  v_mfma_f32_16x16x32_bf16 v[108:111], v[28:31], v[144:147], v[108:111]
  s_waitcnt lgkmcnt(2)
  v_mfma_f32_16x16x32_bf16 v[124:127], v[32:35], v[136:139], v[124:127]
  v_mfma_f32_16x16x32_bf16 v[128:131], v[32:35], v[140:143], v[128:131]
  v_mfma_f32_16x16x32_bf16 v[132:135], v[32:35], v[144:147], v[132:135]
  s_waitcnt lgkmcnt(0)
  v_mfma_f32_16x16x32_bf16 v[148:151], v[36:39], v[136:139], v[148:151]
  v_mfma_f32_16x16x32_bf16 v[152:155], v[36:39], v[140:143], v[152:155]
  v_mfma_f32_16x16x32_bf16 v[156:159], v[36:39], v[144:147], v[156:159]
  v_mul_f32 v76, v0, v76
  v_mul_f32 v77, v0, v77
  v_mul_f32 v78, v0, v78
  v_mul_f32 v79, v0, v79
  v_mul_f32 v80, v2, v80
  v_mul_f32 v81, v2, v81
  v_mul_f32 v82, v2, v82
  v_mul_f32 v83, v2, v83
  v_mul_f32 v84, v4, v84
  v_mul_f32 v85, v4, v85
  v_mul_f32 v86, v4, v86
  v_mul_f32 v87, v4, v87
  v_mul_f32 v100, v0, v100
  v_mul_f32 v101, v0, v101
  v_mul_f32 v102, v0, v102
  v_mul_f32 v103, v0, v103
  v_mul_f32 v104, v2, v104
  v_mul_f32 v105, v2, v105
  v_mul_f32 v106, v2, v106
  v_mul_f32 v107, v2, v107
  v_mul_f32 v108, v4, v108
  v_mul_f32 v109, v4, v109
  v_mul_f32 v110, v4, v110
  v_mul_f32 v111, v4, v111
  v_mul_f32 v124, v0, v124
  v_mul_f32 v125, v0, v125
  v_mul_f32 v126, v0, v126
  v_mul_f32 v127, v0, v127
  v_mul_f32 v128, v2, v128
  v_mul_f32 v129, v2, v129
  v_mul_f32 v130, v2, v130
  v_mul_f32 v131, v2, v131
  v_mul_f32 v132, v4, v132
  v_mul_f32 v133, v4, v133
  v_mul_f32 v134, v4, v134
  v_mul_f32 v135, v4, v135
  v_mul_f32 v148, v0, v148
  v_mul_f32 v149, v0, v149
  v_mul_f32 v150, v0, v150
  v_mul_f32 v151, v0, v151
  v_mul_f32 v152, v2, v152
  v_mul_f32 v153, v2, v153
  v_mul_f32 v154, v2, v154
  v_mul_f32 v155, v2, v155
  v_mul_f32 v156, v4, v156
  v_mul_f32 v157, v4, v157
  v_mul_f32 v158, v4, v158
  v_mul_f32 v159, v4, v159
  s_waitcnt lgkmcnt(0)
  s_barrier
  s_setprio 2
  ds_read_b64_tr_b16 v[24:25], v42 offset:32768
  ds_read_b64_tr_b16 v[26:27], v42 offset:34816
  ds_read_b64_tr_b16 v[28:29], v43 offset:32768
  ds_read_b64_tr_b16 v[30:31], v43 offset:34816
  ds_read_b64_tr_b16 v[32:33], v42 offset:36864
  ds_read_b64_tr_b16 v[34:35], v42 offset:38912
  ds_read_b64_tr_b16 v[36:37], v43 offset:36864
  ds_read_b64_tr_b16 v[38:39], v43 offset:38912
  s_waitcnt lgkmcnt(6)
  v_mfma_f32_16x16x32_bf16 v[124:127], v[24:27], v[160:163], v[124:127]
  v_mfma_f32_16x16x32_bf16 v[128:131], v[24:27], v[164:167], v[128:131]
  v_mfma_f32_16x16x32_bf16 v[132:135], v[24:27], v[168:171], v[132:135]
  ds_read_b64_tr_b16 v[24:25], v42 offset:40960
  ds_read_b64_tr_b16 v[26:27], v42 offset:43008
  s_waitcnt lgkmcnt(6)
  v_mfma_f32_16x16x32_bf16 v[148:151], v[28:31], v[160:163], v[148:151]
  v_mfma_f32_16x16x32_bf16 v[152:155], v[28:31], v[164:167], v[152:155]
  v_mfma_f32_16x16x32_bf16 v[156:159], v[28:31], v[168:171], v[156:159]
  ds_read_b64_tr_b16 v[28:29], v43 offset:40960
  ds_read_b64_tr_b16 v[30:31], v43 offset:43008
  s_waitcnt lgkmcnt(6)
  v_mfma_f32_16x16x32_bf16 v[124:127], v[32:35], v[184:187], v[124:127]
  v_mfma_f32_16x16x32_bf16 v[128:131], v[32:35], v[188:191], v[128:131]
  v_mfma_f32_16x16x32_bf16 v[132:135], v[32:35], v[192:195], v[132:135]
  ds_read_b64_tr_b16 v[32:33], v42 offset:45056
  ds_read_b64_tr_b16 v[34:35], v42 offset:47104
  s_waitcnt lgkmcnt(6)
  v_mfma_f32_16x16x32_bf16 v[148:151], v[36:39], v[184:187], v[148:151]
  v_mfma_f32_16x16x32_bf16 v[152:155], v[36:39], v[188:191], v[152:155]
  v_mfma_f32_16x16x32_bf16 v[156:159], v[36:39], v[192:195], v[156:159]
  ds_read_b64_tr_b16 v[36:37], v43 offset:45056
  ds_read_b64_tr_b16 v[38:39], v43 offset:47104
  s_waitcnt lgkmcnt(6)
  v_mfma_f32_16x16x32_bf16 v[124:127], v[24:27], v[208:211], v[124:127]
  v_mfma_f32_16x16x32_bf16 v[128:131], v[24:27], v[212:215], v[128:131]
  v_mfma_f32_16x16x32_bf16 v[132:135], v[24:27], v[216:219], v[132:135]
  ds_read_b64_tr_b16 v[24:25], v40 offset:32768
  ds_read_b64_tr_b16 v[26:27], v40 offset:34816
  s_waitcnt lgkmcnt(6)
  v_mfma_f32_16x16x32_bf16 v[148:151], v[28:31], v[208:211], v[148:151]
  v_mfma_f32_16x16x32_bf16 v[152:155], v[28:31], v[212:215], v[152:155]
  v_mfma_f32_16x16x32_bf16 v[156:159], v[28:31], v[216:219], v[156:159]
  ds_read_b64_tr_b16 v[28:29], v41 offset:32768
  ds_read_b64_tr_b16 v[30:31], v41 offset:34816
  s_waitcnt lgkmcnt(6)
  v_mfma_f32_16x16x32_bf16 v[124:127], v[32:35], v[232:235], v[124:127]
  v_mfma_f32_16x16x32_bf16 v[128:131], v[32:35], v[236:239], v[128:131]
  v_mfma_f32_16x16x32_bf16 v[132:135], v[32:35], v[240:243], v[132:135]
  ds_read_b64_tr_b16 v[32:33], v40 offset:36864
  ds_read_b64_tr_b16 v[34:35], v40 offset:38912
  s_waitcnt lgkmcnt(6)
  v_mfma_f32_16x16x32_bf16 v[148:151], v[36:39], v[232:235], v[148:151]
  v_mfma_f32_16x16x32_bf16 v[152:155], v[36:39], v[236:239], v[152:155]
  v_mfma_f32_16x16x32_bf16 v[156:159], v[36:39], v[240:243], v[156:159]
  ds_read_b64_tr_b16 v[36:37], v41 offset:36864
  ds_read_b64_tr_b16 v[38:39], v41 offset:38912
  s_waitcnt lgkmcnt(6)
  v_mfma_f32_16x16x32_bf16 v[76:79], v[24:27], v[160:163], v[76:79]
  v_mfma_f32_16x16x32_bf16 v[80:83], v[24:27], v[164:167], v[80:83]
  v_mfma_f32_16x16x32_bf16 v[84:87], v[24:27], v[168:171], v[84:87]
  ds_write_b128 v52, v[124:127] offset:0
  ds_write_b128 v52, v[128:131] offset:1024
  ds_write_b128 v52, v[132:135] offset:2048
  ds_read_b64_tr_b16 v[24:25], v40 offset:40960
  ds_read_b64_tr_b16 v[26:27], v40 offset:43008
  s_waitcnt lgkmcnt(9)
  v_mfma_f32_16x16x32_bf16 v[100:103], v[28:31], v[160:163], v[100:103]
  v_mfma_f32_16x16x32_bf16 v[104:107], v[28:31], v[164:167], v[104:107]
  v_mfma_f32_16x16x32_bf16 v[108:111], v[28:31], v[168:171], v[108:111]
  ds_write_b128 v52, v[148:151] offset:3072
  ds_write_b128 v52, v[152:155] offset:4096
  ds_write_b128 v52, v[156:159] offset:5120
  v_mov_b32 v57, 2
  ds_write_b32 v55, v57
  ds_read_b64_tr_b16 v[28:29], v41 offset:40960
  ds_read_b64_tr_b16 v[30:31], v41 offset:43008
  s_waitcnt lgkmcnt(13)
  v_mfma_f32_16x16x32_bf16 v[76:79], v[32:35], v[184:187], v[76:79]
  v_mfma_f32_16x16x32_bf16 v[80:83], v[32:35], v[188:191], v[80:83]
  v_mfma_f32_16x16x32_bf16 v[84:87], v[32:35], v[192:195], v[84:87]
  ds_read_b64_tr_b16 v[32:33], v40 offset:45056
  ds_read_b64_tr_b16 v[34:35], v40 offset:47104
  s_waitcnt lgkmcnt(13)
  v_mfma_f32_16x16x32_bf16 v[100:103], v[36:39], v[184:187], v[100:103]
  v_mfma_f32_16x16x32_bf16 v[104:107], v[36:39], v[188:191], v[104:107]
  v_mfma_f32_16x16x32_bf16 v[108:111], v[36:39], v[192:195], v[108:111]
  ds_read_b64_tr_b16 v[36:37], v41 offset:45056
  ds_read_b64_tr_b16 v[38:39], v41 offset:47104
  s_waitcnt lgkmcnt(10)
  v_mfma_f32_16x16x32_bf16 v[76:79], v[24:27], v[208:211], v[76:79]
  v_mfma_f32_16x16x32_bf16 v[80:83], v[24:27], v[212:215], v[80:83]
  v_mfma_f32_16x16x32_bf16 v[84:87], v[24:27], v[216:219], v[84:87]
  s_waitcnt lgkmcnt(4)
  v_mfma_f32_16x16x32_bf16 v[100:103], v[28:31], v[208:211], v[100:103]
  v_mfma_f32_16x16x32_bf16 v[104:107], v[28:31], v[212:215], v[104:107]
  v_mfma_f32_16x16x32_bf16 v[108:111], v[28:31], v[216:219], v[108:111]
  s_waitcnt lgkmcnt(2)
  v_mfma_f32_16x16x32_bf16 v[76:79], v[32:35], v[232:235], v[76:79]
  v_mfma_f32_16x16x32_bf16 v[80:83], v[32:35], v[236:239], v[80:83]
  v_mfma_f32_16x16x32_bf16 v[84:87], v[32:35], v[240:243], v[84:87]
  s_waitcnt lgkmcnt(0)
  v_mfma_f32_16x16x32_bf16 v[100:103], v[36:39], v[232:235], v[100:103]
  v_mfma_f32_16x16x32_bf16 v[104:107], v[36:39], v[236:239], v[104:107]
  v_mfma_f32_16x16x32_bf16 v[108:111], v[36:39], v[240:243], v[108:111]
  s_setprio 0
  s_waitcnt lgkmcnt(0)
L_ps1:
  ds_read_b32 v57, v56
  s_waitcnt lgkmcnt(0)
  v_readfirstlane_b32 s66, v57
  s_nop 1
  s_cmp_lt_u32 s66, 2
  s_cbranch_scc1 L_ps1
  ds_read_b128 v[172:175], v53 offset:0
  ds_read_b128 v[196:199], v53 offset:3072
  ds_read_b128 v[176:179], v53 offset:1024
  ds_read_b128 v[200:203], v53 offset:4096
  ds_read_b128 v[180:183], v53 offset:2048
  ds_read_b128 v[204:207], v53 offset:5120
  v_mul_f32 v76, v6, v76
  v_mul_f32 v77, v6, v77
  v_mul_f32 v78, v6, v78
  v_mul_f32 v79, v6, v79
  v_mul_f32 v100, v6, v100
  v_mul_f32 v101, v6, v101
  v_mul_f32 v102, v6, v102
  v_mul_f32 v103, v6, v103
  v_mul_f32 v80, v8, v80
  v_mul_f32 v81, v8, v81
  v_mul_f32 v82, v8, v82
  v_mul_f32 v83, v8, v83
  v_mul_f32 v104, v8, v104
  v_mul_f32 v105, v8, v105
  v_mul_f32 v106, v8, v106
  v_mul_f32 v107, v8, v107
  v_mul_f32 v84, v10, v84
  v_mul_f32 v85, v10, v85
  v_mul_f32 v86, v10, v86
  v_mul_f32 v87, v10, v87
  v_mul_f32 v108, v10, v108
  v_mul_f32 v109, v10, v109
  v_mul_f32 v110, v10, v110
  v_mul_f32 v111, v10, v111
  s_waitcnt lgkmcnt(4)
  v_fma_f32 v76, v172, v12, v76
  v_fma_f32 v77, v173, v12, v77
  v_fma_f32 v78, v174, v12, v78
  v_fma_f32 v79, v175, v12, v79
  v_fma_f32 v100, v196, v12, v100
  v_fma_f32 v101, v197, v12, v101
  v_fma_f32 v102, v198, v12, v102
  v_fma_f32 v103, v199, v12, v103
  v_cvt_pk_bf16_f32 v172, v76, v77
  v_cvt_pk_bf16_f32 v173, v78, v79
  v_cvt_pk_bf16_f32 v174, v100, v101
  v_cvt_pk_bf16_f32 v175, v102, v103
  ds_write_b128 v54, v[172:175] offset:0
  s_waitcnt lgkmcnt(3)
  v_fma_f32 v80, v176, v14, v80
  v_fma_f32 v81, v177, v14, v81
  v_fma_f32 v82, v178, v14, v82
  v_fma_f32 v83, v179, v14, v83
  v_fma_f32 v104, v200, v14, v104
  v_fma_f32 v105, v201, v14, v105
  v_fma_f32 v106, v202, v14, v106
  v_fma_f32 v107, v203, v14, v107
  v_cvt_pk_bf16_f32 v176, v80, v81
  v_cvt_pk_bf16_f32 v177, v82, v83
  v_cvt_pk_bf16_f32 v178, v104, v105
  v_cvt_pk_bf16_f32 v179, v106, v107
  ds_write_b128 v54, v[176:179] offset:2048
  s_waitcnt lgkmcnt(2)
  v_fma_f32 v84, v180, v16, v84
  v_fma_f32 v85, v181, v16, v85
  v_fma_f32 v86, v182, v16, v86
  v_fma_f32 v87, v183, v16, v87
  v_fma_f32 v108, v204, v16, v108
  v_fma_f32 v109, v205, v16, v109
  v_fma_f32 v110, v206, v16, v110
  v_fma_f32 v111, v207, v16, v111
  v_cvt_pk_bf16_f32 v180, v84, v85
  v_cvt_pk_bf16_f32 v181, v86, v87
  v_cvt_pk_bf16_f32 v182, v108, v109
  v_cvt_pk_bf16_f32 v183, v110, v111
  ds_write_b128 v54, v[180:183] offset:4096
  s_waitcnt lgkmcnt(0)
  s_barrier
  ds_read_b64_tr_b16 v[24:25], v40 offset:0
  ds_read_b64_tr_b16 v[26:27], v40 offset:2048
  ds_read_b64_tr_b16 v[28:29], v41 offset:0
  ds_read_b64_tr_b16 v[30:31], v41 offset:2048
  ds_read_b64_tr_b16 v[32:33], v42 offset:0
  ds_read_b64_tr_b16 v[34:35], v42 offset:2048
  ds_read_b64_tr_b16 v[36:37], v43 offset:0
  ds_read_b64_tr_b16 v[38:39], v43 offset:2048
  s_waitcnt lgkmcnt(6)
  v_mfma_f32_16x16x32_bf16 v[76:79], v[24:27], v[64:67], 0
  v_mfma_f32_16x16x32_bf16 v[80:83], v[24:27], v[68:71], 0
  v_mfma_f32_16x16x32_bf16 v[84:87], v[24:27], v[72:75], 0
  ds_read_b64_tr_b16 v[24:25], v40 offset:4096
  ds_read_b64_tr_b16 v[26:27], v40 offset:6144
  s_waitcnt lgkmcnt(6)
  v_mfma_f32_16x16x32_bf16 v[100:103], v[28:31], v[64:67], 0
  v_mfma_f32_16x16x32_bf16 v[104:107], v[28:31], v[68:71], 0
  v_mfma_f32_16x16x32_bf16 v[108:111], v[28:31], v[72:75], 0
  ds_read_b64_tr_b16 v[28:29], v41 offset:4096
  ds_read_b64_tr_b16 v[30:31], v41 offset:6144
  s_waitcnt lgkmcnt(6)
  v_mfma_f32_16x16x32_bf16 v[124:127], v[32:35], v[64:67], 0
  v_mfma_f32_16x16x32_bf16 v[128:131], v[32:35], v[68:71], 0
  v_mfma_f32_16x16x32_bf16 v[132:135], v[32:35], v[72:75], 0
  ds_read_b64_tr_b16 v[32:33], v42 offset:4096
  ds_read_b64_tr_b16 v[34:35], v42 offset:6144
  s_waitcnt lgkmcnt(6)
  v_mfma_f32_16x16x32_bf16 v[148:151], v[36:39], v[64:67], 0
  v_mfma_f32_16x16x32_bf16 v[152:155], v[36:39], v[68:71], 0
  v_mfma_f32_16x16x32_bf16 v[156:159], v[36:39], v[72:75], 0
  ds_read_b64_tr_b16 v[36:37], v43 offset:4096
  ds_read_b64_tr_b16 v[38:39], v43 offset:6144
  s_waitcnt lgkmcnt(6)
  v_mfma_f32_16x16x32_bf16 v[76:79], v[24:27], v[88:91], v[76:79]
  v_mfma_f32_16x16x32_bf16 v[80:83], v[24:27], v[92:95], v[80:83]
  v_mfma_f32_16x16x32_bf16 v[84:87], v[24:27], v[96:99], v[84:87]
  ds_read_b64_tr_b16 v[24:25], v40 offset:8192
  ds_read_b64_tr_b16 v[26:27], v40 offset:10240
  s_waitcnt lgkmcnt(6)
  v_mfma_f32_16x16x32_bf16 v[100:103], v[28:31], v[88:91], v[100:103]
  v_mfma_f32_16x16x32_bf16 v[104:107], v[28:31], v[92:95], v[104:107]
  v_mfma_f32_16x16x32_bf16 v[108:111], v[28:31], v[96:99], v[108:111]
  ds_read_b64_tr_b16 v[28:29], v41 offset:8192
  ds_read_b64_tr_b16 v[30:31], v41 offset:10240
  s_waitcnt lgkmcnt(6)
  v_mfma_f32_16x16x32_bf16 v[124:127], v[32:35], v[88:91], v[124:127]
  v_mfma_f32_16x16x32_bf16 v[128:131], v[32:35], v[92:95], v[128:131]
  v_mfma_f32_16x16x32_bf16 v[132:135], v[32:35], v[96:99], v[132:135]
  ds_read_b64_tr_b16 v[32:33], v42 offset:8192
  ds_read_b64_tr_b16 v[34:35], v42 offset:10240
  s_waitcnt lgkmcnt(6)
  v_mfma_f32_16x16x32_bf16 v[148:151], v[36:39], v[88:91], v[148:151]
  v_mfma_f32_16x16x32_bf16 v[152:155], v[36:39], v[92:95], v[152:155]
  v_mfma_f32_16x16x32_bf16 v[156:159], v[36:39], v[96:99], v[156:159]
  ds_read_b64_tr_b16 v[36:37], v43 offset:8192
  ds_read_b64_tr_b16 v[38:39], v43 offset:10240
  s_waitcnt lgkmcnt(6)
  v_mfma_f32_16x16x32_bf16 v[76:79], v[24:27], v[112:115], v[76:79]
  v_mfma_f32_16x16x32_bf16 v[80:83], v[24:27], v[116:119], v[80:83]
  v_mfma_f32_16x16x32_bf16 v[84:87], v[24:27], v[120:123], v[84:87]
  ds_read_b64_tr_b16 v[24:25], v40 offset:12288
  ds_read_b64_tr_b16 v[26:27], v40 offset:14336
  s_waitcnt lgkmcnt(6)
  v_mfma_f32_16x16x32_bf16 v[100:103], v[28:31], v[112:115], v[100:103]
  v_mfma_f32_16x16x32_bf16 v[104:107], v[28:31], v[116:119], v[104:107]
  v_mfma_f32_16x16x32_bf16 v[108:111], v[28:31], v[120:123], v[108:111]
  ds_read_b64_tr_b16 v[28:29], v41 offset:12288
  ds_read_b64_tr_b16 v[30:31], v41 offset:14336
  s_waitcnt lgkmcnt(6)
  v_mfma_f32_16x16x32_bf16 v[124:127], v[32:35], v[112:115], v[124:127]
  v_mfma_f32_16x16x32_bf16 v[128:131], v[32:35], v[116:119], v[128:131]
  v_mfma_f32_16x16x32_bf16 v[132:135], v[32:35], v[120:123], v[132:135]
  ds_read_b64_tr_b16 v[32:33], v42 offset:12288
  ds_read_b64_tr_b16 v[34:35], v42 offset:14336
  s_waitcnt lgkmcnt(6)
  v_mfma_f32_16x16x32_bf16 v[148:151], v[36:39], v[112:115], v[148:151]
  v_mfma_f32_16x16x32_bf16 v[152:155], v[36:39], v[116:119], v[152:155]
  v_mfma_f32_16x16x32_bf16 v[156:159], v[36:39], v[120:123], v[156:159]
  ds_read_b64_tr_b16 v[36:37], v43 offset:12288
  ds_read_b64_tr_b16 v[38:39], v43 offset:14336
  s_waitcnt lgkmcnt(6)
  v_mfma_f32_16x16x32_bf16 v[76:79], v[24:27], v[136:139], v[76:79]
  v_mfma_f32_16x16x32_bf16 v[80:83], v[24:27], v[140:143], v[80:83]
  v_mfma_f32_16x16x32_bf16 v[84:87], v[24:27], v[144:147], v[84:87]
  s_waitcnt lgkmcnt(4)
  v_mfma_f32_16x16x32_bf16 v[100:103], v[28:31], v[136:139], v[100:103]
  v_mfma_f32_16x16x32_bf16 v[104:107], v[28:31], v[140:143], v[104:107]
  v_mfma_f32_16x16x32_bf16 v[108:111], v[28:31], v[144:147], v[108:111]
  s_waitcnt lgkmcnt(2)
  v_mfma_f32_16x16x32_bf16 v[124:127], v[32:35], v[136:139], v[124:127]
  v_mfma_f32_16x16x32_bf16 v[128:131], v[32:35], v[140:143], v[128:131]
  v_mfma_f32_16x16x32_bf16 v[132:135], v[32:35], v[144:147], v[132:135]
  s_waitcnt lgkmcnt(0)
  v_mfma_f32_16x16x32_bf16 v[148:151], v[36:39], v[136:139], v[148:151]
  v_mfma_f32_16x16x32_bf16 v[152:155], v[36:39], v[140:143], v[152:155]
  v_mfma_f32_16x16x32_bf16 v[156:159], v[36:39], v[144:147], v[156:159]
  v_mul_f32 v76, v0, v76
  v_mul_f32 v77, v0, v77
  v_mul_f32 v78, v0, v78
  v_mul_f32 v79, v0, v79
  v_mul_f32 v80, v2, v80
  v_mul_f32 v81, v2, v81
  v_mul_f32 v82, v2, v82
  v_mul_f32 v83, v2, v83
  v_mul_f32 v84, v4, v84
  v_mul_f32 v85, v4, v85
  v_mul_f32 v86, v4, v86
  v_mul_f32 v87, v4, v87
  v_mul_f32 v100, v0, v100
  v_mul_f32 v101, v0, v101
  v_mul_f32 v102, v0, v102
  v_mul_f32 v103, v0, v103
  v_mul_f32 v104, v2, v104
  v_mul_f32 v105, v2, v105
  v_mul_f32 v106, v2, v106
  v_mul_f32 v107, v2, v107
  v_mul_f32 v108, v4, v108
  v_mul_f32 v109, v4, v109
  v_mul_f32 v110, v4, v110
  v_mul_f32 v111, v4, v111
  v_mul_f32 v124, v0, v124
  v_mul_f32 v125, v0, v125
  v_mul_f32 v126, v0, v126
  v_mul_f32 v127, v0, v127
  v_mul_f32 v128, v2, v128
  v_mul_f32 v129, v2, v129
  v_mul_f32 v130, v2, v130
  v_mul_f32 v131, v2, v131
  v_mul_f32 v132, v4, v132
  v_mul_f32 v133, v4, v133
  v_mul_f32 v134, v4, v134
  v_mul_f32 v135, v4, v135
  v_mul_f32 v148, v0, v148
  v_mul_f32 v149, v0, v149
  v_mul_f32 v150, v0, v150
  v_mul_f32 v151, v0, v151
  v_mul_f32 v152, v2, v152
  v_mul_f32 v153, v2, v153
  v_mul_f32 v154, v2, v154
  v_mul_f32 v155, v2, v155
  v_mul_f32 v156, v4, v156
  v_mul_f32 v157, v4, v157
  v_mul_f32 v158, v4, v158
  v_mul_f32 v159, v4, v159
  s_waitcnt lgkmcnt(0)
  s_barrier
  s_setprio 2
  ds_read_b64_tr_b16 v[24:25], v42 offset:32768
  ds_read_b64_tr_b16 v[26:27], v42 offset:34816
  ds_read_b64_tr_b16 v[28:29], v43 offset:32768
  ds_read_b64_tr_b16 v[30:31], v43 offset:34816
  ds_read_b64_tr_b16 v[32:33], v42 offset:36864
  ds_read_b64_tr_b16 v[34:35], v42 offset:38912
  ds_read_b64_tr_b16 v[36:37], v43 offset:36864
  ds_read_b64_tr_b16 v[38:39], v43 offset:38912
  s_waitcnt lgkmcnt(6)
  v_mfma_f32_16x16x32_bf16 v[124:127], v[24:27], v[160:163], v[124:127]
  v_mfma_f32_16x16x32_bf16 v[128:131], v[24:27], v[164:167], v[128:131]
  v_mfma_f32_16x16x32_bf16 v[132:135], v[24:27], v[168:171], v[132:135]
  ds_read_b64_tr_b16 v[24:25], v42 offset:40960
  ds_read_b64_tr_b16 v[26:27], v42 offset:43008
  s_waitcnt lgkmcnt(6)
  v_mfma_f32_16x16x32_bf16 v[148:151], v[28:31], v[160:163], v[148:151]
  v_mfma_f32_16x16x32_bf16 v[152:155], v[28:31], v[164:167], v[152:155]
  v_mfma_f32_16x16x32_bf16 v[156:159], v[28:31], v[168:171], v[156:159]
  ds_read_b64_tr_b16 v[28:29], v43 offset:40960
  ds_read_b64_tr_b16 v[30:31], v43 offset:43008
  s_waitcnt lgkmcnt(6)
  v_mfma_f32_16x16x32_bf16 v[124:127], v[32:35], v[184:187], v[124:127]
  v_mfma_f32_16x16x32_bf16 v[128:131], v[32:35], v[188:191], v[128:131]
  v_mfma_f32_16x16x32_bf16 v[132:135], v[32:35], v[192:195], v[132:135]
  ds_read_b64_tr_b16 v[32:33], v42 offset:45056
  ds_read_b64_tr_b16 v[34:35], v42 offset:47104
  s_waitcnt lgkmcnt(6)
  v_mfma_f32_16x16x32_bf16 v[148:151], v[36:39], v[184:187], v[148:151]
  v_mfma_f32_16x16x32_bf16 v[152:155], v[36:39], v[188:191], v[152:155]
  v_mfma_f32_16x16x32_bf16 v[156:159], v[36:39], v[192:195], v[156:159]
  ds_read_b64_tr_b16 v[36:37], v43 offset:45056
  ds_read_b64_tr_b16 v[38:39], v43 offset:47104
  s_waitcnt lgkmcnt(6)
  v_mfma_f32_16x16x32_bf16 v[124:127], v[24:27], v[208:211], v[124:127]
  v_mfma_f32_16x16x32_bf16 v[128:131], v[24:27], v[212:215], v[128:131]
  v_mfma_f32_16x16x32_bf16 v[132:135], v[24:27], v[216:219], v[132:135]
  ds_read_b64_tr_b16 v[24:25], v40 offset:32768
  ds_read_b64_tr_b16 v[26:27], v40 offset:34816
  s_waitcnt lgkmcnt(6)
  v_mfma_f32_16x16x32_bf16 v[148:151], v[28:31], v[208:211], v[148:151]
  v_mfma_f32_16x16x32_bf16 v[152:155], v[28:31], v[212:215], v[152:155]
  v_mfma_f32_16x16x32_bf16 v[156:159], v[28:31], v[216:219], v[156:159]
  ds_read_b64_tr_b16 v[28:29], v41 offset:32768
  ds_read_b64_tr_b16 v[30:31], v41 offset:34816
  s_waitcnt lgkmcnt(6)
  v_mfma_f32_16x16x32_bf16 v[124:127], v[32:35], v[232:235], v[124:127]
  v_mfma_f32_16x16x32_bf16 v[128:131], v[32:35], v[236:239], v[128:131]
  v_mfma_f32_16x16x32_bf16 v[132:135], v[32:35], v[240:243], v[132:135]
  ds_read_b64_tr_b16 v[32:33], v40 offset:36864
  ds_read_b64_tr_b16 v[34:35], v40 offset:38912
  s_waitcnt lgkmcnt(6)
  v_mfma_f32_16x16x32_bf16 v[148:151], v[36:39], v[232:235], v[148:151]
  v_mfma_f32_16x16x32_bf16 v[152:155], v[36:39], v[236:239], v[152:155]
  v_mfma_f32_16x16x32_bf16 v[156:159], v[36:39], v[240:243], v[156:159]
  ds_read_b64_tr_b16 v[36:37], v41 offset:36864
  ds_read_b64_tr_b16 v[38:39], v41 offset:38912
  s_waitcnt lgkmcnt(6)
  v_mfma_f32_16x16x32_bf16 v[76:79], v[24:27], v[160:163], v[76:79]
  v_mfma_f32_16x16x32_bf16 v[80:83], v[24:27], v[164:167], v[80:83]
  v_mfma_f32_16x16x32_bf16 v[84:87], v[24:27], v[168:171], v[84:87]
  ds_write_b128 v52, v[124:127] offset:0
  ds_write_b128 v52, v[128:131] offset:1024
  ds_write_b128 v52, v[132:135] offset:2048
  ds_read_b64_tr_b16 v[24:25], v40 offset:40960
  ds_read_b64_tr_b16 v[26:27], v40 offset:43008
  s_waitcnt lgkmcnt(9)
  v_mfma_f32_16x16x32_bf16 v[100:103], v[28:31], v[160:163], v[100:103]
  v_mfma_f32_16x16x32_bf16 v[104:107], v[28:31], v[164:167], v[104:107]
  v_mfma_f32_16x16x32_bf16 v[108:111], v[28:31], v[168:171], v[108:111]
  ds_write_b128 v52, v[148:151] offset:3072
  ds_write_b128 v52, v[152:155] offset:4096
  ds_write_b128 v52, v[156:159] offset:5120
  v_mov_b32 v57, 3
  ds_write_b32 v55, v57
  ds_read_b64_tr_b16 v[28:29], v41 offset:40960
  ds_read_b64_tr_b16 v[30:31], v41 offset:43008
  s_waitcnt lgkmcnt(13)
  v_mfma_f32_16x16x32_bf16 v[76:79], v[32:35], v[184:187], v[76:79]
  v_mfma_f32_16x16x32_bf16 v[80:83], v[32:35], v[188:191], v[80:83]
  v_mfma_f32_16x16x32_bf16 v[84:87], v[32:35], v[192:195], v[84:87]
  ds_read_b64_tr_b16 v[32:33], v40 offset:45056
  ds_read_b64_tr_b16 v[34:35], v40 offset:47104
  s_waitcnt lgkmcnt(13)
  v_mfma_f32_16x16x32_bf16 v[100:103], v[36:39], v[184:187], v[100:103]
  v_mfma_f32_16x16x32_bf16 v[104:107], v[36:39], v[188:191], v[104:107]
  v_mfma_f32_16x16x32_bf16 v[108:111], v[36:39], v[192:195], v[108:111]
  ds_read_b64_tr_b16 v[36:37], v41 offset:45056
  ds_read_b64_tr_b16 v[38:39], v41 offset:47104
  s_waitcnt lgkmcnt(10)
  v_mfma_f32_16x16x32_bf16 v[76:79], v[24:27], v[208:211], v[76:79]
  v_mfma_f32_16x16x32_bf16 v[80:83], v[24:27], v[212:215], v[80:83]
  v_mfma_f32_16x16x32_bf16 v[84:87], v[24:27], v[216:219], v[84:87]
  s_waitcnt lgkmcnt(4)
  v_mfma_f32_16x16x32_bf16 v[100:103], v[28:31], v[208:211], v[100:103]
  v_mfma_f32_16x16x32_bf16 v[104:107], v[28:31], v[212:215], v[104:107]
  v_mfma_f32_16x16x32_bf16 v[108:111], v[28:31], v[216:219], v[108:111]
  s_waitcnt lgkmcnt(2)
  v_mfma_f32_16x16x32_bf16 v[76:79], v[32:35], v[232:235], v[76:79]
  v_mfma_f32_16x16x32_bf16 v[80:83], v[32:35], v[236:239], v[80:83]
  v_mfma_f32_16x16x32_bf16 v[84:87], v[32:35], v[240:243], v[84:87]
  s_waitcnt lgkmcnt(0)
  v_mfma_f32_16x16x32_bf16 v[100:103], v[36:39], v[232:235], v[100:103]
  v_mfma_f32_16x16x32_bf16 v[104:107], v[36:39], v[236:239], v[104:107]
  v_mfma_f32_16x16x32_bf16 v[108:111], v[36:39], v[240:243], v[108:111]
  s_setprio 0
  s_waitcnt lgkmcnt(0)
L_ps2:
  ds_read_b32 v57, v56
  s_waitcnt lgkmcnt(0)
  v_readfirstlane_b32 s66, v57
  s_nop 1
  s_cmp_lt_u32 s66, 3
  s_cbranch_scc1 L_ps2
  ds_read_b128 v[172:175], v53 offset:0
  ds_read_b128 v[196:199], v53 offset:3072
  ds_read_b128 v[176:179], v53 offset:1024
  ds_read_b128 v[200:203], v53 offset:4096
  ds_read_b128 v[180:183], v53 offset:2048
  ds_read_b128 v[204:207], v53 offset:5120
  v_mul_f32 v76, v6, v76
  v_mul_f32 v77, v6, v77
  v_mul_f32 v78, v6, v78
  v_mul_f32 v79, v6, v79
  v_mul_f32 v100, v6, v100
  v_mul_f32 v101, v6, v101
  v_mul_f32 v102, v6, v102
  v_mul_f32 v103, v6, v103
  v_mul_f32 v80, v8, v80
  v_mul_f32 v81, v8, v81
  v_mul_f32 v82, v8, v82
  v_mul_f32 v83, v8, v83
  v_mul_f32 v104, v8, v104
  v_mul_f32 v105, v8, v105
  v_mul_f32 v106, v8, v106
  v_mul_f32 v107, v8, v107
  v_mul_f32 v84, v10, v84
  v_mul_f32 v85, v10, v85
  v_mul_f32 v86, v10, v86
  v_mul_f32 v87, v10, v87
  v_mul_f32 v108, v10, v108
  v_mul_f32 v109, v10, v109
  v_mul_f32 v110, v10, v110
  v_mul_f32 v111, v10, v111
  s_waitcnt lgkmcnt(4)
  v_fma_f32 v76, v172, v12, v76
  v_fma_f32 v77, v173, v12, v77
  v_fma_f32 v78, v174, v12, v78
  v_fma_f32 v79, v175, v12, v79
  v_fma_f32 v100, v196, v12, v100
  v_fma_f32 v101, v197, v12, v101
  v_fma_f32 v102, v198, v12, v102
  v_fma_f32 v103, v199, v12, v103
  v_cvt_pk_bf16_f32 v172, v76, v77
  v_cvt_pk_bf16_f32 v173, v78, v79
  v_cvt_pk_bf16_f32 v174, v100, v101
  v_cvt_pk_bf16_f32 v175, v102, v103
  ds_write_b128 v54, v[172:175] offset:0
  s_waitcnt lgkmcnt(3)
  v_fma_f32 v80, v176, v14, v80
  v_fma_f32 v81, v177, v14, v81
  v_fma_f32 v82, v178, v14, v82
  v_fma_f32 v83, v179, v14, v83
  v_fma_f32 v104, v200, v14, v104
  v_fma_f32 v105, v201, v14, v105
  v_fma_f32 v106, v202, v14, v106
  v_fma_f32 v107, v203, v14, v107
  v_cvt_pk_bf16_f32 v176, v80, v81
  v_cvt_pk_bf16_f32 v177, v82, v83
  v_cvt_pk_bf16_f32 v178, v104, v105
  v_cvt_pk_bf16_f32 v179, v106, v107
  ds_write_b128 v54, v[176:179] offset:2048
  s_waitcnt lgkmcnt(2)
  v_fma_f32 v84, v180, v16, v84
  v_fma_f32 v85, v181, v16, v85
  v_fma_f32 v86, v182, v16, v86
  v_fma_f32 v87, v183, v16, v87
  v_fma_f32 v108, v204, v16, v108
  v_fma_f32 v109, v205, v16, v109
  v_fma_f32 v110, v206, v16, v110
  v_fma_f32 v111, v207, v16, v111
  v_cvt_pk_bf16_f32 v180, v84, v85
  v_cvt_pk_bf16_f32 v181, v86, v87
  v_cvt_pk_bf16_f32 v182, v108, v109
  v_cvt_pk_bf16_f32 v183, v110, v111
  ds_write_b128 v54, v[180:183] offset:4096
  s_waitcnt lgkmcnt(0)
  s_barrier
  ds_read_b64_tr_b16 v[24:25], v40 offset:0
  ds_read_b64_tr_b16 v[26:27], v40 offset:2048
  ds_read_b64_tr_b16 v[28:29], v41 offset:0
  ds_read_b64_tr_b16 v[30:31], v41 offset:2048
  ds_read_b64_tr_b16 v[32:33], v42 offset:0
  ds_read_b64_tr_b16 v[34:35], v42 offset:2048
  ds_read_b64_tr_b16 v[36:37], v43 offset:0
  ds_read_b64_tr_b16 v[38:39], v43 offset:2048
  s_waitcnt lgkmcnt(6)
  v_mfma_f32_16x16x32_bf16 v[76:79], v[24:27], v[64:67], 0
  v_mfma_f32_16x16x32_bf16 v[80:83], v[24:27], v[68:71], 0
  v_mfma_f32_16x16x32_bf16 v[84:87], v[24:27], v[72:75], 0
  ds_read_b64_tr_b16 v[24:25], v40 offset:4096
  ds_read_b64_tr_b16 v[26:27], v40 offset:6144
  s_waitcnt lgkmcnt(6)
  v_mfma_f32_16x16x32_bf16 v[100:103], v[28:31], v[64:67], 0
  v_mfma_f32_16x16x32_bf16 v[104:107], v[28:31], v[68:71], 0
  v_mfma_f32_16x16x32_bf16 v[108:111], v[28:31], v[72:75], 0
  ds_read_b64_tr_b16 v[28:29], v41 offset:4096
  ds_read_b64_tr_b16 v[30:31], v41 offset:6144
  s_waitcnt lgkmcnt(6)
  v_mfma_f32_16x16x32_bf16 v[124:127], v[32:35], v[64:67], 0
  v_mfma_f32_16x16x32_bf16 v[128:131], v[32:35], v[68:71], 0
  v_mfma_f32_16x16x32_bf16 v[132:135], v[32:35], v[72:75], 0
  ds_read_b64_tr_b16 v[32:33], v42 offset:4096
  ds_read_b64_tr_b16 v[34:35], v42 offset:6144
  s_waitcnt lgkmcnt(6)
  v_mfma_f32_16x16x32_bf16 v[148:151], v[36:39], v[64:67], 0
  v_mfma_f32_16x16x32_bf16 v[152:155], v[36:39], v[68:71], 0
  v_mfma_f32_16x16x32_bf16 v[156:159], v[36:39], v[72:75], 0
  ds_read_b64_tr_b16 v[36:37], v43 offset:4096
  ds_read_b64_tr_b16 v[38:39], v43 offset:6144
  s_waitcnt lgkmcnt(6)
  v_mfma_f32_16x16x32_bf16 v[76:79], v[24:27], v[88:91], v[76:79]
  v_mfma_f32_16x16x32_bf16 v[80:83], v[24:27], v[92:95], v[80:83]
  v_mfma_f32_16x16x32_bf16 v[84:87], v[24:27], v[96:99], v[84:87]
  ds_read_b64_tr_b16 v[24:25], v40 offset:8192
  ds_read_b64_tr_b16 v[26:27], v40 offset:10240
  s_waitcnt lgkmcnt(6)
  v_mfma_f32_16x16x32_bf16 v[100:103], v[28:31], v[88:91], v[100:103]
  v_mfma_f32_16x16x32_bf16 v[104:107], v[28:31], v[92:95], v[104:107]
  v_mfma_f32_16x16x32_bf16 v[108:111], v[28:31], v[96:99], v[108:111]
  ds_read_b64_tr_b16 v[28:29], v41 offset:8192
  ds_read_b64_tr_b16 v[30:31], v41 offset:10240
  s_waitcnt lgkmcnt(6)
  v_mfma_f32_16x16x32_bf16 v[124:127], v[32:35], v[88:91], v[124:127]
  v_mfma_f32_16x16x32_bf16 v[128:131], v[32:35], v[92:95], v[128:131]
  v_mfma_f32_16x16x32_bf16 v[132:135], v[32:35], v[96:99], v[132:135]
  ds_read_b64_tr_b16 v[32:33], v42 offset:8192
  ds_read_b64_tr_b16 v[34:35], v42 offset:10240
  s_waitcnt lgkmcnt(6)
  v_mfma_f32_16x16x32_bf16 v[148:151], v[36:39], v[88:91], v[148:151]
  v_mfma_f32_16x16x32_bf16 v[152:155], v[36:39], v[92:95], v[152:155]
  v_mfma_f32_16x16x32_bf16 v[156:159], v[36:39], v[96:99], v[156:159]
  ds_read_b64_tr_b16 v[36:37], v43 offset:8192
  ds_read_b64_tr_b16 v[38:39], v43 offset:10240
  s_waitcnt lgkmcnt(6)
  v_mfma_f32_16x16x32_bf16 v[76:79], v[24:27], v[112:115], v[76:79]
  v_mfma_f32_16x16x32_bf16 v[80:83], v[24:27], v[116:119], v[80:83]
  v_mfma_f32_16x16x32_bf16 v[84:87], v[24:27], v[120:123], v[84:87]
  ds_read_b64_tr_b16 v[24:25], v40 offset:12288
  ds_read_b64_tr_b16 v[26:27], v40 offset:14336
  s_waitcnt lgkmcnt(6)
  v_mfma_f32_16x16x32_bf16 v[100:103], v[28:31], v[112:115], v[100:103]
  v_mfma_f32_16x16x32_bf16 v[104:107], v[28:31], v[116:119], v[104:107]
  v_mfma_f32_16x16x32_bf16 v[108:111], v[28:31], v[120:123], v[108:111]
  ds_read_b64_tr_b16 v[28:29], v41 offset:12288
  ds_read_b64_tr_b16 v[30:31], v41 offset:14336
  s_waitcnt lgkmcnt(6)
  v_mfma_f32_16x16x32_bf16 v[124:127], v[32:35], v[112:115], v[124:127]
  v_mfma_f32_16x16x32_bf16 v[128:131], v[32:35], v[116:119], v[128:131]
  v_mfma_f32_16x16x32_bf16 v[132:135], v[32:35], v[120:123], v[132:135]
  ds_read_b64_tr_b16 v[32:33], v42 offset:12288
  ds_read_b64_tr_b16 v[34:35], v42 offset:14336
  s_waitcnt lgkmcnt(6)
  v_mfma_f32_16x16x32_bf16 v[148:151], v[36:39], v[112:115], v[148:151]
  v_mfma_f32_16x16x32_bf16 v[152:155], v[36:39], v[116:119], v[152:155]
  v_mfma_f32_16x16x32_bf16 v[156:159], v[36:39], v[120:123], v[156:159]
  ds_read_b64_tr_b16 v[36:37], v43 offset:12288
  ds_read_b64_tr_b16 v[38:39], v43 offset:14336
  s_waitcnt lgkmcnt(6)
  v_mfma_f32_16x16x32_bf16 v[76:79], v[24:27], v[136:139], v[76:79]
  v_mfma_f32_16x16x32_bf16 v[80:83], v[24:27], v[140:143], v[80:83]
  v_mfma_f32_16x16x32_bf16 v[84:87], v[24:27], v[144:147], v[84:87]
  s_waitcnt lgkmcnt(4)
  v_mfma_f32_16x16x32_bf16 v[100:103], v[28:31], v[136:139], v[100:103]
  v_mfma_f32_16x16x32_bf16 v[104:107], v[28:31], v[140:143], v[104:107]
  v_mfma_f32_16x16x32_bf16 v[108:111], v[28:31], v[144:147], v[108:111]
  s_waitcnt lgkmcnt(2)
  v_mfma_f32_16x16x32_bf16 v[124:127], v[32:35], v[136:139], v[124:127]
  v_mfma_f32_16x16x32_bf16 v[128:131], v[32:35], v[140:143], v[128:131]
  v_mfma_f32_16x16x32_bf16 v[132:135], v[32:35], v[144:147], v[132:135]
  s_waitcnt lgkmcnt(0)
  v_mfma_f32_16x16x32_bf16 v[148:151], v[36:39], v[136:139], v[148:151]
  v_mfma_f32_16x16x32_bf16 v[152:155], v[36:39], v[140:143], v[152:155]
  v_mfma_f32_16x16x32_bf16 v[156:159], v[36:39], v[144:147], v[156:159]
  v_mul_f32 v76, v0, v76
  v_mul_f32 v77, v0, v77
  v_mul_f32 v78, v0, v78
  v_mul_f32 v79, v0, v79
  v_mul_f32 v80, v2, v80
  v_mul_f32 v81, v2, v81
  v_mul_f32 v82, v2, v82
  v_mul_f32 v83, v2, v83
  v_mul_f32 v84, v4, v84
  v_mul_f32 v85, v4, v85
  v_mul_f32 v86, v4, v86
  v_mul_f32 v87, v4, v87
  v_mul_f32 v100, v0, v100
  v_mul_f32 v101, v0, v101
  v_mul_f32 v102, v0, v102
  v_mul_f32 v103, v0, v103
  v_mul_f32 v104, v2, v104
  v_mul_f32 v105, v2, v105
  v_mul_f32 v106, v2, v106
  v_mul_f32 v107, v2, v107
  v_mul_f32 v108, v4, v108
  v_mul_f32 v109, v4, v109
  v_mul_f32 v110, v4, v110
  v_mul_f32 v111, v4, v111
  v_mul_f32 v124, v0, v124
  v_mul_f32 v125, v0, v125
  v_mul_f32 v126, v0, v126
  v_mul_f32 v127, v0, v127
  v_mul_f32 v128, v2, v128
  v_mul_f32 v129, v2, v129
  v_mul_f32 v130, v2, v130
  v_mul_f32 v131, v2, v131
  v_mul_f32 v132, v4, v132
  v_mul_f32 v133, v4, v133
  v_mul_f32 v134, v4, v134
  v_mul_f32 v135, v4, v135
  v_mul_f32 v148, v0, v148
  v_mul_f32 v149, v0, v149
  v_mul_f32 v150, v0, v150
  v_mul_f32 v151, v0, v151
  v_mul_f32 v152, v2, v152
  v_mul_f32 v153, v2, v153
  v_mul_f32 v154, v2, v154
  v_mul_f32 v155, v2, v155
  v_mul_f32 v156, v4, v156
  v_mul_f32 v157, v4, v157
  v_mul_f32 v158, v4, v158
  v_mul_f32 v159, v4, v159
  s_waitcnt lgkmcnt(0)
  s_barrier
  s_setprio 2
  ds_read_b64_tr_b16 v[24:25], v42 offset:32768
  ds_read_b64_tr_b16 v[26:27], v42 offset:34816
  ds_read_b64_tr_b16 v[28:29], v43 offset:32768
  ds_read_b64_tr_b16 v[30:31], v43 offset:34816
  ds_read_b64_tr_b16 v[32:33], v42 offset:36864
  ds_read_b64_tr_b16 v[34:35], v42 offset:38912
  ds_read_b64_tr_b16 v[36:37], v43 offset:36864
  ds_read_b64_tr_b16 v[38:39], v43 offset:38912
  s_waitcnt lgkmcnt(6)
  v_mfma_f32_16x16x32_bf16 v[124:127], v[24:27], v[160:163], v[124:127]
  v_mfma_f32_16x16x32_bf16 v[128:131], v[24:27], v[164:167], v[128:131]
  v_mfma_f32_16x16x32_bf16 v[132:135], v[24:27], v[168:171], v[132:135]
  ds_read_b64_tr_b16 v[24:25], v42 offset:40960
  ds_read_b64_tr_b16 v[26:27], v42 offset:43008
  s_waitcnt lgkmcnt(6)
  v_mfma_f32_16x16x32_bf16 v[148:151], v[28:31], v[160:163], v[148:151]
  v_mfma_f32_16x16x32_bf16 v[152:155], v[28:31], v[164:167], v[152:155]
  v_mfma_f32_16x16x32_bf16 v[156:159], v[28:31], v[168:171], v[156:159]
  ds_read_b64_tr_b16 v[28:29], v43 offset:40960
  ds_read_b64_tr_b16 v[30:31], v43 offset:43008
  s_waitcnt lgkmcnt(6)
  v_mfma_f32_16x16x32_bf16 v[124:127], v[32:35], v[184:187], v[124:127]
  v_mfma_f32_16x16x32_bf16 v[128:131], v[32:35], v[188:191], v[128:131]
  v_mfma_f32_16x16x32_bf16 v[132:135], v[32:35], v[192:195], v[132:135]
  ds_read_b64_tr_b16 v[32:33], v42 offset:45056
  ds_read_b64_tr_b16 v[34:35], v42 offset:47104
  s_waitcnt lgkmcnt(6)
  v_mfma_f32_16x16x32_bf16 v[148:151], v[36:39], v[184:187], v[148:151]
  v_mfma_f32_16x16x32_bf16 v[152:155], v[36:39], v[188:191], v[152:155]
  v_mfma_f32_16x16x32_bf16 v[156:159], v[36:39], v[192:195], v[156:159]
  ds_read_b64_tr_b16 v[36:37], v43 offset:45056
  ds_read_b64_tr_b16 v[38:39], v43 offset:47104
  s_waitcnt lgkmcnt(6)
  v_mfma_f32_16x16x32_bf16 v[124:127], v[24:27], v[208:211], v[124:127]
  v_mfma_f32_16x16x32_bf16 v[128:131], v[24:27], v[212:215], v[128:131]
  v_mfma_f32_16x16x32_bf16 v[132:135], v[24:27], v[216:219], v[132:135]
  ds_read_b64_tr_b16 v[24:25], v40 offset:32768
  ds_read_b64_tr_b16 v[26:27], v40 offset:34816
  s_waitcnt lgkmcnt(6)
  v_mfma_f32_16x16x32_bf16 v[148:151], v[28:31], v[208:211], v[148:151]
  v_mfma_f32_16x16x32_bf16 v[152:155], v[28:31], v[212:215], v[152:155]
  v_mfma_f32_16x16x32_bf16 v[156:159], v[28:31], v[216:219], v[156:159]
  ds_read_b64_tr_b16 v[28:29], v41 offset:32768
  ds_read_b64_tr_b16 v[30:31], v41 offset:34816
  s_waitcnt lgkmcnt(6)
  v_mfma_f32_16x16x32_bf16 v[124:127], v[32:35], v[232:235], v[124:127]
  v_mfma_f32_16x16x32_bf16 v[128:131], v[32:35], v[236:239], v[128:131]
  v_mfma_f32_16x16x32_bf16 v[132:135], v[32:35], v[240:243], v[132:135]
  ds_read_b64_tr_b16 v[32:33], v40 offset:36864
  ds_read_b64_tr_b16 v[34:35], v40 offset:38912
  s_waitcnt lgkmcnt(6)
  v_mfma_f32_16x16x32_bf16 v[148:151], v[36:39], v[232:235], v[148:151]
  v_mfma_f32_16x16x32_bf16 v[152:155], v[36:39], v[236:239], v[152:155]
  v_mfma_f32_16x16x32_bf16 v[156:159], v[36:39], v[240:243], v[156:159]
  ds_read_b64_tr_b16 v[36:37], v41 offset:36864
  ds_read_b64_tr_b16 v[38:39], v41 offset:38912
  s_waitcnt lgkmcnt(6)
  v_mfma_f32_16x16x32_bf16 v[76:79], v[24:27], v[160:163], v[76:79]
  v_mfma_f32_16x16x32_bf16 v[80:83], v[24:27], v[164:167], v[80:83]
  v_mfma_f32_16x16x32_bf16 v[84:87], v[24:27], v[168:171], v[84:87]
  ds_write_b128 v52, v[124:127] offset:0
  ds_write_b128 v52, v[128:131] offset:1024
  ds_write_b128 v52, v[132:135] offset:2048
  ds_read_b64_tr_b16 v[24:25], v40 offset:40960
  ds_read_b64_tr_b16 v[26:27], v40 offset:43008
  s_waitcnt lgkmcnt(9)
  v_mfma_f32_16x16x32_bf16 v[100:103], v[28:31], v[160:163], v[100:103]
  v_mfma_f32_16x16x32_bf16 v[104:107], v[28:31], v[164:167], v[104:107]
  v_mfma_f32_16x16x32_bf16 v[108:111], v[28:31], v[168:171], v[108:111]
  ds_write_b128 v52, v[148:151] offset:3072
  ds_write_b128 v52, v[152:155] offset:4096
  ds_write_b128 v52, v[156:159] offset:5120
  v_mov_b32 v57, 4
  ds_write_b32 v55, v57
  ds_read_b64_tr_b16 v[28:29], v41 offset:40960
  ds_read_b64_tr_b16 v[30:31], v41 offset:43008
  s_waitcnt lgkmcnt(13)
  v_mfma_f32_16x16x32_bf16 v[76:79], v[32:35], v[184:187], v[76:79]
  v_mfma_f32_16x16x32_bf16 v[80:83], v[32:35], v[188:191], v[80:83]
  v_mfma_f32_16x16x32_bf16 v[84:87], v[32:35], v[192:195], v[84:87]
  ds_read_b64_tr_b16 v[32:33], v40 offset:45056
  ds_read_b64_tr_b16 v[34:35], v40 offset:47104
  s_waitcnt lgkmcnt(13)
  v_mfma_f32_16x16x32_bf16 v[100:103], v[36:39], v[184:187], v[100:103]
  v_mfma_f32_16x16x32_bf16 v[104:107], v[36:39], v[188:191], v[104:107]
  v_mfma_f32_16x16x32_bf16 v[108:111], v[36:39], v[192:195], v[108:111]
  ds_read_b64_tr_b16 v[36:37], v41 offset:45056
  ds_read_b64_tr_b16 v[38:39], v41 offset:47104
  s_waitcnt lgkmcnt(10)
  v_mfma_f32_16x16x32_bf16 v[76:79], v[24:27], v[208:211], v[76:79]
  v_mfma_f32_16x16x32_bf16 v[80:83], v[24:27], v[212:215], v[80:83]
  v_mfma_f32_16x16x32_bf16 v[84:87], v[24:27], v[216:219], v[84:87]
  s_waitcnt lgkmcnt(4)
  v_mfma_f32_16x16x32_bf16 v[100:103], v[28:31], v[208:211], v[100:103]
  v_mfma_f32_16x16x32_bf16 v[104:107], v[28:31], v[212:215], v[104:107]
  v_mfma_f32_16x16x32_bf16 v[108:111], v[28:31], v[216:219], v[108:111]
  s_waitcnt lgkmcnt(2)
  v_mfma_f32_16x16x32_bf16 v[76:79], v[32:35], v[232:235], v[76:79]
  v_mfma_f32_16x16x32_bf16 v[80:83], v[32:35], v[236:239], v[80:83]
  v_mfma_f32_16x16x32_bf16 v[84:87], v[32:35], v[240:243], v[84:87]
  s_waitcnt lgkmcnt(0)
  v_mfma_f32_16x16x32_bf16 v[100:103], v[36:39], v[232:235], v[100:103]
  v_mfma_f32_16x16x32_bf16 v[104:107], v[36:39], v[236:239], v[104:107]
  v_mfma_f32_16x16x32_bf16 v[108:111], v[36:39], v[240:243], v[108:111]
  s_waitcnt lgkmcnt(0)
L_ps3:
  ds_read_b32 v57, v56
  s_waitcnt lgkmcnt(0)
  v_readfirstlane_b32 s66, v57
  s_nop 1
  s_cmp_lt_u32 s66, 4
  s_cbranch_scc1 L_ps3
  ds_read_b128 v[172:175], v53 offset:0
  ds_read_b128 v[196:199], v53 offset:3072
  ds_read_b128 v[176:179], v53 offset:1024
  ds_read_b128 v[200:203], v53 offset:4096
  ds_read_b128 v[180:183], v53 offset:2048
  ds_read_b128 v[204:207], v53 offset:5120
  v_mul_f32 v76, v6, v76
  v_mul_f32 v77, v6, v77
  v_mul_f32 v78, v6, v78
  v_mul_f32 v79, v6, v79
  v_mul_f32 v100, v6, v100
  v_mul_f32 v101, v6, v101
  v_mul_f32 v102, v6, v102
  v_mul_f32 v103, v6, v103
  v_mul_f32 v80, v8, v80
  v_mul_f32 v81, v8, v81
  v_mul_f32 v82, v8, v82
  v_mul_f32 v83, v8, v83
  v_mul_f32 v104, v8, v104
  v_mul_f32 v105, v8, v105
  v_mul_f32 v106, v8, v106
  v_mul_f32 v107, v8, v107
  v_mul_f32 v84, v10, v84
  v_mul_f32 v85, v10, v85
  v_mul_f32 v86, v10, v86
  v_mul_f32 v87, v10, v87
  v_mul_f32 v108, v10, v108
  v_mul_f32 v109, v10, v109
  v_mul_f32 v110, v10, v110
  v_mul_f32 v111, v10, v111
  s_waitcnt lgkmcnt(4)
  v_fma_f32 v76, v172, v12, v76
  v_fma_f32 v77, v173, v12, v77
  v_fma_f32 v78, v174, v12, v78
  v_fma_f32 v79, v175, v12, v79
  v_fma_f32 v100, v196, v12, v100
  v_fma_f32 v101, v197, v12, v101
  v_fma_f32 v102, v198, v12, v102
  v_fma_f32 v103, v199, v12, v103
  v_cvt_pk_bf16_f32 v172, v76, v77
  v_cvt_pk_bf16_f32 v173, v78, v79
  v_cvt_pk_bf16_f32 v174, v100, v101
  v_cvt_pk_bf16_f32 v175, v102, v103
  ds_write_b128 v54, v[172:175] offset:0
  s_waitcnt lgkmcnt(3)
  v_fma_f32 v80, v176, v14, v80
  v_fma_f32 v81, v177, v14, v81
  v_fma_f32 v82, v178, v14, v82
  v_fma_f32 v83, v179, v14, v83
  v_fma_f32 v104, v200, v14, v104
  v_fma_f32 v105, v201, v14, v105
  v_fma_f32 v106, v202, v14, v106
  v_fma_f32 v107, v203, v14, v107
  v_cvt_pk_bf16_f32 v176, v80, v81
  v_cvt_pk_bf16_f32 v177, v82, v83
  v_cvt_pk_bf16_f32 v178, v104, v105
  v_cvt_pk_bf16_f32 v179, v106, v107
  ds_write_b128 v54, v[176:179] offset:2048
  s_waitcnt lgkmcnt(2)
  v_fma_f32 v84, v180, v16, v84
  v_fma_f32 v85, v181, v16, v85
  v_fma_f32 v86, v182, v16, v86
  v_fma_f32 v87, v183, v16, v87
  v_fma_f32 v108, v204, v16, v108
  v_fma_f32 v109, v205, v16, v109
  v_fma_f32 v110, v206, v16, v110
  v_fma_f32 v111, v207, v16, v111
  v_cvt_pk_bf16_f32 v180, v84, v85
  v_cvt_pk_bf16_f32 v181, v86, v87
  v_cvt_pk_bf16_f32 v182, v108, v109
  v_cvt_pk_bf16_f32 v183, v110, v111
  ds_write_b128 v54, v[180:183] offset:4096
  s_waitcnt lgkmcnt(0)
  s_barrier
  s_waitcnt vmcnt(0)
  s_branch L_tail
L_P:
  s_barrier
  s_lshl_b32 s63, s4, 14
  s_add_u32 s63, s63, 65536
  v_lshrrev_b32 v29, 3, v26
  v_lshlrev_b32 v29, 13, v29
  v_bfe_u32 v30, v26, 1, 2
  v_xor_b32 v30, v30, v28
  v_lshl_add_u32 v29, v30, 5, v29
  v_and_b32 v30, 1, v26
  v_lshl_add_u32 v29, v30, 4, v29
  s_and_b32 s66, s4, 1
  s_lshl_b32 s66, s66, 9
  v_add_u32 v20, s66, v29
  v_lshrrev_b32 v29, 2, v26
  v_lshrrev_b32 v30, 1, v29
  v_and_b32 v30, 3, v30
  v_lshlrev_b32 v31, 7, v29
  v_add_u32 v31, s63, v31
  v_and_b32 v32, 3, v26
  v_lshl_add_u32 v31, v32, 3, v31
  v_xor_b32 v32, 0, v30
  v_lshl_add_u32 v21, v32, 5, v31
  v_xor_b32 v32, 1, v30
  v_lshl_add_u32 v22, v32, 5, v31
  v_xor_b32 v32, 2, v30
  v_lshl_add_u32 v23, v32, 5, v31
  v_xor_b32 v32, 3, v30
  v_lshl_add_u32 v24, v32, 5, v31
  s_and_b32 s66, s4, 1
  s_mul_i32 s66, s66, 6144
  s_lshr_b32 s67, s4, 1
  s_mul_i32 s67, s67, 12288
  s_add_u32 s66, s66, s67
  s_add_u32 s66, s66, 131072
  v_lshlrev_b32 v31, 7, v27
  v_add_u32 v31, s66, v31
  v_and_b32 v32, 1, v28
  v_lshl_add_u32 v31, v32, 3, v31
  v_lshrrev_b32 v32, 1, v28
  v_lshrrev_b32 v29, 1, v27
  v_xor_b32 v32, v32, v29
  v_lshl_add_u32 v25, v32, 4, v31
  v_lshrrev_b32 v29, 1, v27
  v_lshrrev_b32 v30, 1, v28
  v_xor_b32 v30, v30, v29
  s_mov_b32 s66, 896
  v_mul_lo_u32 v31, s66, v27
  v_and_b32 v32, 1, v28
  v_lshl_add_u32 v31, v32, 3, v31
  v_add_u32 v31, 32768, v31
  v_xor_b32 v32, 0, v30
  v_lshl_add_u32 v33, v32, 4, v31
  v_xor_b32 v32, 2, v30
  v_lshl_add_u32 v34, v32, 4, v31
  v_xor_b32 v32, 4, v30
  v_lshl_add_u32 v35, v32, 4, v31
  v_xor_b32 v32, 6, v30
  v_lshl_add_u32 v36, v32, 4, v31
  s_waitcnt vmcnt(0)
  s_barrier
  ds_read_b64 v[40:41], v33 offset:0
  ds_read_b64 v[42:43], v34 offset:0
  ds_read_b64 v[44:45], v33 offset:14336
  ds_read_b64 v[46:47], v34 offset:14336
  ds_read_b64 v[52:53], v35 offset:0
  ds_read_b64 v[54:55], v36 offset:0
  ds_read_b64 v[56:57], v35 offset:14336
  ds_read_b64 v[58:59], v36 offset:14336
  ds_read_b64 v[64:65], v33 offset:128
  ds_read_b64 v[66:67], v34 offset:128
  ds_read_b64 v[68:69], v33 offset:14464
  ds_read_b64 v[70:71], v34 offset:14464
  ds_read_b64 v[76:77], v35 offset:128
  ds_read_b64 v[78:79], v36 offset:128
  ds_read_b64 v[80:81], v35 offset:14464
  s_waitcnt lgkmcnt(14)
  ds_read_b64 v[82:83], v36 offset:14464
  s_waitcnt lgkmcnt(14)
  ds_read_b64 v[88:89], v33 offset:256
  s_waitcnt lgkmcnt(14)
  ds_read_b64 v[90:91], v34 offset:256
  s_waitcnt lgkmcnt(14)
  ds_read_b64 v[92:93], v33 offset:14592
  s_waitcnt lgkmcnt(14)
  ds_read_b64 v[94:95], v34 offset:14592
  s_waitcnt lgkmcnt(14)
  ds_read_b64 v[100:101], v35 offset:256
  s_waitcnt lgkmcnt(14)
  ds_read_b64 v[102:103], v36 offset:256
  s_waitcnt lgkmcnt(14)
  ds_read_b64 v[104:105], v35 offset:14592
  s_waitcnt lgkmcnt(14)
  ds_read_b64 v[106:107], v36 offset:14592
  s_waitcnt lgkmcnt(14)
  ds_read_b64 v[112:113], v33 offset:384
  s_waitcnt lgkmcnt(14)
  ds_read_b64 v[114:115], v34 offset:384
  s_waitcnt lgkmcnt(14)
  ds_read_b64 v[116:117], v33 offset:14720
  s_waitcnt lgkmcnt(14)
  ds_read_b64 v[118:119], v34 offset:14720
  s_waitcnt lgkmcnt(14)
  ds_read_b64 v[124:125], v35 offset:384
  s_waitcnt lgkmcnt(14)
  ds_read_b64 v[126:127], v36 offset:384
  s_waitcnt lgkmcnt(14)
  ds_read_b64 v[128:129], v35 offset:14720
  s_waitcnt lgkmcnt(14)
  ds_read_b64 v[130:131], v36 offset:14720
  s_waitcnt lgkmcnt(14)
  ds_read_b64 v[136:137], v33 offset:512
  s_waitcnt lgkmcnt(14)
  ds_read_b64 v[138:139], v34 offset:512
  s_waitcnt lgkmcnt(14)
  ds_read_b64 v[140:141], v33 offset:14848
  s_waitcnt lgkmcnt(14)
  ds_read_b64 v[142:143], v34 offset:14848
  s_waitcnt lgkmcnt(14)
  ds_read_b64 v[148:149], v35 offset:512
  s_waitcnt lgkmcnt(14)
  ds_read_b64 v[150:151], v36 offset:512
  s_waitcnt lgkmcnt(14)
  ds_read_b64 v[152:153], v35 offset:14848
  s_waitcnt lgkmcnt(14)
  ds_read_b64 v[154:155], v36 offset:14848
  s_waitcnt lgkmcnt(14)
  ds_read_b64 v[160:161], v33 offset:640
  s_waitcnt lgkmcnt(14)
  ds_read_b64 v[162:163], v34 offset:640
  s_waitcnt lgkmcnt(14)
  ds_read_b64 v[164:165], v33 offset:14976
  s_waitcnt lgkmcnt(14)
  ds_read_b64 v[166:167], v34 offset:14976
  s_waitcnt lgkmcnt(14)
  ds_read_b64 v[172:173], v35 offset:640
  s_waitcnt lgkmcnt(14)
  ds_read_b64 v[174:175], v36 offset:640
  s_waitcnt lgkmcnt(14)
  ds_read_b64 v[176:177], v35 offset:14976
  s_waitcnt lgkmcnt(14)
  ds_read_b64 v[178:179], v36 offset:14976
  s_waitcnt lgkmcnt(14)
  ds_read_b64 v[184:185], v33 offset:768
  s_waitcnt lgkmcnt(14)
  ds_read_b64 v[186:187], v34 offset:768
  s_waitcnt lgkmcnt(14)
  ds_read_b64 v[188:189], v33 offset:15104
  s_waitcnt lgkmcnt(14)
  ds_read_b64 v[190:191], v34 offset:15104
  s_waitcnt lgkmcnt(14)
  ds_read_b64 v[196:197], v35 offset:768
  s_waitcnt lgkmcnt(14)
  ds_read_b64 v[198:199], v36 offset:768
  s_waitcnt lgkmcnt(14)
  ds_read_b64 v[200:201], v35 offset:15104
  s_waitcnt lgkmcnt(14)
  ds_read_b64 v[202:203], v36 offset:15104
  s_waitcnt lgkmcnt(0)
  v_add_u32 v33, 98304, v33
  v_add_u32 v34, 98304, v34
  v_add_u32 v35, 98304, v35
  v_add_u32 v36, 98304, v36
  ds_read_b64 v[48:49], v33 offset:0
  ds_read_b64 v[50:51], v34 offset:0
  ds_read_b64 v[60:61], v35 offset:0
  ds_read_b64 v[62:63], v36 offset:0
  ds_read_b64 v[72:73], v33 offset:128
  ds_read_b64 v[74:75], v34 offset:128
  ds_read_b64 v[84:85], v35 offset:128
  ds_read_b64 v[86:87], v36 offset:128
  ds_read_b64 v[96:97], v33 offset:256
  ds_read_b64 v[98:99], v34 offset:256
  ds_read_b64 v[108:109], v35 offset:256
  ds_read_b64 v[110:111], v36 offset:256
  ds_read_b64 v[120:121], v33 offset:384
  ds_read_b64 v[122:123], v34 offset:384
  ds_read_b64 v[132:133], v35 offset:384
  s_waitcnt lgkmcnt(14)
  ds_read_b64 v[134:135], v36 offset:384
  s_waitcnt lgkmcnt(14)
  ds_read_b64 v[144:145], v33 offset:512
  s_waitcnt lgkmcnt(14)
  ds_read_b64 v[146:147], v34 offset:512
  s_waitcnt lgkmcnt(14)
  ds_read_b64 v[156:157], v35 offset:512
  s_waitcnt lgkmcnt(14)
  ds_read_b64 v[158:159], v36 offset:512
  s_waitcnt lgkmcnt(14)
  ds_read_b64 v[168:169], v33 offset:640
  s_waitcnt lgkmcnt(14)
  ds_read_b64 v[170:171], v34 offset:640
  s_waitcnt lgkmcnt(14)
  ds_read_b64 v[180:181], v35 offset:640
  s_waitcnt lgkmcnt(14)
  ds_read_b64 v[182:183], v36 offset:640
  s_waitcnt lgkmcnt(14)
  ds_read_b64 v[192:193], v33 offset:768
  s_waitcnt lgkmcnt(14)
  ds_read_b64 v[194:195], v34 offset:768
  s_waitcnt lgkmcnt(14)
  ds_read_b64 v[204:205], v35 offset:768
  s_waitcnt lgkmcnt(14)
  ds_read_b64 v[206:207], v36 offset:768
  s_waitcnt lgkmcnt(0)
  s_lshl_b32 s47, s4, 12
  s_add_u32 s47, s47, 131072
  s_sub_u32 s66, s47, s63
  v_add_u32 v35, s66, v21
  v_add_u32 v36, s66, v22
  v_add_u32 v37, s66, v23
  v_add_u32 v38, s66, v24
  s_barrier
  s_add_u32 m0, s47, 0
  s_add_u32 s67, s44, 1048576
  buffer_load_dwordx4 v20, s[16:19], s67 offen  lds
  s_add_u32 m0, s47, 1024
  s_add_u32 s67, s44, 1114112
  buffer_load_dwordx4 v20, s[16:19], s67 offen  lds
  s_add_u32 m0, s47, 2048
  s_add_u32 s67, s44, 1179648
  buffer_load_dwordx4 v20, s[16:19], s67 offen  lds
  s_add_u32 m0, s47, 3072
  s_add_u32 s67, s44, 1245184
  buffer_load_dwordx4 v20, s[16:19], s67 offen  lds
  ds_read_b64_tr_b16 v[0:1], v21 offset:0
  ds_read_b64_tr_b16 v[2:3], v21 offset:2048
  ds_read_b64_tr_b16 v[4:5], v22 offset:0
  ds_read_b64_tr_b16 v[6:7], v22 offset:2048
  ds_read_b64_tr_b16 v[8:9], v23 offset:0
  ds_read_b64_tr_b16 v[10:11], v23 offset:2048
  ds_read_b64_tr_b16 v[12:13], v24 offset:0
  ds_read_b64_tr_b16 v[14:15], v24 offset:2048
  ds_read_b64_tr_b16 v[16:17], v21 offset:4096
  ds_read_b64_tr_b16 v[18:19], v21 offset:6144
  s_waitcnt lgkmcnt(8)
  v_mfma_f32_16x16x32_bf16 v[208:211], v[0:3], v[40:43], 0
  v_mfma_f32_16x16x32_bf16 v[212:215], v[0:3], v[44:47], 0
  v_mfma_f32_16x16x32_bf16 v[216:219], v[0:3], v[48:51], 0
  ds_read_b64_tr_b16 v[0:1], v22 offset:4096
  ds_read_b64_tr_b16 v[2:3], v22 offset:6144
  s_waitcnt lgkmcnt(8)
  v_mfma_f32_16x16x32_bf16 v[220:223], v[4:7], v[40:43], 0
  v_mfma_f32_16x16x32_bf16 v[224:227], v[4:7], v[44:47], 0
  v_mfma_f32_16x16x32_bf16 v[228:231], v[4:7], v[48:51], 0
  ds_read_b64_tr_b16 v[4:5], v23 offset:4096
  ds_read_b64_tr_b16 v[6:7], v23 offset:6144
  s_waitcnt lgkmcnt(8)
  v_mfma_f32_16x16x32_bf16 v[232:235], v[8:11], v[40:43], 0
  v_mfma_f32_16x16x32_bf16 v[236:239], v[8:11], v[44:47], 0
  v_mfma_f32_16x16x32_bf16 v[240:243], v[8:11], v[48:51], 0
  ds_read_b64_tr_b16 v[8:9], v24 offset:4096
  ds_read_b64_tr_b16 v[10:11], v24 offset:6144
  s_waitcnt lgkmcnt(8)
  v_mfma_f32_16x16x32_bf16 v[244:247], v[12:15], v[40:43], 0
  v_mfma_f32_16x16x32_bf16 v[248:251], v[12:15], v[44:47], 0
  v_mfma_f32_16x16x32_bf16 v[252:255], v[12:15], v[48:51], 0
  ds_read_b64_tr_b16 v[12:13], v21 offset:8192
  ds_read_b64_tr_b16 v[14:15], v21 offset:10240
  s_add_u32 m0, s63, 0
  s_add_u32 s67, s44, 1310720
  buffer_load_dwordx4 v20, s[16:19], s67 offen  lds
  s_waitcnt lgkmcnt(8)
  v_mfma_f32_16x16x32_bf16 v[208:211], v[16:19], v[52:55], v[208:211]
  v_mfma_f32_16x16x32_bf16 v[212:215], v[16:19], v[56:59], v[212:215]
  v_mfma_f32_16x16x32_bf16 v[216:219], v[16:19], v[60:63], v[216:219]
  ds_read_b64_tr_b16 v[16:17], v22 offset:8192
  ds_read_b64_tr_b16 v[18:19], v22 offset:10240
  s_add_u32 m0, s63, 1024
  s_add_u32 s67, s44, 1376256
  buffer_load_dwordx4 v20, s[16:19], s67 offen  lds
  s_waitcnt lgkmcnt(8)
  v_mfma_f32_16x16x32_bf16 v[220:223], v[0:3], v[52:55], v[220:223]
  v_mfma_f32_16x16x32_bf16 v[224:227], v[0:3], v[56:59], v[224:227]
  v_mfma_f32_16x16x32_bf16 v[228:231], v[0:3], v[60:63], v[228:231]
  ds_read_b64_tr_b16 v[0:1], v23 offset:8192
  ds_read_b64_tr_b16 v[2:3], v23 offset:10240
  s_add_u32 m0, s63, 2048
  s_add_u32 s67, s44, 1441792
  buffer_load_dwordx4 v20, s[16:19], s67 offen  lds
  s_waitcnt lgkmcnt(8)
  v_mfma_f32_16x16x32_bf16 v[232:235], v[4:7], v[52:55], v[232:235]
  v_mfma_f32_16x16x32_bf16 v[236:239], v[4:7], v[56:59], v[236:239]
  v_mfma_f32_16x16x32_bf16 v[240:243], v[4:7], v[60:63], v[240:243]
  ds_read_b64_tr_b16 v[4:5], v24 offset:8192
  ds_read_b64_tr_b16 v[6:7], v24 offset:10240
  s_add_u32 m0, s63, 3072
  s_add_u32 s67, s44, 1507328
  buffer_load_dwordx4 v20, s[16:19], s67 offen  lds
  s_waitcnt lgkmcnt(8)
  v_mfma_f32_16x16x32_bf16 v[244:247], v[8:11], v[52:55], v[244:247]
  v_mfma_f32_16x16x32_bf16 v[248:251], v[8:11], v[56:59], v[248:251]
  v_mfma_f32_16x16x32_bf16 v[252:255], v[8:11], v[60:63], v[252:255]
  ds_read_b64_tr_b16 v[8:9], v21 offset:12288
  ds_read_b64_tr_b16 v[10:11], v21 offset:14336
  s_add_u32 m0, s63, 4096
  s_add_u32 s67, s44, 1572864
  buffer_load_dwordx4 v20, s[16:19], s67 offen  lds
  s_waitcnt lgkmcnt(8)
  v_mfma_f32_16x16x32_bf16 v[208:211], v[12:15], v[64:67], v[208:211]
  v_mfma_f32_16x16x32_bf16 v[212:215], v[12:15], v[68:71], v[212:215]
  v_mfma_f32_16x16x32_bf16 v[216:219], v[12:15], v[72:75], v[216:219]
  ds_read_b64_tr_b16 v[12:13], v22 offset:12288
  ds_read_b64_tr_b16 v[14:15], v22 offset:14336
  s_add_u32 m0, s63, 5120
  s_add_u32 s67, s44, 1638400
  buffer_load_dwordx4 v20, s[16:19], s67 offen  lds
  s_waitcnt lgkmcnt(8)
  v_mfma_f32_16x16x32_bf16 v[220:223], v[16:19], v[64:67], v[220:223]
  v_mfma_f32_16x16x32_bf16 v[224:227], v[16:19], v[68:71], v[224:227]
  v_mfma_f32_16x16x32_bf16 v[228:231], v[16:19], v[72:75], v[228:231]
  ds_read_b64_tr_b16 v[16:17], v23 offset:12288
  ds_read_b64_tr_b16 v[18:19], v23 offset:14336
  s_add_u32 m0, s63, 6144
  s_add_u32 s67, s44, 1703936
  buffer_load_dwordx4 v20, s[16:19], s67 offen  lds
  s_waitcnt lgkmcnt(8)
  v_mfma_f32_16x16x32_bf16 v[232:235], v[0:3], v[64:67], v[232:235]
  v_mfma_f32_16x16x32_bf16 v[236:239], v[0:3], v[68:71], v[236:239]
  v_mfma_f32_16x16x32_bf16 v[240:243], v[0:3], v[72:75], v[240:243]
  ds_read_b64_tr_b16 v[0:1], v24 offset:12288
  ds_read_b64_tr_b16 v[2:3], v24 offset:14336
  s_add_u32 m0, s63, 7168
  s_add_u32 s67, s44, 1769472
  buffer_load_dwordx4 v20, s[16:19], s67 offen  lds
  s_waitcnt lgkmcnt(8)
  v_mfma_f32_16x16x32_bf16 v[244:247], v[4:7], v[64:67], v[244:247]
  v_mfma_f32_16x16x32_bf16 v[248:251], v[4:7], v[68:71], v[248:251]
  v_mfma_f32_16x16x32_bf16 v[252:255], v[4:7], v[72:75], v[252:255]
  s_waitcnt vmcnt(8)
  ds_read_b64_tr_b16 v[4:5], v35 offset:0
  ds_read_b64_tr_b16 v[6:7], v35 offset:2048
  s_add_u32 m0, s63, 8192
  s_add_u32 s67, s44, 1835008
  buffer_load_dwordx4 v20, s[16:19], s67 offen  lds
  s_waitcnt lgkmcnt(8)
  v_mfma_f32_16x16x32_bf16 v[208:211], v[8:11], v[76:79], v[208:211]
  v_mfma_f32_16x16x32_bf16 v[212:215], v[8:11], v[80:83], v[212:215]
  v_mfma_f32_16x16x32_bf16 v[216:219], v[8:11], v[84:87], v[216:219]
  ds_read_b64_tr_b16 v[8:9], v36 offset:0
  ds_read_b64_tr_b16 v[10:11], v36 offset:2048
  s_add_u32 m0, s63, 9216
  s_add_u32 s67, s44, 1900544
  buffer_load_dwordx4 v20, s[16:19], s67 offen  lds
  s_waitcnt lgkmcnt(8)
  v_mfma_f32_16x16x32_bf16 v[220:223], v[12:15], v[76:79], v[220:223]
  v_mfma_f32_16x16x32_bf16 v[224:227], v[12:15], v[80:83], v[224:227]
  v_mfma_f32_16x16x32_bf16 v[228:231], v[12:15], v[84:87], v[228:231]
  ds_read_b64_tr_b16 v[12:13], v37 offset:0
  ds_read_b64_tr_b16 v[14:15], v37 offset:2048
  s_add_u32 m0, s63, 10240
  s_add_u32 s67, s44, 1966080
  buffer_load_dwordx4 v20, s[16:19], s67 offen  lds
  s_waitcnt lgkmcnt(8)
  v_mfma_f32_16x16x32_bf16 v[232:235], v[16:19], v[76:79], v[232:235]
  v_mfma_f32_16x16x32_bf16 v[236:239], v[16:19], v[80:83], v[236:239]
  v_mfma_f32_16x16x32_bf16 v[240:243], v[16:19], v[84:87], v[240:243]
  ds_read_b64_tr_b16 v[16:17], v38 offset:0
  ds_read_b64_tr_b16 v[18:19], v38 offset:2048
  s_add_u32 m0, s63, 11264
  s_add_u32 s67, s44, 2031616
  buffer_load_dwordx4 v20, s[16:19], s67 offen  lds
  s_waitcnt lgkmcnt(8)
  v_mfma_f32_16x16x32_bf16 v[244:247], v[0:3], v[76:79], v[244:247]
  v_mfma_f32_16x16x32_bf16 v[248:251], v[0:3], v[80:83], v[248:251]
  v_mfma_f32_16x16x32_bf16 v[252:255], v[0:3], v[84:87], v[252:255]
  s_waitcnt vmcnt(8)
  ds_read_b64_tr_b16 v[0:1], v21 offset:0
  ds_read_b64_tr_b16 v[2:3], v21 offset:2048
  s_add_u32 m0, s63, 12288
  s_add_u32 s67, s44, 2097152
  buffer_load_dwordx4 v20, s[16:19], s67 offen  lds
  s_waitcnt lgkmcnt(8)
  v_mfma_f32_16x16x32_bf16 v[208:211], v[4:7], v[88:91], v[208:211]
  v_mfma_f32_16x16x32_bf16 v[212:215], v[4:7], v[92:95], v[212:215]
  v_mfma_f32_16x16x32_bf16 v[216:219], v[4:7], v[96:99], v[216:219]
  ds_read_b64_tr_b16 v[4:5], v22 offset:0
  ds_read_b64_tr_b16 v[6:7], v22 offset:2048
  s_add_u32 m0, s63, 13312
  s_add_u32 s67, s44, 2162688
  buffer_load_dwordx4 v20, s[16:19], s67 offen  lds
  s_waitcnt lgkmcnt(8)
  v_mfma_f32_16x16x32_bf16 v[220:223], v[8:11], v[88:91], v[220:223]
  v_mfma_f32_16x16x32_bf16 v[224:227], v[8:11], v[92:95], v[224:227]
  v_mfma_f32_16x16x32_bf16 v[228:231], v[8:11], v[96:99], v[228:231]
  ds_read_b64_tr_b16 v[8:9], v23 offset:0
  ds_read_b64_tr_b16 v[10:11], v23 offset:2048
  s_add_u32 m0, s63, 14336
  s_add_u32 s67, s44, 2228224
  buffer_load_dwordx4 v20, s[16:19], s67 offen  lds
  s_waitcnt lgkmcnt(8)
  v_mfma_f32_16x16x32_bf16 v[232:235], v[12:15], v[88:91], v[232:235]
  v_mfma_f32_16x16x32_bf16 v[236:239], v[12:15], v[92:95], v[236:239]
  v_mfma_f32_16x16x32_bf16 v[240:243], v[12:15], v[96:99], v[240:243]
  ds_read_b64_tr_b16 v[12:13], v24 offset:0
  ds_read_b64_tr_b16 v[14:15], v24 offset:2048
  s_add_u32 m0, s63, 15360
  s_add_u32 s67, s44, 2293760
  buffer_load_dwordx4 v20, s[16:19], s67 offen  lds
  s_waitcnt lgkmcnt(8)
  v_mfma_f32_16x16x32_bf16 v[244:247], v[16:19], v[88:91], v[244:247]
  v_mfma_f32_16x16x32_bf16 v[248:251], v[16:19], v[92:95], v[248:251]
  v_mfma_f32_16x16x32_bf16 v[252:255], v[16:19], v[96:99], v[252:255]
  s_waitcnt vmcnt(8)
  ds_read_b64_tr_b16 v[16:17], v21 offset:4096
  ds_read_b64_tr_b16 v[18:19], v21 offset:6144
  s_add_u32 m0, s47, 0
  s_add_u32 s67, s44, 2359296
  buffer_load_dwordx4 v20, s[16:19], s67 offen  lds
  s_waitcnt lgkmcnt(8)
  v_mfma_f32_16x16x32_bf16 v[208:211], v[0:3], v[100:103], v[208:211]
  v_mfma_f32_16x16x32_bf16 v[212:215], v[0:3], v[104:107], v[212:215]
  v_mfma_f32_16x16x32_bf16 v[216:219], v[0:3], v[108:111], v[216:219]
  ds_read_b64_tr_b16 v[0:1], v22 offset:4096
  ds_read_b64_tr_b16 v[2:3], v22 offset:6144
  s_add_u32 m0, s47, 1024
  s_add_u32 s67, s44, 2424832
  buffer_load_dwordx4 v20, s[16:19], s67 offen  lds
  s_waitcnt lgkmcnt(8)
  v_mfma_f32_16x16x32_bf16 v[220:223], v[4:7], v[100:103], v[220:223]
  v_mfma_f32_16x16x32_bf16 v[224:227], v[4:7], v[104:107], v[224:227]
  v_mfma_f32_16x16x32_bf16 v[228:231], v[4:7], v[108:111], v[228:231]
  ds_read_b64_tr_b16 v[4:5], v23 offset:4096
  ds_read_b64_tr_b16 v[6:7], v23 offset:6144
  s_add_u32 m0, s47, 2048
  s_add_u32 s67, s44, 2490368
  buffer_load_dwordx4 v20, s[16:19], s67 offen  lds
  s_waitcnt lgkmcnt(8)
  v_mfma_f32_16x16x32_bf16 v[232:235], v[8:11], v[100:103], v[232:235]
  v_mfma_f32_16x16x32_bf16 v[236:239], v[8:11], v[104:107], v[236:239]
  v_mfma_f32_16x16x32_bf16 v[240:243], v[8:11], v[108:111], v[240:243]
  ds_read_b64_tr_b16 v[8:9], v24 offset:4096
  ds_read_b64_tr_b16 v[10:11], v24 offset:6144
  s_add_u32 m0, s47, 3072
  s_add_u32 s67, s44, 2555904
  buffer_load_dwordx4 v20, s[16:19], s67 offen  lds
  s_waitcnt lgkmcnt(8)
  v_mfma_f32_16x16x32_bf16 v[244:247], v[12:15], v[100:103], v[244:247]
  v_mfma_f32_16x16x32_bf16 v[248:251], v[12:15], v[104:107], v[248:251]
  v_mfma_f32_16x16x32_bf16 v[252:255], v[12:15], v[108:111], v[252:255]
  s_waitcnt vmcnt(8)
  ds_read_b64_tr_b16 v[12:13], v21 offset:8192
  ds_read_b64_tr_b16 v[14:15], v21 offset:10240
  s_add_u32 m0, s63, 0
  s_add_u32 s67, s44, 2621440
  buffer_load_dwordx4 v20, s[16:19], s67 offen  lds
  s_waitcnt lgkmcnt(8)
  v_mfma_f32_16x16x32_bf16 v[208:211], v[16:19], v[112:115], v[208:211]
  v_mfma_f32_16x16x32_bf16 v[212:215], v[16:19], v[116:119], v[212:215]
  v_mfma_f32_16x16x32_bf16 v[216:219], v[16:19], v[120:123], v[216:219]
  ds_read_b64_tr_b16 v[16:17], v22 offset:8192
  ds_read_b64_tr_b16 v[18:19], v22 offset:10240
  s_add_u32 m0, s63, 1024
  s_add_u32 s67, s44, 2686976
  buffer_load_dwordx4 v20, s[16:19], s67 offen  lds
  s_waitcnt lgkmcnt(8)
  v_mfma_f32_16x16x32_bf16 v[220:223], v[0:3], v[112:115], v[220:223]
  v_mfma_f32_16x16x32_bf16 v[224:227], v[0:3], v[116:119], v[224:227]
  v_mfma_f32_16x16x32_bf16 v[228:231], v[0:3], v[120:123], v[228:231]
  ds_read_b64_tr_b16 v[0:1], v23 offset:8192
  ds_read_b64_tr_b16 v[2:3], v23 offset:10240
  s_add_u32 m0, s63, 2048
  s_add_u32 s67, s44, 2752512
  buffer_load_dwordx4 v20, s[16:19], s67 offen  lds
  s_waitcnt lgkmcnt(8)
  v_mfma_f32_16x16x32_bf16 v[232:235], v[4:7], v[112:115], v[232:235]
  v_mfma_f32_16x16x32_bf16 v[236:239], v[4:7], v[116:119], v[236:239]
  v_mfma_f32_16x16x32_bf16 v[240:243], v[4:7], v[120:123], v[240:243]
  ds_read_b64_tr_b16 v[4:5], v24 offset:8192
  ds_read_b64_tr_b16 v[6:7], v24 offset:10240
  s_add_u32 m0, s63, 3072
  s_add_u32 s67, s44, 2818048
  buffer_load_dwordx4 v20, s[16:19], s67 offen  lds
  s_waitcnt lgkmcnt(8)
  v_mfma_f32_16x16x32_bf16 v[244:247], v[8:11], v[112:115], v[244:247]
  v_mfma_f32_16x16x32_bf16 v[248:251], v[8:11], v[116:119], v[248:251]
  v_mfma_f32_16x16x32_bf16 v[252:255], v[8:11], v[120:123], v[252:255]
  s_waitcnt vmcnt(8)
  ds_read_b64_tr_b16 v[8:9], v21 offset:12288
  ds_read_b64_tr_b16 v[10:11], v21 offset:14336
  s_add_u32 m0, s63, 4096
  s_add_u32 s67, s44, 2883584
  buffer_load_dwordx4 v20, s[16:19], s67 offen  lds
  s_waitcnt lgkmcnt(8)
  v_mfma_f32_16x16x32_bf16 v[208:211], v[12:15], v[124:127], v[208:211]
  v_mfma_f32_16x16x32_bf16 v[212:215], v[12:15], v[128:131], v[212:215]
  v_mfma_f32_16x16x32_bf16 v[216:219], v[12:15], v[132:135], v[216:219]
  ds_read_b64_tr_b16 v[12:13], v22 offset:12288
  ds_read_b64_tr_b16 v[14:15], v22 offset:14336
  s_add_u32 m0, s63, 5120
  s_add_u32 s67, s44, 2949120
  buffer_load_dwordx4 v20, s[16:19], s67 offen  lds
  s_waitcnt lgkmcnt(8)
  v_mfma_f32_16x16x32_bf16 v[220:223], v[16:19], v[124:127], v[220:223]
  v_mfma_f32_16x16x32_bf16 v[224:227], v[16:19], v[128:131], v[224:227]
  v_mfma_f32_16x16x32_bf16 v[228:231], v[16:19], v[132:135], v[228:231]
  ds_read_b64_tr_b16 v[16:17], v23 offset:12288
  ds_read_b64_tr_b16 v[18:19], v23 offset:14336
  s_add_u32 m0, s63, 6144
  s_add_u32 s67, s44, 3014656
  buffer_load_dwordx4 v20, s[16:19], s67 offen  lds
  s_waitcnt lgkmcnt(8)
  v_mfma_f32_16x16x32_bf16 v[232:235], v[0:3], v[124:127], v[232:235]
  v_mfma_f32_16x16x32_bf16 v[236:239], v[0:3], v[128:131], v[236:239]
  v_mfma_f32_16x16x32_bf16 v[240:243], v[0:3], v[132:135], v[240:243]
  ds_read_b64_tr_b16 v[0:1], v24 offset:12288
  ds_read_b64_tr_b16 v[2:3], v24 offset:14336
  s_add_u32 m0, s63, 7168
  s_add_u32 s67, s44, 3080192
  buffer_load_dwordx4 v20, s[16:19], s67 offen  lds
  s_waitcnt lgkmcnt(8)
  v_mfma_f32_16x16x32_bf16 v[244:247], v[4:7], v[124:127], v[244:247]
  v_mfma_f32_16x16x32_bf16 v[248:251], v[4:7], v[128:131], v[248:251]
  v_mfma_f32_16x16x32_bf16 v[252:255], v[4:7], v[132:135], v[252:255]
  s_waitcnt vmcnt(8)
  ds_read_b64_tr_b16 v[4:5], v35 offset:0
  ds_read_b64_tr_b16 v[6:7], v35 offset:2048
  s_add_u32 m0, s63, 8192
  s_add_u32 s67, s44, 3145728
  buffer_load_dwordx4 v20, s[16:19], s67 offen  lds
  s_waitcnt lgkmcnt(8)
  v_mfma_f32_16x16x32_bf16 v[208:211], v[8:11], v[136:139], v[208:211]
  v_mfma_f32_16x16x32_bf16 v[212:215], v[8:11], v[140:143], v[212:215]
  v_mfma_f32_16x16x32_bf16 v[216:219], v[8:11], v[144:147], v[216:219]
  ds_read_b64_tr_b16 v[8:9], v36 offset:0
  ds_read_b64_tr_b16 v[10:11], v36 offset:2048
  s_add_u32 m0, s63, 9216
  s_add_u32 s67, s44, 3211264
  buffer_load_dwordx4 v20, s[16:19], s67 offen  lds
  s_waitcnt lgkmcnt(8)
  v_mfma_f32_16x16x32_bf16 v[220:223], v[12:15], v[136:139], v[220:223]
  v_mfma_f32_16x16x32_bf16 v[224:227], v[12:15], v[140:143], v[224:227]
  v_mfma_f32_16x16x32_bf16 v[228:231], v[12:15], v[144:147], v[228:231]
  ds_read_b64_tr_b16 v[12:13], v37 offset:0
  ds_read_b64_tr_b16 v[14:15], v37 offset:2048
  s_add_u32 m0, s63, 10240
  s_add_u32 s67, s44, 3276800
  buffer_load_dwordx4 v20, s[16:19], s67 offen  lds
  s_waitcnt lgkmcnt(8)
  v_mfma_f32_16x16x32_bf16 v[232:235], v[16:19], v[136:139], v[232:235]
  v_mfma_f32_16x16x32_bf16 v[236:239], v[16:19], v[140:143], v[236:239]
  v_mfma_f32_16x16x32_bf16 v[240:243], v[16:19], v[144:147], v[240:243]
  ds_read_b64_tr_b16 v[16:17], v38 offset:0
  ds_read_b64_tr_b16 v[18:19], v38 offset:2048
  s_add_u32 m0, s63, 11264
  s_add_u32 s67, s44, 3342336
  buffer_load_dwordx4 v20, s[16:19], s67 offen  lds
  s_waitcnt lgkmcnt(8)
  v_mfma_f32_16x16x32_bf16 v[244:247], v[0:3], v[136:139], v[244:247]
  v_mfma_f32_16x16x32_bf16 v[248:251], v[0:3], v[140:143], v[248:251]
  v_mfma_f32_16x16x32_bf16 v[252:255], v[0:3], v[144:147], v[252:255]
  s_waitcnt vmcnt(8)
  ds_read_b64_tr_b16 v[0:1], v21 offset:0
  ds_read_b64_tr_b16 v[2:3], v21 offset:2048
  s_add_u32 m0, s63, 12288
  s_add_u32 s67, s44, 3407872
  buffer_load_dwordx4 v20, s[16:19], s67 offen  lds
  s_waitcnt lgkmcnt(8)
  v_mfma_f32_16x16x32_bf16 v[208:211], v[4:7], v[148:151], v[208:211]
  v_mfma_f32_16x16x32_bf16 v[212:215], v[4:7], v[152:155], v[212:215]
  v_mfma_f32_16x16x32_bf16 v[216:219], v[4:7], v[156:159], v[216:219]
  ds_read_b64_tr_b16 v[4:5], v22 offset:0
  ds_read_b64_tr_b16 v[6:7], v22 offset:2048
  s_add_u32 m0, s63, 13312
  s_add_u32 s67, s44, 3473408
  buffer_load_dwordx4 v20, s[16:19], s67 offen  lds
  s_waitcnt lgkmcnt(8)
  v_mfma_f32_16x16x32_bf16 v[220:223], v[8:11], v[148:151], v[220:223]
  v_mfma_f32_16x16x32_bf16 v[224:227], v[8:11], v[152:155], v[224:227]
  v_mfma_f32_16x16x32_bf16 v[228:231], v[8:11], v[156:159], v[228:231]
  ds_read_b64_tr_b16 v[8:9], v23 offset:0
  ds_read_b64_tr_b16 v[10:11], v23 offset:2048
  s_add_u32 m0, s63, 14336
  s_add_u32 s67, s44, 3538944
  buffer_load_dwordx4 v20, s[16:19], s67 offen  lds
  s_waitcnt lgkmcnt(8)
  v_mfma_f32_16x16x32_bf16 v[232:235], v[12:15], v[148:151], v[232:235]
  v_mfma_f32_16x16x32_bf16 v[236:239], v[12:15], v[152:155], v[236:239]
  v_mfma_f32_16x16x32_bf16 v[240:243], v[12:15], v[156:159], v[240:243]
  ds_read_b64_tr_b16 v[12:13], v24 offset:0
  ds_read_b64_tr_b16 v[14:15], v24 offset:2048
  s_add_u32 m0, s63, 15360
  s_add_u32 s67, s44, 3604480
  buffer_load_dwordx4 v20, s[16:19], s67 offen  lds
  s_waitcnt lgkmcnt(8)
  v_mfma_f32_16x16x32_bf16 v[244:247], v[16:19], v[148:151], v[244:247]
  v_mfma_f32_16x16x32_bf16 v[248:251], v[16:19], v[152:155], v[248:251]
  v_mfma_f32_16x16x32_bf16 v[252:255], v[16:19], v[156:159], v[252:255]
  s_waitcnt vmcnt(8)
  ds_read_b64_tr_b16 v[16:17], v21 offset:4096
  ds_read_b64_tr_b16 v[18:19], v21 offset:6144
  s_waitcnt lgkmcnt(8)
  v_mfma_f32_16x16x32_bf16 v[208:211], v[0:3], v[160:163], v[208:211]
  v_mfma_f32_16x16x32_bf16 v[212:215], v[0:3], v[164:167], v[212:215]
  v_mfma_f32_16x16x32_bf16 v[216:219], v[0:3], v[168:171], v[216:219]
  ds_read_b64_tr_b16 v[0:1], v22 offset:4096
  ds_read_b64_tr_b16 v[2:3], v22 offset:6144
  s_waitcnt lgkmcnt(8)
  v_mfma_f32_16x16x32_bf16 v[220:223], v[4:7], v[160:163], v[220:223]
  v_mfma_f32_16x16x32_bf16 v[224:227], v[4:7], v[164:167], v[224:227]
  v_mfma_f32_16x16x32_bf16 v[228:231], v[4:7], v[168:171], v[228:231]
  ds_read_b64_tr_b16 v[4:5], v23 offset:4096
  ds_read_b64_tr_b16 v[6:7], v23 offset:6144
  s_waitcnt lgkmcnt(8)
  v_mfma_f32_16x16x32_bf16 v[232:235], v[8:11], v[160:163], v[232:235]
  v_mfma_f32_16x16x32_bf16 v[236:239], v[8:11], v[164:167], v[236:239]
  v_mfma_f32_16x16x32_bf16 v[240:243], v[8:11], v[168:171], v[240:243]
  ds_read_b64_tr_b16 v[8:9], v24 offset:4096
  ds_read_b64_tr_b16 v[10:11], v24 offset:6144
  s_waitcnt lgkmcnt(8)
  v_mfma_f32_16x16x32_bf16 v[244:247], v[12:15], v[160:163], v[244:247]
  v_mfma_f32_16x16x32_bf16 v[248:251], v[12:15], v[164:167], v[248:251]
  v_mfma_f32_16x16x32_bf16 v[252:255], v[12:15], v[168:171], v[252:255]
  s_waitcnt vmcnt(4)
  ds_read_b64_tr_b16 v[12:13], v21 offset:8192
  ds_read_b64_tr_b16 v[14:15], v21 offset:10240
  s_waitcnt lgkmcnt(8)
  v_mfma_f32_16x16x32_bf16 v[208:211], v[16:19], v[172:175], v[208:211]
  v_mfma_f32_16x16x32_bf16 v[212:215], v[16:19], v[176:179], v[212:215]
  v_mfma_f32_16x16x32_bf16 v[216:219], v[16:19], v[180:183], v[216:219]
  ds_read_b64_tr_b16 v[16:17], v22 offset:8192
  ds_read_b64_tr_b16 v[18:19], v22 offset:10240
  s_waitcnt lgkmcnt(8)
  v_mfma_f32_16x16x32_bf16 v[220:223], v[0:3], v[172:175], v[220:223]
  v_mfma_f32_16x16x32_bf16 v[224:227], v[0:3], v[176:179], v[224:227]
  v_mfma_f32_16x16x32_bf16 v[228:231], v[0:3], v[180:183], v[228:231]
  ds_read_b64_tr_b16 v[0:1], v23 offset:8192
  ds_read_b64_tr_b16 v[2:3], v23 offset:10240
  s_waitcnt lgkmcnt(8)
  v_mfma_f32_16x16x32_bf16 v[232:235], v[4:7], v[172:175], v[232:235]
  v_mfma_f32_16x16x32_bf16 v[236:239], v[4:7], v[176:179], v[236:239]
  v_mfma_f32_16x16x32_bf16 v[240:243], v[4:7], v[180:183], v[240:243]
  ds_read_b64_tr_b16 v[4:5], v24 offset:8192
  ds_read_b64_tr_b16 v[6:7], v24 offset:10240
  s_waitcnt lgkmcnt(8)
  v_mfma_f32_16x16x32_bf16 v[244:247], v[8:11], v[172:175], v[244:247]
  v_mfma_f32_16x16x32_bf16 v[248:251], v[8:11], v[176:179], v[248:251]
  v_mfma_f32_16x16x32_bf16 v[252:255], v[8:11], v[180:183], v[252:255]
  s_barrier
  s_waitcnt vmcnt(0)
  ds_read_b64_tr_b16 v[8:9], v21 offset:12288
  ds_read_b64_tr_b16 v[10:11], v21 offset:14336
  s_waitcnt lgkmcnt(8)
  v_mfma_f32_16x16x32_bf16 v[208:211], v[12:15], v[184:187], v[208:211]
  v_mfma_f32_16x16x32_bf16 v[212:215], v[12:15], v[188:191], v[212:215]
  v_mfma_f32_16x16x32_bf16 v[216:219], v[12:15], v[192:195], v[216:219]
  ds_read_b64_tr_b16 v[12:13], v22 offset:12288
  ds_read_b64_tr_b16 v[14:15], v22 offset:14336
  s_waitcnt lgkmcnt(8)
  v_mfma_f32_16x16x32_bf16 v[220:223], v[16:19], v[184:187], v[220:223]
  v_mfma_f32_16x16x32_bf16 v[224:227], v[16:19], v[188:191], v[224:227]
  v_mfma_f32_16x16x32_bf16 v[228:231], v[16:19], v[192:195], v[228:231]
  ds_read_b64_tr_b16 v[16:17], v23 offset:12288
  ds_read_b64_tr_b16 v[18:19], v23 offset:14336
  s_waitcnt lgkmcnt(8)
  v_mfma_f32_16x16x32_bf16 v[232:235], v[0:3], v[184:187], v[232:235]
  v_mfma_f32_16x16x32_bf16 v[236:239], v[0:3], v[188:191], v[236:239]
  v_mfma_f32_16x16x32_bf16 v[240:243], v[0:3], v[192:195], v[240:243]
  ds_read_b64_tr_b16 v[0:1], v24 offset:12288
  ds_read_b64_tr_b16 v[2:3], v24 offset:14336
  s_waitcnt lgkmcnt(8)
  v_mfma_f32_16x16x32_bf16 v[244:247], v[4:7], v[184:187], v[244:247]
  v_mfma_f32_16x16x32_bf16 v[248:251], v[4:7], v[188:191], v[248:251]
  v_mfma_f32_16x16x32_bf16 v[252:255], v[4:7], v[192:195], v[252:255]
  s_waitcnt lgkmcnt(6)
  v_mfma_f32_16x16x32_bf16 v[208:211], v[8:11], v[196:199], v[208:211]
  v_mfma_f32_16x16x32_bf16 v[212:215], v[8:11], v[200:203], v[212:215]
  v_mfma_f32_16x16x32_bf16 v[216:219], v[8:11], v[204:207], v[216:219]
  s_waitcnt lgkmcnt(4)
  v_mfma_f32_16x16x32_bf16 v[220:223], v[12:15], v[196:199], v[220:223]
  v_mfma_f32_16x16x32_bf16 v[224:227], v[12:15], v[200:203], v[224:227]
  v_mfma_f32_16x16x32_bf16 v[228:231], v[12:15], v[204:207], v[228:231]
  s_waitcnt lgkmcnt(2)
  v_mfma_f32_16x16x32_bf16 v[232:235], v[16:19], v[196:199], v[232:235]
  v_mfma_f32_16x16x32_bf16 v[236:239], v[16:19], v[200:203], v[236:239]
  v_mfma_f32_16x16x32_bf16 v[240:243], v[16:19], v[204:207], v[240:243]
  s_waitcnt lgkmcnt(0)
  v_mfma_f32_16x16x32_bf16 v[244:247], v[0:3], v[196:199], v[244:247]
  v_mfma_f32_16x16x32_bf16 v[248:251], v[0:3], v[200:203], v[248:251]
  v_mfma_f32_16x16x32_bf16 v[252:255], v[0:3], v[204:207], v[252:255]
  v_xor_b32 v34, 0, v25
  v_cvt_pk_bf16_f32 v26, v208, v209
  v_cvt_pk_bf16_f32 v27, v210, v211
  ds_write_b64 v34, v[26:27] offset:0
  v_cvt_pk_bf16_f32 v28, v212, v213
  v_cvt_pk_bf16_f32 v29, v214, v215
  ds_write_b64 v34, v[28:29] offset:2048
  v_cvt_pk_bf16_f32 v30, v216, v217
  v_cvt_pk_bf16_f32 v31, v218, v219
  ds_write_b64 v34, v[30:31] offset:4096
  v_xor_b32 v34, 32, v25
  v_cvt_pk_bf16_f32 v32, v220, v221
  v_cvt_pk_bf16_f32 v33, v222, v223
  ds_write_b64 v34, v[32:33] offset:0
  v_cvt_pk_bf16_f32 v26, v224, v225
  v_cvt_pk_bf16_f32 v27, v226, v227
  ds_write_b64 v34, v[26:27] offset:2048
  v_cvt_pk_bf16_f32 v28, v228, v229
  v_cvt_pk_bf16_f32 v29, v230, v231
  ds_write_b64 v34, v[28:29] offset:4096
  v_xor_b32 v34, 64, v25
  v_cvt_pk_bf16_f32 v30, v232, v233
  v_cvt_pk_bf16_f32 v31, v234, v235
  ds_write_b64 v34, v[30:31] offset:0
  v_cvt_pk_bf16_f32 v32, v236, v237
  v_cvt_pk_bf16_f32 v33, v238, v239
  ds_write_b64 v34, v[32:33] offset:2048
  v_cvt_pk_bf16_f32 v26, v240, v241
  v_cvt_pk_bf16_f32 v27, v242, v243
  ds_write_b64 v34, v[26:27] offset:4096
  v_xor_b32 v34, 96, v25
  v_cvt_pk_bf16_f32 v28, v244, v245
  v_cvt_pk_bf16_f32 v29, v246, v247
  ds_write_b64 v34, v[28:29] offset:0
  v_cvt_pk_bf16_f32 v30, v248, v249
  v_cvt_pk_bf16_f32 v31, v250, v251
  ds_write_b64 v34, v[30:31] offset:2048
  v_cvt_pk_bf16_f32 v32, v252, v253
  v_cvt_pk_bf16_f32 v33, v254, v255
  ds_write_b64 v34, v[32:33] offset:4096
  s_waitcnt lgkmcnt(0)
  s_barrier
  s_setprio 1
  s_add_u32 m0, s63, 8192
  s_add_u32 s67, s45, 0
  buffer_load_dwordx4 v20, s[16:19], s67 offen  lds
  s_add_u32 m0, s63, 9216
  s_add_u32 s67, s45, 65536
  buffer_load_dwordx4 v20, s[16:19], s67 offen  lds
  s_add_u32 m0, s63, 10240
  s_add_u32 s67, s45, 131072
  buffer_load_dwordx4 v20, s[16:19], s67 offen  lds
  s_add_u32 m0, s63, 11264
  s_add_u32 s67, s45, 196608
  buffer_load_dwordx4 v20, s[16:19], s67 offen  lds
  s_add_u32 m0, s63, 12288
  s_add_u32 s67, s45, 262144
  buffer_load_dwordx4 v20, s[16:19], s67 offen  lds
  s_add_u32 m0, s63, 13312
  s_add_u32 s67, s45, 327680
  buffer_load_dwordx4 v20, s[16:19], s67 offen  lds
  s_add_u32 m0, s63, 14336
  s_add_u32 s67, s45, 393216
  buffer_load_dwordx4 v20, s[16:19], s67 offen  lds
  s_add_u32 m0, s63, 15360
  s_add_u32 s67, s45, 458752
  buffer_load_dwordx4 v20, s[16:19], s67 offen  lds
  s_add_u32 m0, s63, 0
  s_add_u32 s67, s45, 524288
  buffer_load_dwordx4 v20, s[16:19], s67 offen  lds
  s_add_u32 m0, s63, 1024
  s_add_u32 s67, s45, 589824
  buffer_load_dwordx4 v20, s[16:19], s67 offen  lds
  s_add_u32 m0, s63, 2048
  s_add_u32 s67, s45, 655360
  buffer_load_dwordx4 v20, s[16:19], s67 offen  lds
  s_add_u32 m0, s63, 3072
  s_add_u32 s67, s45, 720896
  buffer_load_dwordx4 v20, s[16:19], s67 offen  lds
  s_add_u32 m0, s63, 4096
  s_add_u32 s67, s45, 786432
  buffer_load_dwordx4 v20, s[16:19], s67 offen  lds
  s_add_u32 m0, s63, 5120
  s_add_u32 s67, s45, 851968
  buffer_load_dwordx4 v20, s[16:19], s67 offen  lds
  s_add_u32 m0, s63, 6144
  s_add_u32 s67, s45, 917504
  buffer_load_dwordx4 v20, s[16:19], s67 offen  lds
  s_add_u32 m0, s63, 7168
  s_add_u32 s67, s45, 983040
  buffer_load_dwordx4 v20, s[16:19], s67 offen  lds
  s_barrier
  s_waitcnt vmcnt(12)
  ds_read_b64_tr_b16 v[0:1], v21 offset:8192
  ds_read_b64_tr_b16 v[2:3], v21 offset:10240
  ds_read_b64_tr_b16 v[4:5], v22 offset:8192
  ds_read_b64_tr_b16 v[6:7], v22 offset:10240
  ds_read_b64_tr_b16 v[8:9], v23 offset:8192
  ds_read_b64_tr_b16 v[10:11], v23 offset:10240
  ds_read_b64_tr_b16 v[12:13], v24 offset:8192
  ds_read_b64_tr_b16 v[14:15], v24 offset:10240
  s_waitcnt vmcnt(8)
  ds_read_b64_tr_b16 v[16:17], v21 offset:12288
  ds_read_b64_tr_b16 v[18:19], v21 offset:14336
  s_waitcnt lgkmcnt(8)
  v_mfma_f32_16x16x32_bf16 v[208:211], v[0:3], v[40:43], 0
  v_mfma_f32_16x16x32_bf16 v[212:215], v[0:3], v[44:47], 0
  v_mfma_f32_16x16x32_bf16 v[216:219], v[0:3], v[48:51], 0
  ds_read_b64_tr_b16 v[0:1], v22 offset:12288
  ds_read_b64_tr_b16 v[2:3], v22 offset:14336
  s_waitcnt lgkmcnt(8)
  v_mfma_f32_16x16x32_bf16 v[220:223], v[4:7], v[40:43], 0
  v_mfma_f32_16x16x32_bf16 v[224:227], v[4:7], v[44:47], 0
  v_mfma_f32_16x16x32_bf16 v[228:231], v[4:7], v[48:51], 0
  ds_read_b64_tr_b16 v[4:5], v23 offset:12288
  ds_read_b64_tr_b16 v[6:7], v23 offset:14336
  s_waitcnt lgkmcnt(8)
  v_mfma_f32_16x16x32_bf16 v[232:235], v[8:11], v[40:43], 0
  v_mfma_f32_16x16x32_bf16 v[236:239], v[8:11], v[44:47], 0
  v_mfma_f32_16x16x32_bf16 v[240:243], v[8:11], v[48:51], 0
  ds_read_b64_tr_b16 v[8:9], v24 offset:12288
  ds_read_b64_tr_b16 v[10:11], v24 offset:14336
  s_waitcnt lgkmcnt(8)
  v_mfma_f32_16x16x32_bf16 v[244:247], v[12:15], v[40:43], 0
  v_mfma_f32_16x16x32_bf16 v[248:251], v[12:15], v[44:47], 0
  v_mfma_f32_16x16x32_bf16 v[252:255], v[12:15], v[48:51], 0
  s_waitcnt lgkmcnt(6)
  v_mfma_f32_16x16x32_bf16 v[208:211], v[16:19], v[52:55], v[208:211]
  v_mfma_f32_16x16x32_bf16 v[212:215], v[16:19], v[56:59], v[212:215]
  v_mfma_f32_16x16x32_bf16 v[216:219], v[16:19], v[60:63], v[216:219]
  s_waitcnt lgkmcnt(4)
  v_mfma_f32_16x16x32_bf16 v[220:223], v[0:3], v[52:55], v[220:223]
  v_mfma_f32_16x16x32_bf16 v[224:227], v[0:3], v[56:59], v[224:227]
  v_mfma_f32_16x16x32_bf16 v[228:231], v[0:3], v[60:63], v[228:231]
  s_waitcnt lgkmcnt(2)
  v_mfma_f32_16x16x32_bf16 v[232:235], v[4:7], v[52:55], v[232:235]
  v_mfma_f32_16x16x32_bf16 v[236:239], v[4:7], v[56:59], v[236:239]
  v_mfma_f32_16x16x32_bf16 v[240:243], v[4:7], v[60:63], v[240:243]
  s_waitcnt lgkmcnt(0)
  v_mfma_f32_16x16x32_bf16 v[244:247], v[8:11], v[52:55], v[244:247]
  v_mfma_f32_16x16x32_bf16 v[248:251], v[8:11], v[56:59], v[248:251]
  v_mfma_f32_16x16x32_bf16 v[252:255], v[8:11], v[60:63], v[252:255]
  s_add_u32 m0, s63, 8192
  s_add_u32 s67, s45, 1048576
  buffer_load_dwordx4 v20, s[16:19], s67 offen  lds
  s_add_u32 m0, s63, 9216
  s_add_u32 s67, s45, 1114112
  buffer_load_dwordx4 v20, s[16:19], s67 offen  lds
  s_add_u32 m0, s63, 10240
  s_add_u32 s67, s45, 1179648
  buffer_load_dwordx4 v20, s[16:19], s67 offen  lds
  s_add_u32 m0, s63, 11264
  s_add_u32 s67, s45, 1245184
  buffer_load_dwordx4 v20, s[16:19], s67 offen  lds
  s_add_u32 m0, s63, 12288
  s_add_u32 s67, s45, 1310720
  buffer_load_dwordx4 v20, s[16:19], s67 offen  lds
  s_add_u32 m0, s63, 13312
  s_add_u32 s67, s45, 1376256
  buffer_load_dwordx4 v20, s[16:19], s67 offen  lds
  s_add_u32 m0, s63, 14336
  s_add_u32 s67, s45, 1441792
  buffer_load_dwordx4 v20, s[16:19], s67 offen  lds
  s_add_u32 m0, s63, 15360
  s_add_u32 s67, s45, 1507328
  buffer_load_dwordx4 v20, s[16:19], s67 offen  lds
  s_barrier
  s_waitcnt vmcnt(12)
  ds_read_b64_tr_b16 v[0:1], v21 offset:0
  ds_read_b64_tr_b16 v[2:3], v21 offset:2048
  ds_read_b64_tr_b16 v[4:5], v22 offset:0
  ds_read_b64_tr_b16 v[6:7], v22 offset:2048
  ds_read_b64_tr_b16 v[8:9], v23 offset:0
  ds_read_b64_tr_b16 v[10:11], v23 offset:2048
  ds_read_b64_tr_b16 v[12:13], v24 offset:0
  ds_read_b64_tr_b16 v[14:15], v24 offset:2048
  s_waitcnt vmcnt(8)
  ds_read_b64_tr_b16 v[16:17], v21 offset:4096
  ds_read_b64_tr_b16 v[18:19], v21 offset:6144
  s_waitcnt lgkmcnt(8)
  v_mfma_f32_16x16x32_bf16 v[208:211], v[0:3], v[64:67], v[208:211]
  v_mfma_f32_16x16x32_bf16 v[212:215], v[0:3], v[68:71], v[212:215]
  v_mfma_f32_16x16x32_bf16 v[216:219], v[0:3], v[72:75], v[216:219]
  ds_read_b64_tr_b16 v[0:1], v22 offset:4096
  ds_read_b64_tr_b16 v[2:3], v22 offset:6144
  s_waitcnt lgkmcnt(8)
  v_mfma_f32_16x16x32_bf16 v[220:223], v[4:7], v[64:67], v[220:223]
  v_mfma_f32_16x16x32_bf16 v[224:227], v[4:7], v[68:71], v[224:227]
  v_mfma_f32_16x16x32_bf16 v[228:231], v[4:7], v[72:75], v[228:231]
  ds_read_b64_tr_b16 v[4:5], v23 offset:4096
  ds_read_b64_tr_b16 v[6:7], v23 offset:6144
  s_waitcnt lgkmcnt(8)
  v_mfma_f32_16x16x32_bf16 v[232:235], v[8:11], v[64:67], v[232:235]
  v_mfma_f32_16x16x32_bf16 v[236:239], v[8:11], v[68:71], v[236:239]
  v_mfma_f32_16x16x32_bf16 v[240:243], v[8:11], v[72:75], v[240:243]
  ds_read_b64_tr_b16 v[8:9], v24 offset:4096
  ds_read_b64_tr_b16 v[10:11], v24 offset:6144
  s_waitcnt lgkmcnt(8)
  v_mfma_f32_16x16x32_bf16 v[244:247], v[12:15], v[64:67], v[244:247]
  v_mfma_f32_16x16x32_bf16 v[248:251], v[12:15], v[68:71], v[248:251]
  v_mfma_f32_16x16x32_bf16 v[252:255], v[12:15], v[72:75], v[252:255]
  s_waitcnt vmcnt(4)
  ds_read_b64_tr_b16 v[12:13], v21 offset:8192
  ds_read_b64_tr_b16 v[14:15], v21 offset:10240
  s_waitcnt lgkmcnt(8)
  v_mfma_f32_16x16x32_bf16 v[208:211], v[16:19], v[76:79], v[208:211]
  v_mfma_f32_16x16x32_bf16 v[212:215], v[16:19], v[80:83], v[212:215]
  v_mfma_f32_16x16x32_bf16 v[216:219], v[16:19], v[84:87], v[216:219]
  ds_read_b64_tr_b16 v[16:17], v22 offset:8192
  ds_read_b64_tr_b16 v[18:19], v22 offset:10240
  s_waitcnt lgkmcnt(8)
  v_mfma_f32_16x16x32_bf16 v[220:223], v[0:3], v[76:79], v[220:223]
  v_mfma_f32_16x16x32_bf16 v[224:227], v[0:3], v[80:83], v[224:227]
  v_mfma_f32_16x16x32_bf16 v[228:231], v[0:3], v[84:87], v[228:231]
  ds_read_b64_tr_b16 v[0:1], v23 offset:8192
  ds_read_b64_tr_b16 v[2:3], v23 offset:10240
  s_waitcnt lgkmcnt(8)
  v_mfma_f32_16x16x32_bf16 v[232:235], v[4:7], v[76:79], v[232:235]
  v_mfma_f32_16x16x32_bf16 v[236:239], v[4:7], v[80:83], v[236:239]
  v_mfma_f32_16x16x32_bf16 v[240:243], v[4:7], v[84:87], v[240:243]
  ds_read_b64_tr_b16 v[4:5], v24 offset:8192
  ds_read_b64_tr_b16 v[6:7], v24 offset:10240
  s_waitcnt lgkmcnt(8)
  v_mfma_f32_16x16x32_bf16 v[244:247], v[8:11], v[76:79], v[244:247]
  v_mfma_f32_16x16x32_bf16 v[248:251], v[8:11], v[80:83], v[248:251]
  v_mfma_f32_16x16x32_bf16 v[252:255], v[8:11], v[84:87], v[252:255]
  s_waitcnt vmcnt(0)
  ds_read_b64_tr_b16 v[8:9], v21 offset:12288
  ds_read_b64_tr_b16 v[10:11], v21 offset:14336
  s_waitcnt lgkmcnt(8)
  v_mfma_f32_16x16x32_bf16 v[208:211], v[12:15], v[88:91], v[208:211]
  v_mfma_f32_16x16x32_bf16 v[212:215], v[12:15], v[92:95], v[212:215]
  v_mfma_f32_16x16x32_bf16 v[216:219], v[12:15], v[96:99], v[216:219]
  ds_read_b64_tr_b16 v[12:13], v22 offset:12288
  ds_read_b64_tr_b16 v[14:15], v22 offset:14336
  s_waitcnt lgkmcnt(8)
  v_mfma_f32_16x16x32_bf16 v[220:223], v[16:19], v[88:91], v[220:223]
  v_mfma_f32_16x16x32_bf16 v[224:227], v[16:19], v[92:95], v[224:227]
  v_mfma_f32_16x16x32_bf16 v[228:231], v[16:19], v[96:99], v[228:231]
  ds_read_b64_tr_b16 v[16:17], v23 offset:12288
  ds_read_b64_tr_b16 v[18:19], v23 offset:14336
  s_waitcnt lgkmcnt(8)
  v_mfma_f32_16x16x32_bf16 v[232:235], v[0:3], v[88:91], v[232:235]
  v_mfma_f32_16x16x32_bf16 v[236:239], v[0:3], v[92:95], v[236:239]
  v_mfma_f32_16x16x32_bf16 v[240:243], v[0:3], v[96:99], v[240:243]
  ds_read_b64_tr_b16 v[0:1], v24 offset:12288
  ds_read_b64_tr_b16 v[2:3], v24 offset:14336
  s_waitcnt lgkmcnt(8)
  v_mfma_f32_16x16x32_bf16 v[244:247], v[4:7], v[88:91], v[244:247]
  v_mfma_f32_16x16x32_bf16 v[248:251], v[4:7], v[92:95], v[248:251]
  v_mfma_f32_16x16x32_bf16 v[252:255], v[4:7], v[96:99], v[252:255]
  s_waitcnt lgkmcnt(6)
  v_mfma_f32_16x16x32_bf16 v[208:211], v[8:11], v[100:103], v[208:211]
  v_mfma_f32_16x16x32_bf16 v[212:215], v[8:11], v[104:107], v[212:215]
  v_mfma_f32_16x16x32_bf16 v[216:219], v[8:11], v[108:111], v[216:219]
  s_waitcnt lgkmcnt(4)
  v_mfma_f32_16x16x32_bf16 v[220:223], v[12:15], v[100:103], v[220:223]
  v_mfma_f32_16x16x32_bf16 v[224:227], v[12:15], v[104:107], v[224:227]
  v_mfma_f32_16x16x32_bf16 v[228:231], v[12:15], v[108:111], v[228:231]
  s_waitcnt lgkmcnt(2)
  v_mfma_f32_16x16x32_bf16 v[232:235], v[16:19], v[100:103], v[232:235]
  v_mfma_f32_16x16x32_bf16 v[236:239], v[16:19], v[104:107], v[236:239]
  v_mfma_f32_16x16x32_bf16 v[240:243], v[16:19], v[108:111], v[240:243]
  s_waitcnt lgkmcnt(0)
  v_mfma_f32_16x16x32_bf16 v[244:247], v[0:3], v[100:103], v[244:247]
  v_mfma_f32_16x16x32_bf16 v[248:251], v[0:3], v[104:107], v[248:251]
  v_mfma_f32_16x16x32_bf16 v[252:255], v[0:3], v[108:111], v[252:255]
  s_add_u32 m0, s63, 0
  s_add_u32 s67, s45, 1572864
  buffer_load_dwordx4 v20, s[16:19], s67 offen  lds
  s_add_u32 m0, s63, 1024
  s_add_u32 s67, s45, 1638400
  buffer_load_dwordx4 v20, s[16:19], s67 offen  lds
  s_add_u32 m0, s63, 2048
  s_add_u32 s67, s45, 1703936
  buffer_load_dwordx4 v20, s[16:19], s67 offen  lds
  s_add_u32 m0, s63, 3072
  s_add_u32 s67, s45, 1769472
  buffer_load_dwordx4 v20, s[16:19], s67 offen  lds
  s_add_u32 m0, s63, 4096
  s_add_u32 s67, s45, 1835008
  buffer_load_dwordx4 v20, s[16:19], s67 offen  lds
  s_add_u32 m0, s63, 5120
  s_add_u32 s67, s45, 1900544
  buffer_load_dwordx4 v20, s[16:19], s67 offen  lds
  s_add_u32 m0, s63, 6144
  s_add_u32 s67, s45, 1966080
  buffer_load_dwordx4 v20, s[16:19], s67 offen  lds
  s_add_u32 m0, s63, 7168
  s_add_u32 s67, s45, 2031616
  buffer_load_dwordx4 v20, s[16:19], s67 offen  lds
  s_add_u32 m0, s63, 8192
  s_add_u32 s67, s45, 2097152
  buffer_load_dwordx4 v20, s[16:19], s67 offen  lds
  s_add_u32 m0, s63, 9216
  s_add_u32 s67, s45, 2162688
  buffer_load_dwordx4 v20, s[16:19], s67 offen  lds
  s_add_u32 m0, s63, 10240
  s_add_u32 s67, s45, 2228224
  buffer_load_dwordx4 v20, s[16:19], s67 offen  lds
  s_add_u32 m0, s63, 11264
  s_add_u32 s67, s45, 2293760
  buffer_load_dwordx4 v20, s[16:19], s67 offen  lds
  s_add_u32 m0, s63, 12288
  s_add_u32 s67, s45, 2359296
  buffer_load_dwordx4 v20, s[16:19], s67 offen  lds
  s_add_u32 m0, s63, 13312
  s_add_u32 s67, s45, 2424832
  buffer_load_dwordx4 v20, s[16:19], s67 offen  lds
  s_add_u32 m0, s63, 14336
  s_add_u32 s67, s45, 2490368
  buffer_load_dwordx4 v20, s[16:19], s67 offen  lds
  s_add_u32 m0, s63, 15360
  s_add_u32 s67, s45, 2555904
  buffer_load_dwordx4 v20, s[16:19], s67 offen  lds
  s_barrier
  s_waitcnt vmcnt(12)
  ds_read_b64_tr_b16 v[0:1], v21 offset:0
  ds_read_b64_tr_b16 v[2:3], v21 offset:2048
  ds_read_b64_tr_b16 v[4:5], v22 offset:0
  ds_read_b64_tr_b16 v[6:7], v22 offset:2048
  ds_read_b64_tr_b16 v[8:9], v23 offset:0
  ds_read_b64_tr_b16 v[10:11], v23 offset:2048
  ds_read_b64_tr_b16 v[12:13], v24 offset:0
  ds_read_b64_tr_b16 v[14:15], v24 offset:2048
  s_waitcnt vmcnt(8)
  ds_read_b64_tr_b16 v[16:17], v21 offset:4096
  ds_read_b64_tr_b16 v[18:19], v21 offset:6144
  s_waitcnt lgkmcnt(8)
  v_mfma_f32_16x16x32_bf16 v[208:211], v[0:3], v[112:115], v[208:211]
  v_mfma_f32_16x16x32_bf16 v[212:215], v[0:3], v[116:119], v[212:215]
  v_mfma_f32_16x16x32_bf16 v[216:219], v[0:3], v[120:123], v[216:219]
  ds_read_b64_tr_b16 v[0:1], v22 offset:4096
  ds_read_b64_tr_b16 v[2:3], v22 offset:6144
  s_waitcnt lgkmcnt(8)
  v_mfma_f32_16x16x32_bf16 v[220:223], v[4:7], v[112:115], v[220:223]
  v_mfma_f32_16x16x32_bf16 v[224:227], v[4:7], v[116:119], v[224:227]
  v_mfma_f32_16x16x32_bf16 v[228:231], v[4:7], v[120:123], v[228:231]
  ds_read_b64_tr_b16 v[4:5], v23 offset:4096
  ds_read_b64_tr_b16 v[6:7], v23 offset:6144
  s_waitcnt lgkmcnt(8)
  v_mfma_f32_16x16x32_bf16 v[232:235], v[8:11], v[112:115], v[232:235]
  v_mfma_f32_16x16x32_bf16 v[236:239], v[8:11], v[116:119], v[236:239]
  v_mfma_f32_16x16x32_bf16 v[240:243], v[8:11], v[120:123], v[240:243]
  ds_read_b64_tr_b16 v[8:9], v24 offset:4096
  ds_read_b64_tr_b16 v[10:11], v24 offset:6144
  s_waitcnt lgkmcnt(8)
  v_mfma_f32_16x16x32_bf16 v[244:247], v[12:15], v[112:115], v[244:247]
  v_mfma_f32_16x16x32_bf16 v[248:251], v[12:15], v[116:119], v[248:251]
  v_mfma_f32_16x16x32_bf16 v[252:255], v[12:15], v[120:123], v[252:255]
  s_waitcnt vmcnt(4)
  ds_read_b64_tr_b16 v[12:13], v21 offset:8192
  ds_read_b64_tr_b16 v[14:15], v21 offset:10240
  s_waitcnt lgkmcnt(8)
  v_mfma_f32_16x16x32_bf16 v[208:211], v[16:19], v[124:127], v[208:211]
  v_mfma_f32_16x16x32_bf16 v[212:215], v[16:19], v[128:131], v[212:215]
  v_mfma_f32_16x16x32_bf16 v[216:219], v[16:19], v[132:135], v[216:219]
  ds_read_b64_tr_b16 v[16:17], v22 offset:8192
  ds_read_b64_tr_b16 v[18:19], v22 offset:10240
  s_waitcnt lgkmcnt(8)
  v_mfma_f32_16x16x32_bf16 v[220:223], v[0:3], v[124:127], v[220:223]
  v_mfma_f32_16x16x32_bf16 v[224:227], v[0:3], v[128:131], v[224:227]
  v_mfma_f32_16x16x32_bf16 v[228:231], v[0:3], v[132:135], v[228:231]
  ds_read_b64_tr_b16 v[0:1], v23 offset:8192
  ds_read_b64_tr_b16 v[2:3], v23 offset:10240
  s_waitcnt lgkmcnt(8)
  v_mfma_f32_16x16x32_bf16 v[232:235], v[4:7], v[124:127], v[232:235]
  v_mfma_f32_16x16x32_bf16 v[236:239], v[4:7], v[128:131], v[236:239]
  v_mfma_f32_16x16x32_bf16 v[240:243], v[4:7], v[132:135], v[240:243]
  ds_read_b64_tr_b16 v[4:5], v24 offset:8192
  ds_read_b64_tr_b16 v[6:7], v24 offset:10240
  s_waitcnt lgkmcnt(8)
  v_mfma_f32_16x16x32_bf16 v[244:247], v[8:11], v[124:127], v[244:247]
  v_mfma_f32_16x16x32_bf16 v[248:251], v[8:11], v[128:131], v[248:251]
  v_mfma_f32_16x16x32_bf16 v[252:255], v[8:11], v[132:135], v[252:255]
  s_waitcnt vmcnt(0)
  ds_read_b64_tr_b16 v[8:9], v21 offset:12288
  ds_read_b64_tr_b16 v[10:11], v21 offset:14336
  s_waitcnt lgkmcnt(8)
  v_mfma_f32_16x16x32_bf16 v[208:211], v[12:15], v[136:139], v[208:211]
  v_mfma_f32_16x16x32_bf16 v[212:215], v[12:15], v[140:143], v[212:215]
  v_mfma_f32_16x16x32_bf16 v[216:219], v[12:15], v[144:147], v[216:219]
  ds_read_b64_tr_b16 v[12:13], v22 offset:12288
  ds_read_b64_tr_b16 v[14:15], v22 offset:14336
  s_waitcnt lgkmcnt(8)
  v_mfma_f32_16x16x32_bf16 v[220:223], v[16:19], v[136:139], v[220:223]
  v_mfma_f32_16x16x32_bf16 v[224:227], v[16:19], v[140:143], v[224:227]
  v_mfma_f32_16x16x32_bf16 v[228:231], v[16:19], v[144:147], v[228:231]
  ds_read_b64_tr_b16 v[16:17], v23 offset:12288
  ds_read_b64_tr_b16 v[18:19], v23 offset:14336
  s_waitcnt lgkmcnt(8)
  v_mfma_f32_16x16x32_bf16 v[232:235], v[0:3], v[136:139], v[232:235]
  v_mfma_f32_16x16x32_bf16 v[236:239], v[0:3], v[140:143], v[236:239]
  v_mfma_f32_16x16x32_bf16 v[240:243], v[0:3], v[144:147], v[240:243]
  ds_read_b64_tr_b16 v[0:1], v24 offset:12288
  ds_read_b64_tr_b16 v[2:3], v24 offset:14336
  s_waitcnt lgkmcnt(8)
  v_mfma_f32_16x16x32_bf16 v[244:247], v[4:7], v[136:139], v[244:247]
  v_mfma_f32_16x16x32_bf16 v[248:251], v[4:7], v[140:143], v[248:251]
  v_mfma_f32_16x16x32_bf16 v[252:255], v[4:7], v[144:147], v[252:255]
  s_waitcnt lgkmcnt(6)
  v_mfma_f32_16x16x32_bf16 v[208:211], v[8:11], v[148:151], v[208:211]
  v_mfma_f32_16x16x32_bf16 v[212:215], v[8:11], v[152:155], v[212:215]
  v_mfma_f32_16x16x32_bf16 v[216:219], v[8:11], v[156:159], v[216:219]
  s_waitcnt lgkmcnt(4)
  v_mfma_f32_16x16x32_bf16 v[220:223], v[12:15], v[148:151], v[220:223]
  v_mfma_f32_16x16x32_bf16 v[224:227], v[12:15], v[152:155], v[224:227]
  v_mfma_f32_16x16x32_bf16 v[228:231], v[12:15], v[156:159], v[228:231]
  s_waitcnt lgkmcnt(2)
  v_mfma_f32_16x16x32_bf16 v[232:235], v[16:19], v[148:151], v[232:235]
  v_mfma_f32_16x16x32_bf16 v[236:239], v[16:19], v[152:155], v[236:239]
  v_mfma_f32_16x16x32_bf16 v[240:243], v[16:19], v[156:159], v[240:243]
  s_waitcnt lgkmcnt(0)
  v_mfma_f32_16x16x32_bf16 v[244:247], v[0:3], v[148:151], v[244:247]
  v_mfma_f32_16x16x32_bf16 v[248:251], v[0:3], v[152:155], v[248:251]
  v_mfma_f32_16x16x32_bf16 v[252:255], v[0:3], v[156:159], v[252:255]
  s_add_u32 m0, s63, 0
  s_add_u32 s67, s45, 2621440
  buffer_load_dwordx4 v20, s[16:19], s67 offen  lds
  s_add_u32 m0, s63, 1024
  s_add_u32 s67, s45, 2686976
  buffer_load_dwordx4 v20, s[16:19], s67 offen  lds
  s_add_u32 m0, s63, 2048
  s_add_u32 s67, s45, 2752512
  buffer_load_dwordx4 v20, s[16:19], s67 offen  lds
  s_add_u32 m0, s63, 3072
  s_add_u32 s67, s45, 2818048
  buffer_load_dwordx4 v20, s[16:19], s67 offen  lds
  s_add_u32 m0, s63, 4096
  s_add_u32 s67, s45, 2883584
  buffer_load_dwordx4 v20, s[16:19], s67 offen  lds
  s_add_u32 m0, s63, 5120
  s_add_u32 s67, s45, 2949120
  buffer_load_dwordx4 v20, s[16:19], s67 offen  lds
  s_add_u32 m0, s63, 6144
  s_add_u32 s67, s45, 3014656
  buffer_load_dwordx4 v20, s[16:19], s67 offen  lds
  s_add_u32 m0, s63, 7168
  s_add_u32 s67, s45, 3080192
  buffer_load_dwordx4 v20, s[16:19], s67 offen  lds
  s_add_u32 m0, s63, 8192
  s_add_u32 s67, s45, 3145728
  buffer_load_dwordx4 v20, s[16:19], s67 offen  lds
  s_add_u32 m0, s63, 9216
  s_add_u32 s67, s45, 3211264
  buffer_load_dwordx4 v20, s[16:19], s67 offen  lds
  s_add_u32 m0, s63, 10240
  s_add_u32 s67, s45, 3276800
  buffer_load_dwordx4 v20, s[16:19], s67 offen  lds
  s_add_u32 m0, s63, 11264
  s_add_u32 s67, s45, 3342336
  buffer_load_dwordx4 v20, s[16:19], s67 offen  lds
  s_add_u32 m0, s63, 12288
  s_add_u32 s67, s45, 3407872
  buffer_load_dwordx4 v20, s[16:19], s67 offen  lds
  s_add_u32 m0, s63, 13312
  s_add_u32 s67, s45, 3473408
  buffer_load_dwordx4 v20, s[16:19], s67 offen  lds
  s_add_u32 m0, s63, 14336
  s_add_u32 s67, s45, 3538944
  buffer_load_dwordx4 v20, s[16:19], s67 offen  lds
  s_add_u32 m0, s63, 15360
  s_add_u32 s67, s45, 3604480
  buffer_load_dwordx4 v20, s[16:19], s67 offen  lds
  s_barrier
  s_waitcnt vmcnt(12)
  ds_read_b64_tr_b16 v[0:1], v21 offset:0
  ds_read_b64_tr_b16 v[2:3], v21 offset:2048
  ds_read_b64_tr_b16 v[4:5], v22 offset:0
  ds_read_b64_tr_b16 v[6:7], v22 offset:2048
  ds_read_b64_tr_b16 v[8:9], v23 offset:0
  ds_read_b64_tr_b16 v[10:11], v23 offset:2048
  ds_read_b64_tr_b16 v[12:13], v24 offset:0
  ds_read_b64_tr_b16 v[14:15], v24 offset:2048
  s_waitcnt vmcnt(8)
  ds_read_b64_tr_b16 v[16:17], v21 offset:4096
  ds_read_b64_tr_b16 v[18:19], v21 offset:6144
  s_waitcnt lgkmcnt(8)
  v_mfma_f32_16x16x32_bf16 v[208:211], v[0:3], v[160:163], v[208:211]
  v_mfma_f32_16x16x32_bf16 v[212:215], v[0:3], v[164:167], v[212:215]
  v_mfma_f32_16x16x32_bf16 v[216:219], v[0:3], v[168:171], v[216:219]
  ds_read_b64_tr_b16 v[0:1], v22 offset:4096
  ds_read_b64_tr_b16 v[2:3], v22 offset:6144
  s_waitcnt lgkmcnt(8)
  v_mfma_f32_16x16x32_bf16 v[220:223], v[4:7], v[160:163], v[220:223]
  v_mfma_f32_16x16x32_bf16 v[224:227], v[4:7], v[164:167], v[224:227]
  v_mfma_f32_16x16x32_bf16 v[228:231], v[4:7], v[168:171], v[228:231]
  ds_read_b64_tr_b16 v[4:5], v23 offset:4096
  ds_read_b64_tr_b16 v[6:7], v23 offset:6144
  s_waitcnt lgkmcnt(8)
  v_mfma_f32_16x16x32_bf16 v[232:235], v[8:11], v[160:163], v[232:235]
  v_mfma_f32_16x16x32_bf16 v[236:239], v[8:11], v[164:167], v[236:239]
  v_mfma_f32_16x16x32_bf16 v[240:243], v[8:11], v[168:171], v[240:243]
  ds_read_b64_tr_b16 v[8:9], v24 offset:4096
  ds_read_b64_tr_b16 v[10:11], v24 offset:6144
  s_waitcnt lgkmcnt(8)
  v_mfma_f32_16x16x32_bf16 v[244:247], v[12:15], v[160:163], v[244:247]
  v_mfma_f32_16x16x32_bf16 v[248:251], v[12:15], v[164:167], v[248:251]
  v_mfma_f32_16x16x32_bf16 v[252:255], v[12:15], v[168:171], v[252:255]
  s_waitcnt vmcnt(4)
  ds_read_b64_tr_b16 v[12:13], v21 offset:8192
  ds_read_b64_tr_b16 v[14:15], v21 offset:10240
  s_waitcnt lgkmcnt(8)
  v_mfma_f32_16x16x32_bf16 v[208:211], v[16:19], v[172:175], v[208:211]
  v_mfma_f32_16x16x32_bf16 v[212:215], v[16:19], v[176:179], v[212:215]
  v_mfma_f32_16x16x32_bf16 v[216:219], v[16:19], v[180:183], v[216:219]
  ds_read_b64_tr_b16 v[16:17], v22 offset:8192
  ds_read_b64_tr_b16 v[18:19], v22 offset:10240
  s_waitcnt lgkmcnt(8)
  v_mfma_f32_16x16x32_bf16 v[220:223], v[0:3], v[172:175], v[220:223]
  v_mfma_f32_16x16x32_bf16 v[224:227], v[0:3], v[176:179], v[224:227]
  v_mfma_f32_16x16x32_bf16 v[228:231], v[0:3], v[180:183], v[228:231]
  ds_read_b64_tr_b16 v[0:1], v23 offset:8192
  ds_read_b64_tr_b16 v[2:3], v23 offset:10240
  s_waitcnt lgkmcnt(8)
  v_mfma_f32_16x16x32_bf16 v[232:235], v[4:7], v[172:175], v[232:235]
  v_mfma_f32_16x16x32_bf16 v[236:239], v[4:7], v[176:179], v[236:239]
  v_mfma_f32_16x16x32_bf16 v[240:243], v[4:7], v[180:183], v[240:243]
  ds_read_b64_tr_b16 v[4:5], v24 offset:8192
  ds_read_b64_tr_b16 v[6:7], v24 offset:10240
  s_waitcnt lgkmcnt(8)
  v_mfma_f32_16x16x32_bf16 v[244:247], v[8:11], v[172:175], v[244:247]
  v_mfma_f32_16x16x32_bf16 v[248:251], v[8:11], v[176:179], v[248:251]
  v_mfma_f32_16x16x32_bf16 v[252:255], v[8:11], v[180:183], v[252:255]
  s_waitcnt vmcnt(0)
  ds_read_b64_tr_b16 v[8:9], v21 offset:12288
  ds_read_b64_tr_b16 v[10:11], v21 offset:14336
  s_waitcnt lgkmcnt(8)
  v_mfma_f32_16x16x32_bf16 v[208:211], v[12:15], v[184:187], v[208:211]
  v_mfma_f32_16x16x32_bf16 v[212:215], v[12:15], v[188:191], v[212:215]
  v_mfma_f32_16x16x32_bf16 v[216:219], v[12:15], v[192:195], v[216:219]
  ds_read_b64_tr_b16 v[12:13], v22 offset:12288
  ds_read_b64_tr_b16 v[14:15], v22 offset:14336
  s_waitcnt lgkmcnt(8)
  v_mfma_f32_16x16x32_bf16 v[220:223], v[16:19], v[184:187], v[220:223]
  v_mfma_f32_16x16x32_bf16 v[224:227], v[16:19], v[188:191], v[224:227]
  v_mfma_f32_16x16x32_bf16 v[228:231], v[16:19], v[192:195], v[228:231]
  ds_read_b64_tr_b16 v[16:17], v23 offset:12288
  ds_read_b64_tr_b16 v[18:19], v23 offset:14336
  s_waitcnt lgkmcnt(8)
  v_mfma_f32_16x16x32_bf16 v[232:235], v[0:3], v[184:187], v[232:235]
  v_mfma_f32_16x16x32_bf16 v[236:239], v[0:3], v[188:191], v[236:239]
  v_mfma_f32_16x16x32_bf16 v[240:243], v[0:3], v[192:195], v[240:243]
  ds_read_b64_tr_b16 v[0:1], v24 offset:12288
  ds_read_b64_tr_b16 v[2:3], v24 offset:14336
  s_waitcnt lgkmcnt(8)
  v_mfma_f32_16x16x32_bf16 v[244:247], v[4:7], v[184:187], v[244:247]
  v_mfma_f32_16x16x32_bf16 v[248:251], v[4:7], v[188:191], v[248:251]
  v_mfma_f32_16x16x32_bf16 v[252:255], v[4:7], v[192:195], v[252:255]
  s_waitcnt lgkmcnt(6)
  v_mfma_f32_16x16x32_bf16 v[208:211], v[8:11], v[196:199], v[208:211]
  v_mfma_f32_16x16x32_bf16 v[212:215], v[8:11], v[200:203], v[212:215]
  v_mfma_f32_16x16x32_bf16 v[216:219], v[8:11], v[204:207], v[216:219]
  s_waitcnt lgkmcnt(4)
  v_mfma_f32_16x16x32_bf16 v[220:223], v[12:15], v[196:199], v[220:223]
  v_mfma_f32_16x16x32_bf16 v[224:227], v[12:15], v[200:203], v[224:227]
  v_mfma_f32_16x16x32_bf16 v[228:231], v[12:15], v[204:207], v[228:231]
  s_waitcnt lgkmcnt(2)
  v_mfma_f32_16x16x32_bf16 v[232:235], v[16:19], v[196:199], v[232:235]
  v_mfma_f32_16x16x32_bf16 v[236:239], v[16:19], v[200:203], v[236:239]
  v_mfma_f32_16x16x32_bf16 v[240:243], v[16:19], v[204:207], v[240:243]
  s_waitcnt lgkmcnt(0)
  v_mfma_f32_16x16x32_bf16 v[244:247], v[0:3], v[196:199], v[244:247]
  v_mfma_f32_16x16x32_bf16 v[248:251], v[0:3], v[200:203], v[248:251]
  v_mfma_f32_16x16x32_bf16 v[252:255], v[0:3], v[204:207], v[252:255]
  v_xor_b32 v34, 0, v25
  v_cvt_pk_bf16_f32 v26, v208, v209
  v_cvt_pk_bf16_f32 v27, v210, v211
  ds_write_b64 v34, v[26:27] offset:0
  v_cvt_pk_bf16_f32 v28, v212, v213
  v_cvt_pk_bf16_f32 v29, v214, v215
  ds_write_b64 v34, v[28:29] offset:2048
  v_cvt_pk_bf16_f32 v30, v216, v217
  v_cvt_pk_bf16_f32 v31, v218, v219
  ds_write_b64 v34, v[30:31] offset:4096
  v_xor_b32 v34, 32, v25
  v_cvt_pk_bf16_f32 v32, v220, v221
  v_cvt_pk_bf16_f32 v33, v222, v223
  ds_write_b64 v34, v[32:33] offset:0
  v_cvt_pk_bf16_f32 v26, v224, v225
  v_cvt_pk_bf16_f32 v27, v226, v227
  ds_write_b64 v34, v[26:27] offset:2048
  v_cvt_pk_bf16_f32 v28, v228, v229
  v_cvt_pk_bf16_f32 v29, v230, v231
  ds_write_b64 v34, v[28:29] offset:4096
  v_xor_b32 v34, 64, v25
  v_cvt_pk_bf16_f32 v30, v232, v233
  v_cvt_pk_bf16_f32 v31, v234, v235
  ds_write_b64 v34, v[30:31] offset:0
  v_cvt_pk_bf16_f32 v32, v236, v237
  v_cvt_pk_bf16_f32 v33, v238, v239
  ds_write_b64 v34, v[32:33] offset:2048
  v_cvt_pk_bf16_f32 v26, v240, v241
  v_cvt_pk_bf16_f32 v27, v242, v243
  ds_write_b64 v34, v[26:27] offset:4096
  v_xor_b32 v34, 96, v25
  v_cvt_pk_bf16_f32 v28, v244, v245
  v_cvt_pk_bf16_f32 v29, v246, v247
  ds_write_b64 v34, v[28:29] offset:0
  v_cvt_pk_bf16_f32 v30, v248, v249
  v_cvt_pk_bf16_f32 v31, v250, v251
  ds_write_b64 v34, v[30:31] offset:2048
  v_cvt_pk_bf16_f32 v32, v252, v253
  v_cvt_pk_bf16_f32 v33, v254, v255
  ds_write_b64 v34, v[32:33] offset:4096
  s_waitcnt lgkmcnt(0)
  s_barrier
  s_setprio 0
  s_cmp_eq_u32 s4, 3
  s_cbranch_scc1 L_P3
  s_lshl_b32 s62, s4, 13
  v_mbcnt_lo_u32_b32 v48, -1, 0
  v_mbcnt_hi_u32_b32 v48, -1, v48
  v_lshrrev_b32 v50, 4, v48
  v_lshrrev_b32 v51, 3, v48
  v_lshlrev_b32 v51, 9, v51
  s_lshl_b32 s67, s4, 15
  v_add_u32 v51, s67, v51
  v_and_b32 v52, 7, v48
  v_xor_b32 v53, v52, v50
  v_lshl_add_u32 v44, v53, 4, v51
  v_xor_b32 v53, 4, v53
  v_lshl_add_u32 v45, v53, 4, v51
  v_lshrrev_b32 v53, 1, v52
  v_xor_b32 v53, v53, v50
  v_lshl_add_u32 v53, v53, 5, v51
  v_and_b32 v52, 1, v48
  v_lshl_add_u32 v46, v52, 4, v53
  v_lshlrev_b32 v56, 7, v48
  s_add_u32 m0, s62, 65536
  s_add_u32 s67, s39, 0
  buffer_load_dwordx4 v44, s[8:11], s67 offen nt lds
  s_add_u32 m0, s62, 66560
  s_add_u32 s67, s39, 4096
  buffer_load_dwordx4 v45, s[8:11], s67 offen nt lds
  s_add_u32 m0, s62, 67584
  s_add_u32 s67, s39, 8192
  buffer_load_dwordx4 v44, s[8:11], s67 offen nt lds
  s_add_u32 m0, s62, 68608
  s_add_u32 s67, s39, 12288
  buffer_load_dwordx4 v45, s[8:11], s67 offen nt lds
  s_add_u32 m0, s62, 69632
  s_add_u32 s67, s39, 16384
  buffer_load_dwordx4 v44, s[8:11], s67 offen nt lds
  s_add_u32 m0, s62, 70656
  s_add_u32 s67, s39, 20480
  buffer_load_dwordx4 v45, s[8:11], s67 offen nt lds
  s_add_u32 m0, s62, 71680
  s_add_u32 s67, s39, 24576
  buffer_load_dwordx4 v44, s[8:11], s67 offen nt lds
  s_add_u32 m0, s62, 72704
  s_add_u32 s67, s39, 28672
  buffer_load_dwordx4 v45, s[8:11], s67 offen nt lds
  v_mbcnt_lo_u32_b32 v48, -1, 0
  v_mbcnt_hi_u32_b32 v48, -1, v48
  v_and_b32 v49, 15, v48
  v_lshrrev_b32 v50, 4, v48
  s_lshl_b32 s66, s4, 8
  v_bfe_u32 v51, v48, 1, 3
  v_xor_b32 v51, v51, v50
  s_mov_b32 s67, 896
  v_mul_lo_u32 v52, s67, v50
  v_and_b32 v53, 1, v48
  v_lshl_add_u32 v52, v53, 4, v52
  v_add_u32 v52, s66, v52
  v_lshl_add_u32 v32, v51, 5, v52
  v_xor_b32 v51, 4, v51
  v_lshl_add_u32 v33, v51, 5, v52
  v_lshrrev_b32 v51, 2, v48
  v_and_b32 v52, 7, v51
  v_lshlrev_b32 v53, 8, v51
  v_and_b32 v54, 3, v48
  v_lshl_add_u32 v53, v54, 3, v53
  s_lshl_b32 s67, s4, 13
  v_xor_b32 v54, 0, v52
  v_lshl_add_u32 v55, v54, 5, v53
  v_add_u32 v34, s63, v55
  v_add_u32 v208, s67, v55
  v_xor_b32 v54, 1, v52
  v_lshl_add_u32 v55, v54, 5, v53
  v_add_u32 v35, s63, v55
  v_add_u32 v209, s67, v55
  v_xor_b32 v54, 2, v52
  v_lshl_add_u32 v55, v54, 5, v53
  v_add_u32 v36, s63, v55
  v_add_u32 v210, s67, v55
  v_xor_b32 v54, 3, v52
  v_lshl_add_u32 v55, v54, 5, v53
  v_add_u32 v37, s63, v55
  v_add_u32 v211, s67, v55
  v_xor_b32 v54, 4, v52
  v_lshl_add_u32 v55, v54, 5, v53
  v_add_u32 v38, s63, v55
  v_add_u32 v212, s67, v55
  v_xor_b32 v54, 5, v52
  v_lshl_add_u32 v55, v54, 5, v53
  v_add_u32 v39, s63, v55
  v_add_u32 v213, s67, v55
  v_xor_b32 v54, 6, v52
  v_lshl_add_u32 v55, v54, 5, v53
  v_add_u32 v40, s63, v55
  v_add_u32 v214, s67, v55
  v_xor_b32 v54, 7, v52
  v_lshl_add_u32 v55, v54, 5, v53
  v_add_u32 v41, s63, v55
  v_add_u32 v215, s67, v55
  v_lshrrev_b32 v51, 1, v49
  v_xor_b32 v51, v50, v51
  v_lshlrev_b32 v52, 7, v49
  v_add_u32 v52, 122880, v52
  v_lshl_add_u32 v42, v51, 4, v52
  v_xor_b32 v51, 4, v51
  v_lshl_add_u32 v43, v51, 4, v52
  s_lshl_b32 s62, s4, 13
  s_barrier
  s_add_u32 m0, s62, 98304
  s_add_u32 s67, s39, 131072
  buffer_load_dwordx4 v44, s[8:11], s67 offen nt lds
  s_add_u32 m0, s62, 99328
  s_add_u32 s67, s39, 135168
  buffer_load_dwordx4 v45, s[8:11], s67 offen nt lds
  s_add_u32 m0, s62, 100352
  s_add_u32 s67, s39, 139264
  buffer_load_dwordx4 v44, s[8:11], s67 offen nt lds
  s_add_u32 m0, s62, 101376
  s_add_u32 s67, s39, 143360
  buffer_load_dwordx4 v45, s[8:11], s67 offen nt lds
  s_add_u32 m0, s62, 102400
  s_add_u32 s67, s39, 147456
  buffer_load_dwordx4 v44, s[8:11], s67 offen nt lds
  s_add_u32 m0, s62, 103424
  s_add_u32 s67, s39, 151552
  buffer_load_dwordx4 v45, s[8:11], s67 offen nt lds
  s_add_u32 m0, s62, 104448
  s_add_u32 s67, s39, 155648
  buffer_load_dwordx4 v44, s[8:11], s67 offen nt lds
  s_add_u32 m0, s62, 105472
  s_add_u32 s67, s39, 159744
  buffer_load_dwordx4 v45, s[8:11], s67 offen nt lds
  s_waitcnt vmcnt(8)
  s_barrier
  s_add_u32 m0, s62, 0
  s_add_u32 s67, s36, 0
  buffer_load_dwordx4 v46, s[12:15], s67 offen nt lds
  s_add_u32 m0, s62, 1024
  s_add_u32 s67, s36, 4096
  buffer_load_dwordx4 v46, s[12:15], s67 offen nt lds
  s_add_u32 m0, s62, 2048
  s_add_u32 s67, s36, 8192
  buffer_load_dwordx4 v46, s[12:15], s67 offen nt lds
  s_add_u32 m0, s62, 3072
  s_add_u32 s67, s36, 12288
  buffer_load_dwordx4 v46, s[12:15], s67 offen nt lds
  s_add_u32 m0, s62, 4096
  s_add_u32 s67, s36, 16384
  buffer_load_dwordx4 v46, s[12:15], s67 offen nt lds
  s_add_u32 m0, s62, 5120
  s_add_u32 s67, s36, 20480
  buffer_load_dwordx4 v46, s[12:15], s67 offen nt lds
  s_add_u32 m0, s62, 6144
  s_add_u32 s67, s36, 24576
  buffer_load_dwordx4 v46, s[12:15], s67 offen nt lds
  s_add_u32 m0, s62, 7168
  s_add_u32 s67, s36, 28672
  buffer_load_dwordx4 v46, s[12:15], s67 offen nt lds
  s_waitcnt vmcnt(8)
  s_barrier
  s_add_u32 m0, s62, 32768
  s_add_u32 s67, s36, 131072
  buffer_load_dwordx4 v46, s[12:15], s67 offen nt lds
  s_add_u32 m0, s62, 33792
  s_add_u32 s67, s36, 135168
  buffer_load_dwordx4 v46, s[12:15], s67 offen nt lds
  s_add_u32 m0, s62, 34816
  s_add_u32 s67, s36, 139264
  buffer_load_dwordx4 v46, s[12:15], s67 offen nt lds
  s_add_u32 m0, s62, 35840
  s_add_u32 s67, s36, 143360
  buffer_load_dwordx4 v46, s[12:15], s67 offen nt lds
  s_add_u32 m0, s62, 36864
  s_add_u32 s67, s36, 147456
  buffer_load_dwordx4 v46, s[12:15], s67 offen nt lds
  s_add_u32 m0, s62, 37888
  s_add_u32 s67, s36, 151552
  buffer_load_dwordx4 v46, s[12:15], s67 offen nt lds
  s_add_u32 m0, s62, 38912
  s_add_u32 s67, s36, 155648
  buffer_load_dwordx4 v46, s[12:15], s67 offen nt lds
  s_add_u32 m0, s62, 39936
  s_add_u32 s67, s36, 159744
  buffer_load_dwordx4 v46, s[12:15], s67 offen nt lds
  s_mul_i32 s68, s6, 28672
  s_lshl_b32 s69, s4, 13
  s_add_u32 s68, s68, s69
  s_cmp_eq_u32 s4, 3
  s_cselect_b32 exec_hi, 0, -1
  buffer_load_dword v57, v56, s[20:23], s68 offen
  s_mov_b32 exec_hi, -1
  s_lshl_b32 s66, s6, 4
  s_lshl_b32 s67, s7, 2
  s_add_u32 s66, s66, s67
  s_mul_i32 s66, s66, 43008
  v_mov_b32 v58, s66
  s_add_u32 s67, s66, 516092
  v_writelane_b32 v58, s67, 1
  s_mul_i32 s67, s2, 43008
  v_writelane_b32 v58, s67, 2
  s_mul_i32 s67, s76, 8448
  s_add_u32 s67, s67, 16777216
  v_writelane_b32 v58, s67, 3
  s_mul_i32 s68, s6, 86016
  s_mov_b64 s[70:71], exec
  s_mov_b64 exec, 0xf
  buffer_load_dword v59, v58, s[32:35], 0 offen sc0 sc1
  s_mov_b64 exec, 1
  v_mov_b32 v60, 0
  buffer_load_dword v59, v60, s[28:31], s68 offen sc0 sc1
  s_mov_b64 exec, s[70:71]
  s_waitcnt vmcnt(11)
  s_barrier
  s_waitcnt vmcnt(3)
  s_barrier
  s_add_u32 m0, s62, 0
  s_add_u32 s67, s37, 0
  buffer_load_dwordx4 v46, s[12:15], s67 offen nt lds
  s_add_u32 m0, s62, 1024
  s_add_u32 s67, s37, 4096
  buffer_load_dwordx4 v46, s[12:15], s67 offen nt lds
  s_add_u32 m0, s62, 2048
  s_add_u32 s67, s37, 8192
  buffer_load_dwordx4 v46, s[12:15], s67 offen nt lds
  s_add_u32 m0, s62, 3072
  s_add_u32 s67, s37, 12288
  buffer_load_dwordx4 v46, s[12:15], s67 offen nt lds
  s_add_u32 m0, s62, 4096
  s_add_u32 s67, s37, 16384
  buffer_load_dwordx4 v46, s[12:15], s67 offen nt lds
  s_add_u32 m0, s62, 5120
  s_add_u32 s67, s37, 20480
  buffer_load_dwordx4 v46, s[12:15], s67 offen nt lds
  s_add_u32 m0, s62, 6144
  s_add_u32 s67, s37, 24576
  buffer_load_dwordx4 v46, s[12:15], s67 offen nt lds
  s_add_u32 m0, s62, 7168
  s_add_u32 s67, s37, 28672
  buffer_load_dwordx4 v46, s[12:15], s67 offen nt lds
  s_add_u32 m0, s63, 0
  s_add_u32 s67, s40, 0
  buffer_load_dwordx4 v32, s[20:23], s67 offen  lds
  s_add_u32 m0, s63, 1024
  s_add_u32 s67, s40, 3584
  buffer_load_dwordx4 v33, s[20:23], s67 offen  lds
  s_add_u32 m0, s63, 2048
  s_add_u32 s67, s40, 7168
  buffer_load_dwordx4 v32, s[20:23], s67 offen  lds
  s_add_u32 m0, s63, 3072
  s_add_u32 s67, s40, 10752
  buffer_load_dwordx4 v33, s[20:23], s67 offen  lds
  s_add_u32 m0, s63, 4096
  s_add_u32 s67, s40, 14336
  buffer_load_dwordx4 v32, s[20:23], s67 offen  lds
  s_add_u32 m0, s63, 5120
  s_add_u32 s67, s40, 17920
  buffer_load_dwordx4 v33, s[20:23], s67 offen  lds
  s_add_u32 m0, s63, 6144
  s_add_u32 s67, s40, 21504
  buffer_load_dwordx4 v32, s[20:23], s67 offen  lds
  s_add_u32 m0, s63, 7168
  s_add_u32 s67, s40, 25088
  buffer_load_dwordx4 v33, s[20:23], s67 offen  lds
  s_add_u32 m0, s63, 8192
  s_add_u32 s67, s40, 28672
  buffer_load_dwordx4 v32, s[20:23], s67 offen  lds
  s_add_u32 m0, s63, 9216
  s_add_u32 s67, s40, 32256
  buffer_load_dwordx4 v33, s[20:23], s67 offen  lds
  s_add_u32 m0, s63, 10240
  s_add_u32 s67, s40, 35840
  buffer_load_dwordx4 v32, s[20:23], s67 offen  lds
  s_add_u32 m0, s63, 11264
  s_add_u32 s67, s40, 39424
  buffer_load_dwordx4 v33, s[20:23], s67 offen  lds
  s_add_u32 m0, s63, 12288
  s_add_u32 s67, s40, 43008
  buffer_load_dwordx4 v32, s[20:23], s67 offen  lds
  s_add_u32 m0, s63, 13312
  s_add_u32 s67, s40, 46592
  buffer_load_dwordx4 v33, s[20:23], s67 offen  lds
  s_add_u32 m0, s63, 14336
  s_add_u32 s67, s40, 50176
  buffer_load_dwordx4 v32, s[20:23], s67 offen  lds
  s_add_u32 m0, s63, 15360
  s_add_u32 s67, s40, 53760
  buffer_load_dwordx4 v33, s[20:23], s67 offen  lds
  s_waitcnt vmcnt(16)
  s_barrier
  s_add_u32 m0, s62, 32768
  s_add_u32 s67, s37, 131072
  buffer_load_dwordx4 v46, s[12:15], s67 offen nt lds
  s_add_u32 m0, s62, 33792
  s_add_u32 s67, s37, 135168
  buffer_load_dwordx4 v46, s[12:15], s67 offen nt lds
  s_add_u32 m0, s62, 34816
  s_add_u32 s67, s37, 139264
  buffer_load_dwordx4 v46, s[12:15], s67 offen nt lds
  s_add_u32 m0, s62, 35840
  s_add_u32 s67, s37, 143360
  buffer_load_dwordx4 v46, s[12:15], s67 offen nt lds
  s_add_u32 m0, s62, 36864
  s_add_u32 s67, s37, 147456
  buffer_load_dwordx4 v46, s[12:15], s67 offen nt lds
  s_add_u32 m0, s62, 37888
  s_add_u32 s67, s37, 151552
  buffer_load_dwordx4 v46, s[12:15], s67 offen nt lds
  s_add_u32 m0, s62, 38912
  s_add_u32 s67, s37, 155648
  buffer_load_dwordx4 v46, s[12:15], s67 offen nt lds
  s_add_u32 m0, s62, 39936
  s_add_u32 s67, s37, 159744
  buffer_load_dwordx4 v46, s[12:15], s67 offen nt lds
  s_setprio 1
  ds_read_b128 v[160:163], v42 offset:0
  ds_read_b128 v[164:167], v42 offset:2048
  ds_read_b128 v[168:171], v42 offset:4096
  s_waitcnt vmcnt(16)
  ds_read_b64_tr_b16 v[0:1], v34 offset:0
  ds_read_b64_tr_b16 v[2:3], v34 offset:4096
  ds_read_b64_tr_b16 v[4:5], v35 offset:0
  ds_read_b64_tr_b16 v[6:7], v35 offset:4096
  ds_read_b64_tr_b16 v[8:9], v36 offset:0
  ds_read_b64_tr_b16 v[10:11], v36 offset:4096
  ds_read_b64_tr_b16 v[12:13], v37 offset:0
  ds_read_b64_tr_b16 v[14:15], v37 offset:4096
  ds_read_b64_tr_b16 v[16:17], v38 offset:0
  ds_read_b64_tr_b16 v[18:19], v38 offset:4096
  ds_read_b128 v[172:175], v43 offset:0
  ds_read_b128 v[176:179], v43 offset:2048
  s_waitcnt lgkmcnt(14)
  ds_read_b128 v[180:183], v43 offset:4096
  s_waitcnt lgkmcnt(11)
  v_mfma_f32_16x16x32_bf16 v[64:67], v[0:3], v[160:163], 0
  v_mfma_f32_16x16x32_bf16 v[68:71], v[0:3], v[164:167], 0
  v_mfma_f32_16x16x32_bf16 v[72:75], v[0:3], v[168:171], 0
  ds_read_b64_tr_b16 v[0:1], v39 offset:0
  ds_read_b64_tr_b16 v[2:3], v39 offset:4096
  ds_read_b128 v[184:187], v42 offset:6144
  ds_read_b128 v[188:191], v42 offset:8192
  s_waitcnt lgkmcnt(14)
  ds_read_b128 v[192:195], v42 offset:10240
  s_waitcnt lgkmcnt(14)
  v_mfma_f32_16x16x32_bf16 v[76:79], v[4:7], v[160:163], 0
  v_mfma_f32_16x16x32_bf16 v[80:83], v[4:7], v[164:167], 0
  v_mfma_f32_16x16x32_bf16 v[84:87], v[4:7], v[168:171], 0
  s_waitcnt lgkmcnt(13)
  ds_read_b64_tr_b16 v[4:5], v40 offset:0
  ds_read_b64_tr_b16 v[6:7], v40 offset:4096
  s_waitcnt lgkmcnt(14)
  ds_read_b128 v[196:199], v43 offset:6144
  s_waitcnt lgkmcnt(14)
  ds_read_b128 v[200:203], v43 offset:8192
  s_waitcnt lgkmcnt(14)
  ds_read_b128 v[204:207], v43 offset:10240
  v_mfma_f32_16x16x32_bf16 v[88:91], v[8:11], v[160:163], 0
  v_mfma_f32_16x16x32_bf16 v[92:95], v[8:11], v[164:167], 0
  v_mfma_f32_16x16x32_bf16 v[96:99], v[8:11], v[168:171], 0
  s_waitcnt lgkmcnt(13)
  ds_read_b64_tr_b16 v[8:9], v41 offset:0
  ds_read_b64_tr_b16 v[10:11], v41 offset:4096
  v_mfma_f32_16x16x32_bf16 v[100:103], v[12:15], v[160:163], 0
  v_mfma_f32_16x16x32_bf16 v[104:107], v[12:15], v[164:167], 0
  v_mfma_f32_16x16x32_bf16 v[108:111], v[12:15], v[168:171], 0
  s_waitcnt vmcnt(8)
  s_waitcnt lgkmcnt(13)
  ds_read_b64_tr_b16 v[12:13], v34 offset:8192
  ds_read_b64_tr_b16 v[14:15], v34 offset:12288
  v_mfma_f32_16x16x32_bf16 v[112:115], v[16:19], v[160:163], 0
  v_mfma_f32_16x16x32_bf16 v[116:119], v[16:19], v[164:167], 0
  v_mfma_f32_16x16x32_bf16 v[120:123], v[16:19], v[168:171], 0
  s_waitcnt lgkmcnt(13)
  ds_read_b64_tr_b16 v[16:17], v35 offset:8192
  ds_read_b64_tr_b16 v[18:19], v35 offset:12288
  s_waitcnt lgkmcnt(14)
  v_mfma_f32_16x16x32_bf16 v[124:127], v[0:3], v[160:163], 0
  v_mfma_f32_16x16x32_bf16 v[128:131], v[0:3], v[164:167], 0
  v_mfma_f32_16x16x32_bf16 v[132:135], v[0:3], v[168:171], 0
  s_waitcnt lgkmcnt(13)
  ds_read_b64_tr_b16 v[0:1], v36 offset:8192
  ds_read_b64_tr_b16 v[2:3], v36 offset:12288
  s_waitcnt lgkmcnt(11)
  v_mfma_f32_16x16x32_bf16 v[136:139], v[4:7], v[160:163], 0
  v_mfma_f32_16x16x32_bf16 v[140:143], v[4:7], v[164:167], 0
  v_mfma_f32_16x16x32_bf16 v[144:147], v[4:7], v[168:171], 0
  ds_read_b64_tr_b16 v[4:5], v37 offset:8192
  ds_read_b64_tr_b16 v[6:7], v37 offset:12288
  s_waitcnt lgkmcnt(8)
  v_mfma_f32_16x16x32_bf16 v[148:151], v[8:11], v[160:163], 0
  v_mfma_f32_16x16x32_bf16 v[152:155], v[8:11], v[164:167], 0
  v_mfma_f32_16x16x32_bf16 v[156:159], v[8:11], v[168:171], 0
  ds_read_b64_tr_b16 v[8:9], v38 offset:8192
  ds_read_b64_tr_b16 v[10:11], v38 offset:12288
  s_waitcnt lgkmcnt(8)
  v_mfma_f32_16x16x32_bf16 v[64:67], v[12:15], v[172:175], v[64:67]
  v_mfma_f32_16x16x32_bf16 v[68:71], v[12:15], v[176:179], v[68:71]
  v_mfma_f32_16x16x32_bf16 v[72:75], v[12:15], v[180:183], v[72:75]
  ds_read_b64_tr_b16 v[12:13], v39 offset:8192
  ds_read_b64_tr_b16 v[14:15], v39 offset:12288
  s_waitcnt lgkmcnt(8)
  v_mfma_f32_16x16x32_bf16 v[76:79], v[16:19], v[172:175], v[76:79]
  v_mfma_f32_16x16x32_bf16 v[80:83], v[16:19], v[176:179], v[80:83]
  v_mfma_f32_16x16x32_bf16 v[84:87], v[16:19], v[180:183], v[84:87]
  ds_read_b64_tr_b16 v[16:17], v40 offset:8192
  ds_read_b64_tr_b16 v[18:19], v40 offset:12288
  s_waitcnt lgkmcnt(8)
  v_mfma_f32_16x16x32_bf16 v[88:91], v[0:3], v[172:175], v[88:91]
  v_mfma_f32_16x16x32_bf16 v[92:95], v[0:3], v[176:179], v[92:95]
  v_mfma_f32_16x16x32_bf16 v[96:99], v[0:3], v[180:183], v[96:99]
  ds_read_b64_tr_b16 v[0:1], v41 offset:8192
  ds_read_b64_tr_b16 v[2:3], v41 offset:12288
  s_waitcnt lgkmcnt(8)
  v_mfma_f32_16x16x32_bf16 v[100:103], v[4:7], v[172:175], v[100:103]
  v_mfma_f32_16x16x32_bf16 v[104:107], v[4:7], v[176:179], v[104:107]
  v_mfma_f32_16x16x32_bf16 v[108:111], v[4:7], v[180:183], v[108:111]
  s_waitcnt lgkmcnt(6)
  v_mfma_f32_16x16x32_bf16 v[112:115], v[8:11], v[172:175], v[112:115]
  v_mfma_f32_16x16x32_bf16 v[116:119], v[8:11], v[176:179], v[116:119]
  v_mfma_f32_16x16x32_bf16 v[120:123], v[8:11], v[180:183], v[120:123]
  s_waitcnt lgkmcnt(4)
  v_mfma_f32_16x16x32_bf16 v[124:127], v[12:15], v[172:175], v[124:127]
  v_mfma_f32_16x16x32_bf16 v[128:131], v[12:15], v[176:179], v[128:131]
  v_mfma_f32_16x16x32_bf16 v[132:135], v[12:15], v[180:183], v[132:135]
  s_waitcnt lgkmcnt(2)
  v_mfma_f32_16x16x32_bf16 v[136:139], v[16:19], v[172:175], v[136:139]
  v_mfma_f32_16x16x32_bf16 v[140:143], v[16:19], v[176:179], v[140:143]
  v_mfma_f32_16x16x32_bf16 v[144:147], v[16:19], v[180:183], v[144:147]
  s_waitcnt lgkmcnt(0)
  v_mfma_f32_16x16x32_bf16 v[148:151], v[0:3], v[172:175], v[148:151]
  v_mfma_f32_16x16x32_bf16 v[152:155], v[0:3], v[176:179], v[152:155]
  v_mfma_f32_16x16x32_bf16 v[156:159], v[0:3], v[180:183], v[156:159]
  s_add_u32 m0, s63, 0
  s_add_u32 s67, s40, 229376
  buffer_load_dwordx4 v32, s[20:23], s67 offen  lds
  s_add_u32 m0, s63, 1024
  s_add_u32 s67, s40, 232960
  buffer_load_dwordx4 v33, s[20:23], s67 offen  lds
  s_add_u32 m0, s63, 2048
  s_add_u32 s67, s40, 236544
  buffer_load_dwordx4 v32, s[20:23], s67 offen  lds
  s_add_u32 m0, s63, 3072
  s_add_u32 s67, s40, 240128
  buffer_load_dwordx4 v33, s[20:23], s67 offen  lds
  s_add_u32 m0, s63, 4096
  s_add_u32 s67, s40, 243712
  buffer_load_dwordx4 v32, s[20:23], s67 offen  lds
  s_add_u32 m0, s63, 5120
  s_add_u32 s67, s40, 247296
  buffer_load_dwordx4 v33, s[20:23], s67 offen  lds
  s_add_u32 m0, s63, 6144
  s_add_u32 s67, s40, 250880
  buffer_load_dwordx4 v32, s[20:23], s67 offen  lds
  s_add_u32 m0, s63, 7168
  s_add_u32 s67, s40, 254464
  buffer_load_dwordx4 v33, s[20:23], s67 offen  lds
  s_add_u32 m0, s63, 8192
  s_add_u32 s67, s40, 258048
  buffer_load_dwordx4 v32, s[20:23], s67 offen  lds
  s_add_u32 m0, s63, 9216
  s_add_u32 s67, s40, 261632
  buffer_load_dwordx4 v33, s[20:23], s67 offen  lds
  s_add_u32 m0, s63, 10240
  s_add_u32 s67, s40, 265216
  buffer_load_dwordx4 v32, s[20:23], s67 offen  lds
  s_add_u32 m0, s63, 11264
  s_add_u32 s67, s40, 268800
  buffer_load_dwordx4 v33, s[20:23], s67 offen  lds
  s_add_u32 m0, s63, 12288
  s_add_u32 s67, s40, 272384
  buffer_load_dwordx4 v32, s[20:23], s67 offen  lds
  s_add_u32 m0, s63, 13312
  s_add_u32 s67, s40, 275968
  buffer_load_dwordx4 v33, s[20:23], s67 offen  lds
  s_add_u32 m0, s63, 14336
  s_add_u32 s67, s40, 279552
  buffer_load_dwordx4 v32, s[20:23], s67 offen  lds
  s_add_u32 m0, s63, 15360
  s_add_u32 s67, s40, 283136
  buffer_load_dwordx4 v33, s[20:23], s67 offen  lds
  s_waitcnt vmcnt(16)
  s_barrier
  s_add_u32 m0, s62, 0
  s_add_u32 s67, s38, 0
  buffer_load_dwordx4 v46, s[12:15], s67 offen nt lds
  s_add_u32 m0, s62, 1024
  s_add_u32 s67, s38, 4096
  buffer_load_dwordx4 v46, s[12:15], s67 offen nt lds
  s_add_u32 m0, s62, 2048
  s_add_u32 s67, s38, 8192
  buffer_load_dwordx4 v46, s[12:15], s67 offen nt lds
  s_add_u32 m0, s62, 3072
  s_add_u32 s67, s38, 12288
  buffer_load_dwordx4 v46, s[12:15], s67 offen nt lds
  s_add_u32 m0, s62, 4096
  s_add_u32 s67, s38, 16384
  buffer_load_dwordx4 v46, s[12:15], s67 offen nt lds
  s_add_u32 m0, s62, 5120
  s_add_u32 s67, s38, 20480
  buffer_load_dwordx4 v46, s[12:15], s67 offen nt lds
  s_add_u32 m0, s62, 6144
  s_add_u32 s67, s38, 24576
  buffer_load_dwordx4 v46, s[12:15], s67 offen nt lds
  s_add_u32 m0, s62, 7168
  s_add_u32 s67, s38, 28672
  buffer_load_dwordx4 v46, s[12:15], s67 offen nt lds
  s_waitcnt vmcnt(16)
  ds_read_b64_tr_b16 v[0:1], v34 offset:0
  ds_read_b64_tr_b16 v[2:3], v34 offset:4096
  ds_read_b64_tr_b16 v[4:5], v35 offset:0
  ds_read_b64_tr_b16 v[6:7], v35 offset:4096
  ds_read_b64_tr_b16 v[8:9], v36 offset:0
  ds_read_b64_tr_b16 v[10:11], v36 offset:4096
  ds_read_b64_tr_b16 v[12:13], v37 offset:0
  ds_read_b64_tr_b16 v[14:15], v37 offset:4096
  ds_read_b64_tr_b16 v[16:17], v38 offset:0
  ds_read_b64_tr_b16 v[18:19], v38 offset:4096
  s_waitcnt lgkmcnt(8)
  v_mfma_f32_16x16x32_bf16 v[64:67], v[0:3], v[184:187], v[64:67]
  v_mfma_f32_16x16x32_bf16 v[68:71], v[0:3], v[188:191], v[68:71]
  v_mfma_f32_16x16x32_bf16 v[72:75], v[0:3], v[192:195], v[72:75]
  ds_read_b64_tr_b16 v[0:1], v39 offset:0
  ds_read_b64_tr_b16 v[2:3], v39 offset:4096
  s_waitcnt lgkmcnt(8)
  v_mfma_f32_16x16x32_bf16 v[76:79], v[4:7], v[184:187], v[76:79]
  v_mfma_f32_16x16x32_bf16 v[80:83], v[4:7], v[188:191], v[80:83]
  v_mfma_f32_16x16x32_bf16 v[84:87], v[4:7], v[192:195], v[84:87]
  ds_read_b64_tr_b16 v[4:5], v40 offset:0
  ds_read_b64_tr_b16 v[6:7], v40 offset:4096
  s_waitcnt lgkmcnt(8)
  v_mfma_f32_16x16x32_bf16 v[88:91], v[8:11], v[184:187], v[88:91]
  v_mfma_f32_16x16x32_bf16 v[92:95], v[8:11], v[188:191], v[92:95]
  v_mfma_f32_16x16x32_bf16 v[96:99], v[8:11], v[192:195], v[96:99]
  ds_read_b64_tr_b16 v[8:9], v41 offset:0
  ds_read_b64_tr_b16 v[10:11], v41 offset:4096
  s_waitcnt lgkmcnt(8)
  v_mfma_f32_16x16x32_bf16 v[100:103], v[12:15], v[184:187], v[100:103]
  v_mfma_f32_16x16x32_bf16 v[104:107], v[12:15], v[188:191], v[104:107]
  v_mfma_f32_16x16x32_bf16 v[108:111], v[12:15], v[192:195], v[108:111]
  s_waitcnt vmcnt(8)
  ds_read_b64_tr_b16 v[12:13], v34 offset:8192
  ds_read_b64_tr_b16 v[14:15], v34 offset:12288
  s_waitcnt lgkmcnt(8)
  v_mfma_f32_16x16x32_bf16 v[112:115], v[16:19], v[184:187], v[112:115]
  v_mfma_f32_16x16x32_bf16 v[116:119], v[16:19], v[188:191], v[116:119]
  v_mfma_f32_16x16x32_bf16 v[120:123], v[16:19], v[192:195], v[120:123]
  ds_read_b64_tr_b16 v[16:17], v35 offset:8192
  ds_read_b64_tr_b16 v[18:19], v35 offset:12288
  s_waitcnt lgkmcnt(8)
  v_mfma_f32_16x16x32_bf16 v[124:127], v[0:3], v[184:187], v[124:127]
  v_mfma_f32_16x16x32_bf16 v[128:131], v[0:3], v[188:191], v[128:131]
  v_mfma_f32_16x16x32_bf16 v[132:135], v[0:3], v[192:195], v[132:135]
  ds_read_b64_tr_b16 v[0:1], v36 offset:8192
  ds_read_b64_tr_b16 v[2:3], v36 offset:12288
  s_waitcnt lgkmcnt(8)
  v_mfma_f32_16x16x32_bf16 v[136:139], v[4:7], v[184:187], v[136:139]
  v_mfma_f32_16x16x32_bf16 v[140:143], v[4:7], v[188:191], v[140:143]
  v_mfma_f32_16x16x32_bf16 v[144:147], v[4:7], v[192:195], v[144:147]
  ds_read_b64_tr_b16 v[4:5], v37 offset:8192
  ds_read_b64_tr_b16 v[6:7], v37 offset:12288
  s_waitcnt lgkmcnt(8)
  v_mfma_f32_16x16x32_bf16 v[148:151], v[8:11], v[184:187], v[148:151]
  v_mfma_f32_16x16x32_bf16 v[152:155], v[8:11], v[188:191], v[152:155]
  v_mfma_f32_16x16x32_bf16 v[156:159], v[8:11], v[192:195], v[156:159]
  ds_read_b64_tr_b16 v[8:9], v38 offset:8192
  ds_read_b64_tr_b16 v[10:11], v38 offset:12288
  s_waitcnt lgkmcnt(8)
  v_mfma_f32_16x16x32_bf16 v[64:67], v[12:15], v[196:199], v[64:67]
  v_mfma_f32_16x16x32_bf16 v[68:71], v[12:15], v[200:203], v[68:71]
  v_mfma_f32_16x16x32_bf16 v[72:75], v[12:15], v[204:207], v[72:75]
  ds_read_b64_tr_b16 v[12:13], v39 offset:8192
  ds_read_b64_tr_b16 v[14:15], v39 offset:12288
  s_waitcnt lgkmcnt(8)
  v_mfma_f32_16x16x32_bf16 v[76:79], v[16:19], v[196:199], v[76:79]
  v_mfma_f32_16x16x32_bf16 v[80:83], v[16:19], v[200:203], v[80:83]
  v_mfma_f32_16x16x32_bf16 v[84:87], v[16:19], v[204:207], v[84:87]
  ds_read_b64_tr_b16 v[16:17], v40 offset:8192
  ds_read_b64_tr_b16 v[18:19], v40 offset:12288
  s_waitcnt lgkmcnt(8)
  v_mfma_f32_16x16x32_bf16 v[88:91], v[0:3], v[196:199], v[88:91]
  v_mfma_f32_16x16x32_bf16 v[92:95], v[0:3], v[200:203], v[92:95]
  v_mfma_f32_16x16x32_bf16 v[96:99], v[0:3], v[204:207], v[96:99]
  ds_read_b64_tr_b16 v[0:1], v41 offset:8192
  ds_read_b64_tr_b16 v[2:3], v41 offset:12288
  s_waitcnt lgkmcnt(8)
  v_mfma_f32_16x16x32_bf16 v[100:103], v[4:7], v[196:199], v[100:103]
  v_mfma_f32_16x16x32_bf16 v[104:107], v[4:7], v[200:203], v[104:107]
  v_mfma_f32_16x16x32_bf16 v[108:111], v[4:7], v[204:207], v[108:111]
  s_waitcnt lgkmcnt(6)
  v_mfma_f32_16x16x32_bf16 v[112:115], v[8:11], v[196:199], v[112:115]
  v_mfma_f32_16x16x32_bf16 v[116:119], v[8:11], v[200:203], v[116:119]
  v_mfma_f32_16x16x32_bf16 v[120:123], v[8:11], v[204:207], v[120:123]
  s_waitcnt lgkmcnt(4)
  v_mfma_f32_16x16x32_bf16 v[124:127], v[12:15], v[196:199], v[124:127]
  v_mfma_f32_16x16x32_bf16 v[128:131], v[12:15], v[200:203], v[128:131]
  v_mfma_f32_16x16x32_bf16 v[132:135], v[12:15], v[204:207], v[132:135]
  s_waitcnt lgkmcnt(2)
  v_mfma_f32_16x16x32_bf16 v[136:139], v[16:19], v[196:199], v[136:139]
  v_mfma_f32_16x16x32_bf16 v[140:143], v[16:19], v[200:203], v[140:143]
  v_mfma_f32_16x16x32_bf16 v[144:147], v[16:19], v[204:207], v[144:147]
  s_waitcnt lgkmcnt(0)
  v_mfma_f32_16x16x32_bf16 v[148:151], v[0:3], v[196:199], v[148:151]
  v_mfma_f32_16x16x32_bf16 v[152:155], v[0:3], v[200:203], v[152:155]
  v_mfma_f32_16x16x32_bf16 v[156:159], v[0:3], v[204:207], v[156:159]
  s_add_u32 m0, s63, 0
  s_add_u32 s67, s41, 0
  buffer_load_dwordx4 v32, s[20:23], s67 offen  lds
  s_add_u32 m0, s63, 1024
  s_add_u32 s67, s41, 3584
  buffer_load_dwordx4 v33, s[20:23], s67 offen  lds
  s_add_u32 m0, s63, 2048
  s_add_u32 s67, s41, 7168
  buffer_load_dwordx4 v32, s[20:23], s67 offen  lds
  s_add_u32 m0, s63, 3072
  s_add_u32 s67, s41, 10752
  buffer_load_dwordx4 v33, s[20:23], s67 offen  lds
  s_add_u32 m0, s63, 4096
  s_add_u32 s67, s41, 14336
  buffer_load_dwordx4 v32, s[20:23], s67 offen  lds
  s_add_u32 m0, s63, 5120
  s_add_u32 s67, s41, 17920
  buffer_load_dwordx4 v33, s[20:23], s67 offen  lds
  s_add_u32 m0, s63, 6144
  s_add_u32 s67, s41, 21504
  buffer_load_dwordx4 v32, s[20:23], s67 offen  lds
  s_add_u32 m0, s63, 7168
  s_add_u32 s67, s41, 25088
  buffer_load_dwordx4 v33, s[20:23], s67 offen  lds
  s_add_u32 m0, s63, 8192
  s_add_u32 s67, s41, 28672
  buffer_load_dwordx4 v32, s[20:23], s67 offen  lds
  s_add_u32 m0, s63, 9216
  s_add_u32 s67, s41, 32256
  buffer_load_dwordx4 v33, s[20:23], s67 offen  lds
  s_add_u32 m0, s63, 10240
  s_add_u32 s67, s41, 35840
  buffer_load_dwordx4 v32, s[20:23], s67 offen  lds
  s_add_u32 m0, s63, 11264
  s_add_u32 s67, s41, 39424
  buffer_load_dwordx4 v33, s[20:23], s67 offen  lds
  s_add_u32 m0, s63, 12288
  s_add_u32 s67, s41, 43008
  buffer_load_dwordx4 v32, s[20:23], s67 offen  lds
  s_add_u32 m0, s63, 13312
  s_add_u32 s67, s41, 46592
  buffer_load_dwordx4 v33, s[20:23], s67 offen  lds
  s_add_u32 m0, s63, 14336
  s_add_u32 s67, s41, 50176
  buffer_load_dwordx4 v32, s[20:23], s67 offen  lds
  s_add_u32 m0, s63, 15360
  s_add_u32 s67, s41, 53760
  buffer_load_dwordx4 v33, s[20:23], s67 offen  lds
  s_waitcnt vmcnt(16)
  s_barrier
  s_add_u32 m0, s62, 32768
  s_add_u32 s67, s38, 131072
  buffer_load_dwordx4 v46, s[12:15], s67 offen nt lds
  s_add_u32 m0, s62, 33792
  s_add_u32 s67, s38, 135168
  buffer_load_dwordx4 v46, s[12:15], s67 offen nt lds
  s_add_u32 m0, s62, 34816
  s_add_u32 s67, s38, 139264
  buffer_load_dwordx4 v46, s[12:15], s67 offen nt lds
  s_add_u32 m0, s62, 35840
  s_add_u32 s67, s38, 143360
  buffer_load_dwordx4 v46, s[12:15], s67 offen nt lds
  s_add_u32 m0, s62, 36864
  s_add_u32 s67, s38, 147456
  buffer_load_dwordx4 v46, s[12:15], s67 offen nt lds
  s_add_u32 m0, s62, 37888
  s_add_u32 s67, s38, 151552
  buffer_load_dwordx4 v46, s[12:15], s67 offen nt lds
  s_add_u32 m0, s62, 38912
  s_add_u32 s67, s38, 155648
  buffer_load_dwordx4 v46, s[12:15], s67 offen nt lds
  s_add_u32 m0, s62, 39936
  s_add_u32 s67, s38, 159744
  buffer_load_dwordx4 v46, s[12:15], s67 offen nt lds
  ds_read_b128 v[160:163], v42 offset:0
  ds_read_b128 v[164:167], v42 offset:2048
  ds_read_b128 v[168:171], v42 offset:4096
  s_waitcnt vmcnt(16)
  ds_read_b64_tr_b16 v[0:1], v34 offset:0
  ds_read_b64_tr_b16 v[2:3], v34 offset:4096
  ds_read_b64_tr_b16 v[4:5], v35 offset:0
  ds_read_b64_tr_b16 v[6:7], v35 offset:4096
  ds_read_b64_tr_b16 v[8:9], v36 offset:0
  ds_read_b64_tr_b16 v[10:11], v36 offset:4096
  ds_read_b64_tr_b16 v[12:13], v37 offset:0
  ds_read_b64_tr_b16 v[14:15], v37 offset:4096
  ds_read_b64_tr_b16 v[16:17], v38 offset:0
  ds_read_b64_tr_b16 v[18:19], v38 offset:4096
  ds_read_b128 v[172:175], v43 offset:0
  ds_read_b128 v[176:179], v43 offset:2048
  s_waitcnt lgkmcnt(14)
  ds_read_b128 v[180:183], v43 offset:4096
  s_waitcnt lgkmcnt(11)
  v_mfma_f32_16x16x32_bf16 v[64:67], v[0:3], v[160:163], v[64:67]
  v_mfma_f32_16x16x32_bf16 v[68:71], v[0:3], v[164:167], v[68:71]
  v_mfma_f32_16x16x32_bf16 v[72:75], v[0:3], v[168:171], v[72:75]
  ds_read_b64_tr_b16 v[0:1], v39 offset:0
  ds_read_b64_tr_b16 v[2:3], v39 offset:4096
  ds_read_b128 v[184:187], v42 offset:6144
  ds_read_b128 v[188:191], v42 offset:8192
  s_waitcnt lgkmcnt(14)
  ds_read_b128 v[192:195], v42 offset:10240
  s_waitcnt lgkmcnt(14)
  v_mfma_f32_16x16x32_bf16 v[76:79], v[4:7], v[160:163], v[76:79]
  v_mfma_f32_16x16x32_bf16 v[80:83], v[4:7], v[164:167], v[80:83]
  v_mfma_f32_16x16x32_bf16 v[84:87], v[4:7], v[168:171], v[84:87]
  s_waitcnt lgkmcnt(13)
  ds_read_b64_tr_b16 v[4:5], v40 offset:0
  ds_read_b64_tr_b16 v[6:7], v40 offset:4096
  s_waitcnt lgkmcnt(14)
  ds_read_b128 v[196:199], v43 offset:6144
  s_waitcnt lgkmcnt(14)
  ds_read_b128 v[200:203], v43 offset:8192
  s_waitcnt lgkmcnt(14)
  ds_read_b128 v[204:207], v43 offset:10240
  v_mfma_f32_16x16x32_bf16 v[88:91], v[8:11], v[160:163], v[88:91]
  v_mfma_f32_16x16x32_bf16 v[92:95], v[8:11], v[164:167], v[92:95]
  v_mfma_f32_16x16x32_bf16 v[96:99], v[8:11], v[168:171], v[96:99]
  s_waitcnt lgkmcnt(13)
  ds_read_b64_tr_b16 v[8:9], v41 offset:0
  ds_read_b64_tr_b16 v[10:11], v41 offset:4096
  v_mfma_f32_16x16x32_bf16 v[100:103], v[12:15], v[160:163], v[100:103]
  v_mfma_f32_16x16x32_bf16 v[104:107], v[12:15], v[164:167], v[104:107]
  v_mfma_f32_16x16x32_bf16 v[108:111], v[12:15], v[168:171], v[108:111]
  s_waitcnt vmcnt(8)
  s_waitcnt lgkmcnt(13)
  ds_read_b64_tr_b16 v[12:13], v34 offset:8192
  ds_read_b64_tr_b16 v[14:15], v34 offset:12288
  v_mfma_f32_16x16x32_bf16 v[112:115], v[16:19], v[160:163], v[112:115]
  v_mfma_f32_16x16x32_bf16 v[116:119], v[16:19], v[164:167], v[116:119]
  v_mfma_f32_16x16x32_bf16 v[120:123], v[16:19], v[168:171], v[120:123]
  s_waitcnt lgkmcnt(13)
  ds_read_b64_tr_b16 v[16:17], v35 offset:8192
  ds_read_b64_tr_b16 v[18:19], v35 offset:12288
  s_waitcnt lgkmcnt(14)
  v_mfma_f32_16x16x32_bf16 v[124:127], v[0:3], v[160:163], v[124:127]
  v_mfma_f32_16x16x32_bf16 v[128:131], v[0:3], v[164:167], v[128:131]
  v_mfma_f32_16x16x32_bf16 v[132:135], v[0:3], v[168:171], v[132:135]
  s_waitcnt lgkmcnt(13)
  ds_read_b64_tr_b16 v[0:1], v36 offset:8192
  ds_read_b64_tr_b16 v[2:3], v36 offset:12288
  s_waitcnt lgkmcnt(11)
  v_mfma_f32_16x16x32_bf16 v[136:139], v[4:7], v[160:163], v[136:139]
  v_mfma_f32_16x16x32_bf16 v[140:143], v[4:7], v[164:167], v[140:143]
  v_mfma_f32_16x16x32_bf16 v[144:147], v[4:7], v[168:171], v[144:147]
  ds_read_b64_tr_b16 v[4:5], v37 offset:8192
  ds_read_b64_tr_b16 v[6:7], v37 offset:12288
  s_waitcnt lgkmcnt(8)
  v_mfma_f32_16x16x32_bf16 v[148:151], v[8:11], v[160:163], v[148:151]
  v_mfma_f32_16x16x32_bf16 v[152:155], v[8:11], v[164:167], v[152:155]
  v_mfma_f32_16x16x32_bf16 v[156:159], v[8:11], v[168:171], v[156:159]
  ds_read_b64_tr_b16 v[8:9], v38 offset:8192
  ds_read_b64_tr_b16 v[10:11], v38 offset:12288
  s_waitcnt lgkmcnt(8)
  v_mfma_f32_16x16x32_bf16 v[64:67], v[12:15], v[172:175], v[64:67]
  v_mfma_f32_16x16x32_bf16 v[68:71], v[12:15], v[176:179], v[68:71]
  v_mfma_f32_16x16x32_bf16 v[72:75], v[12:15], v[180:183], v[72:75]
  ds_read_b64_tr_b16 v[12:13], v39 offset:8192
  ds_read_b64_tr_b16 v[14:15], v39 offset:12288
  s_waitcnt lgkmcnt(8)
  v_mfma_f32_16x16x32_bf16 v[76:79], v[16:19], v[172:175], v[76:79]
  v_mfma_f32_16x16x32_bf16 v[80:83], v[16:19], v[176:179], v[80:83]
  v_mfma_f32_16x16x32_bf16 v[84:87], v[16:19], v[180:183], v[84:87]
  ds_read_b64_tr_b16 v[16:17], v40 offset:8192
  ds_read_b64_tr_b16 v[18:19], v40 offset:12288
  s_waitcnt lgkmcnt(8)
  v_mfma_f32_16x16x32_bf16 v[88:91], v[0:3], v[172:175], v[88:91]
  v_mfma_f32_16x16x32_bf16 v[92:95], v[0:3], v[176:179], v[92:95]
  v_mfma_f32_16x16x32_bf16 v[96:99], v[0:3], v[180:183], v[96:99]
  ds_read_b64_tr_b16 v[0:1], v41 offset:8192
  ds_read_b64_tr_b16 v[2:3], v41 offset:12288
  s_waitcnt lgkmcnt(8)
  v_mfma_f32_16x16x32_bf16 v[100:103], v[4:7], v[172:175], v[100:103]
  v_mfma_f32_16x16x32_bf16 v[104:107], v[4:7], v[176:179], v[104:107]
  v_mfma_f32_16x16x32_bf16 v[108:111], v[4:7], v[180:183], v[108:111]
  s_waitcnt lgkmcnt(6)
  v_mfma_f32_16x16x32_bf16 v[112:115], v[8:11], v[172:175], v[112:115]
  v_mfma_f32_16x16x32_bf16 v[116:119], v[8:11], v[176:179], v[116:119]
  v_mfma_f32_16x16x32_bf16 v[120:123], v[8:11], v[180:183], v[120:123]
  s_waitcnt lgkmcnt(4)
  v_mfma_f32_16x16x32_bf16 v[124:127], v[12:15], v[172:175], v[124:127]
  v_mfma_f32_16x16x32_bf16 v[128:131], v[12:15], v[176:179], v[128:131]
  v_mfma_f32_16x16x32_bf16 v[132:135], v[12:15], v[180:183], v[132:135]
  s_waitcnt lgkmcnt(2)
  v_mfma_f32_16x16x32_bf16 v[136:139], v[16:19], v[172:175], v[136:139]
  v_mfma_f32_16x16x32_bf16 v[140:143], v[16:19], v[176:179], v[140:143]
  v_mfma_f32_16x16x32_bf16 v[144:147], v[16:19], v[180:183], v[144:147]
  s_waitcnt lgkmcnt(0)
  v_mfma_f32_16x16x32_bf16 v[148:151], v[0:3], v[172:175], v[148:151]
  v_mfma_f32_16x16x32_bf16 v[152:155], v[0:3], v[176:179], v[152:155]
  v_mfma_f32_16x16x32_bf16 v[156:159], v[0:3], v[180:183], v[156:159]
  s_add_u32 m0, s63, 0
  s_add_u32 s67, s41, 229376
  buffer_load_dwordx4 v32, s[20:23], s67 offen  lds
  s_add_u32 m0, s63, 1024
  s_add_u32 s67, s41, 232960
  buffer_load_dwordx4 v33, s[20:23], s67 offen  lds
  s_add_u32 m0, s63, 2048
  s_add_u32 s67, s41, 236544
  buffer_load_dwordx4 v32, s[20:23], s67 offen  lds
  s_add_u32 m0, s63, 3072
  s_add_u32 s67, s41, 240128
  buffer_load_dwordx4 v33, s[20:23], s67 offen  lds
  s_add_u32 m0, s63, 4096
  s_add_u32 s67, s41, 243712
  buffer_load_dwordx4 v32, s[20:23], s67 offen  lds
  s_add_u32 m0, s63, 5120
  s_add_u32 s67, s41, 247296
  buffer_load_dwordx4 v33, s[20:23], s67 offen  lds
  s_add_u32 m0, s63, 6144
  s_add_u32 s67, s41, 250880
  buffer_load_dwordx4 v32, s[20:23], s67 offen  lds
  s_add_u32 m0, s63, 7168
  s_add_u32 s67, s41, 254464
  buffer_load_dwordx4 v33, s[20:23], s67 offen  lds
  s_add_u32 m0, s63, 8192
  s_add_u32 s67, s41, 258048
  buffer_load_dwordx4 v32, s[20:23], s67 offen  lds
  s_add_u32 m0, s63, 9216
  s_add_u32 s67, s41, 261632
  buffer_load_dwordx4 v33, s[20:23], s67 offen  lds
  s_add_u32 m0, s63, 10240
  s_add_u32 s67, s41, 265216
  buffer_load_dwordx4 v32, s[20:23], s67 offen  lds
  s_add_u32 m0, s63, 11264
  s_add_u32 s67, s41, 268800
  buffer_load_dwordx4 v33, s[20:23], s67 offen  lds
  s_add_u32 m0, s63, 12288
  s_add_u32 s67, s41, 272384
  buffer_load_dwordx4 v32, s[20:23], s67 offen  lds
  s_add_u32 m0, s63, 13312
  s_add_u32 s67, s41, 275968
  buffer_load_dwordx4 v33, s[20:23], s67 offen  lds
  s_add_u32 m0, s63, 14336
  s_add_u32 s67, s41, 279552
  buffer_load_dwordx4 v32, s[20:23], s67 offen  lds
  s_add_u32 m0, s63, 15360
  s_add_u32 s67, s41, 283136
  buffer_load_dwordx4 v33, s[20:23], s67 offen  lds
  s_waitcnt vmcnt(16)
  s_barrier
  s_add_u32 m0, s62, 0
  s_add_u32 s67, s39, 0
  buffer_load_dwordx4 v46, s[12:15], s67 offen nt lds
  s_add_u32 m0, s62, 1024
  s_add_u32 s67, s39, 4096
  buffer_load_dwordx4 v46, s[12:15], s67 offen nt lds
  s_add_u32 m0, s62, 2048
  s_add_u32 s67, s39, 8192
  buffer_load_dwordx4 v46, s[12:15], s67 offen nt lds
  s_add_u32 m0, s62, 3072
  s_add_u32 s67, s39, 12288
  buffer_load_dwordx4 v46, s[12:15], s67 offen nt lds
  s_add_u32 m0, s62, 4096
  s_add_u32 s67, s39, 16384
  buffer_load_dwordx4 v46, s[12:15], s67 offen nt lds
  s_add_u32 m0, s62, 5120
  s_add_u32 s67, s39, 20480
  buffer_load_dwordx4 v46, s[12:15], s67 offen nt lds
  s_add_u32 m0, s62, 6144
  s_add_u32 s67, s39, 24576
  buffer_load_dwordx4 v46, s[12:15], s67 offen nt lds
  s_add_u32 m0, s62, 7168
  s_add_u32 s67, s39, 28672
  buffer_load_dwordx4 v46, s[12:15], s67 offen nt lds
  s_waitcnt vmcnt(16)
  ds_read_b64_tr_b16 v[0:1], v34 offset:0
  ds_read_b64_tr_b16 v[2:3], v34 offset:4096
  ds_read_b64_tr_b16 v[4:5], v35 offset:0
  ds_read_b64_tr_b16 v[6:7], v35 offset:4096
  ds_read_b64_tr_b16 v[8:9], v36 offset:0
  ds_read_b64_tr_b16 v[10:11], v36 offset:4096
  ds_read_b64_tr_b16 v[12:13], v37 offset:0
  ds_read_b64_tr_b16 v[14:15], v37 offset:4096
  ds_read_b64_tr_b16 v[16:17], v38 offset:0
  ds_read_b64_tr_b16 v[18:19], v38 offset:4096
  s_waitcnt lgkmcnt(8)
  v_mfma_f32_16x16x32_bf16 v[64:67], v[0:3], v[184:187], v[64:67]
  v_mfma_f32_16x16x32_bf16 v[68:71], v[0:3], v[188:191], v[68:71]
  v_mfma_f32_16x16x32_bf16 v[72:75], v[0:3], v[192:195], v[72:75]
  ds_read_b64_tr_b16 v[0:1], v39 offset:0
  ds_read_b64_tr_b16 v[2:3], v39 offset:4096
  s_waitcnt lgkmcnt(8)
  v_mfma_f32_16x16x32_bf16 v[76:79], v[4:7], v[184:187], v[76:79]
  v_mfma_f32_16x16x32_bf16 v[80:83], v[4:7], v[188:191], v[80:83]
  v_mfma_f32_16x16x32_bf16 v[84:87], v[4:7], v[192:195], v[84:87]
  ds_read_b64_tr_b16 v[4:5], v40 offset:0
  ds_read_b64_tr_b16 v[6:7], v40 offset:4096
  s_waitcnt lgkmcnt(8)
  v_mfma_f32_16x16x32_bf16 v[88:91], v[8:11], v[184:187], v[88:91]
  v_mfma_f32_16x16x32_bf16 v[92:95], v[8:11], v[188:191], v[92:95]
  v_mfma_f32_16x16x32_bf16 v[96:99], v[8:11], v[192:195], v[96:99]
  ds_read_b64_tr_b16 v[8:9], v41 offset:0
  ds_read_b64_tr_b16 v[10:11], v41 offset:4096
  s_waitcnt lgkmcnt(8)
  v_mfma_f32_16x16x32_bf16 v[100:103], v[12:15], v[184:187], v[100:103]
  v_mfma_f32_16x16x32_bf16 v[104:107], v[12:15], v[188:191], v[104:107]
  v_mfma_f32_16x16x32_bf16 v[108:111], v[12:15], v[192:195], v[108:111]
  s_waitcnt vmcnt(8)
  ds_read_b64_tr_b16 v[12:13], v34 offset:8192
  ds_read_b64_tr_b16 v[14:15], v34 offset:12288
  s_waitcnt lgkmcnt(8)
  v_mfma_f32_16x16x32_bf16 v[112:115], v[16:19], v[184:187], v[112:115]
  v_mfma_f32_16x16x32_bf16 v[116:119], v[16:19], v[188:191], v[116:119]
  v_mfma_f32_16x16x32_bf16 v[120:123], v[16:19], v[192:195], v[120:123]
  ds_read_b64_tr_b16 v[16:17], v35 offset:8192
  ds_read_b64_tr_b16 v[18:19], v35 offset:12288
  s_waitcnt lgkmcnt(8)
  v_mfma_f32_16x16x32_bf16 v[124:127], v[0:3], v[184:187], v[124:127]
  v_mfma_f32_16x16x32_bf16 v[128:131], v[0:3], v[188:191], v[128:131]
  v_mfma_f32_16x16x32_bf16 v[132:135], v[0:3], v[192:195], v[132:135]
  ds_read_b64_tr_b16 v[0:1], v36 offset:8192
  ds_read_b64_tr_b16 v[2:3], v36 offset:12288
  s_waitcnt lgkmcnt(8)
  v_mfma_f32_16x16x32_bf16 v[136:139], v[4:7], v[184:187], v[136:139]
  v_mfma_f32_16x16x32_bf16 v[140:143], v[4:7], v[188:191], v[140:143]
  v_mfma_f32_16x16x32_bf16 v[144:147], v[4:7], v[192:195], v[144:147]
  ds_read_b64_tr_b16 v[4:5], v37 offset:8192
  ds_read_b64_tr_b16 v[6:7], v37 offset:12288
  s_waitcnt lgkmcnt(8)
  v_mfma_f32_16x16x32_bf16 v[148:151], v[8:11], v[184:187], v[148:151]
  v_mfma_f32_16x16x32_bf16 v[152:155], v[8:11], v[188:191], v[152:155]
  v_mfma_f32_16x16x32_bf16 v[156:159], v[8:11], v[192:195], v[156:159]
  ds_read_b64_tr_b16 v[8:9], v38 offset:8192
  ds_read_b64_tr_b16 v[10:11], v38 offset:12288
  s_waitcnt lgkmcnt(8)
  v_mfma_f32_16x16x32_bf16 v[64:67], v[12:15], v[196:199], v[64:67]
  v_mfma_f32_16x16x32_bf16 v[68:71], v[12:15], v[200:203], v[68:71]
  v_mfma_f32_16x16x32_bf16 v[72:75], v[12:15], v[204:207], v[72:75]
  ds_read_b64_tr_b16 v[12:13], v39 offset:8192
  ds_read_b64_tr_b16 v[14:15], v39 offset:12288
  s_waitcnt lgkmcnt(8)
  v_mfma_f32_16x16x32_bf16 v[76:79], v[16:19], v[196:199], v[76:79]
  v_mfma_f32_16x16x32_bf16 v[80:83], v[16:19], v[200:203], v[80:83]
  v_mfma_f32_16x16x32_bf16 v[84:87], v[16:19], v[204:207], v[84:87]
  ds_read_b64_tr_b16 v[16:17], v40 offset:8192
  ds_read_b64_tr_b16 v[18:19], v40 offset:12288
  s_waitcnt lgkmcnt(8)
  v_mfma_f32_16x16x32_bf16 v[88:91], v[0:3], v[196:199], v[88:91]
  v_mfma_f32_16x16x32_bf16 v[92:95], v[0:3], v[200:203], v[92:95]
  v_mfma_f32_16x16x32_bf16 v[96:99], v[0:3], v[204:207], v[96:99]
  ds_read_b64_tr_b16 v[0:1], v41 offset:8192
  ds_read_b64_tr_b16 v[2:3], v41 offset:12288
  s_waitcnt lgkmcnt(8)
  v_mfma_f32_16x16x32_bf16 v[100:103], v[4:7], v[196:199], v[100:103]
  v_mfma_f32_16x16x32_bf16 v[104:107], v[4:7], v[200:203], v[104:107]
  v_mfma_f32_16x16x32_bf16 v[108:111], v[4:7], v[204:207], v[108:111]
  s_waitcnt lgkmcnt(6)
  v_mfma_f32_16x16x32_bf16 v[112:115], v[8:11], v[196:199], v[112:115]
  v_mfma_f32_16x16x32_bf16 v[116:119], v[8:11], v[200:203], v[116:119]
  v_mfma_f32_16x16x32_bf16 v[120:123], v[8:11], v[204:207], v[120:123]
  s_waitcnt lgkmcnt(4)
  v_mfma_f32_16x16x32_bf16 v[124:127], v[12:15], v[196:199], v[124:127]
  v_mfma_f32_16x16x32_bf16 v[128:131], v[12:15], v[200:203], v[128:131]
  v_mfma_f32_16x16x32_bf16 v[132:135], v[12:15], v[204:207], v[132:135]
  s_waitcnt lgkmcnt(2)
  v_mfma_f32_16x16x32_bf16 v[136:139], v[16:19], v[196:199], v[136:139]
  v_mfma_f32_16x16x32_bf16 v[140:143], v[16:19], v[200:203], v[140:143]
  v_mfma_f32_16x16x32_bf16 v[144:147], v[16:19], v[204:207], v[144:147]
  s_waitcnt lgkmcnt(0)
  v_mfma_f32_16x16x32_bf16 v[148:151], v[0:3], v[196:199], v[148:151]
  v_mfma_f32_16x16x32_bf16 v[152:155], v[0:3], v[200:203], v[152:155]
  v_mfma_f32_16x16x32_bf16 v[156:159], v[0:3], v[204:207], v[156:159]
  s_add_u32 m0, s63, 0
  s_add_u32 s67, s42, 0
  buffer_load_dwordx4 v32, s[20:23], s67 offen  lds
  s_add_u32 m0, s63, 1024
  s_add_u32 s67, s42, 3584
  buffer_load_dwordx4 v33, s[20:23], s67 offen  lds
  s_add_u32 m0, s63, 2048
  s_add_u32 s67, s42, 7168
  buffer_load_dwordx4 v32, s[20:23], s67 offen  lds
  s_add_u32 m0, s63, 3072
  s_add_u32 s67, s42, 10752
  buffer_load_dwordx4 v33, s[20:23], s67 offen  lds
  s_add_u32 m0, s63, 4096
  s_add_u32 s67, s42, 14336
  buffer_load_dwordx4 v32, s[20:23], s67 offen  lds
  s_add_u32 m0, s63, 5120
  s_add_u32 s67, s42, 17920
  buffer_load_dwordx4 v33, s[20:23], s67 offen  lds
  s_add_u32 m0, s63, 6144
  s_add_u32 s67, s42, 21504
  buffer_load_dwordx4 v32, s[20:23], s67 offen  lds
  s_add_u32 m0, s63, 7168
  s_add_u32 s67, s42, 25088
  buffer_load_dwordx4 v33, s[20:23], s67 offen  lds
  s_add_u32 m0, s63, 8192
  s_add_u32 s67, s42, 28672
  buffer_load_dwordx4 v32, s[20:23], s67 offen  lds
  s_add_u32 m0, s63, 9216
  s_add_u32 s67, s42, 32256
  buffer_load_dwordx4 v33, s[20:23], s67 offen  lds
  s_add_u32 m0, s63, 10240
  s_add_u32 s67, s42, 35840
  buffer_load_dwordx4 v32, s[20:23], s67 offen  lds
  s_add_u32 m0, s63, 11264
  s_add_u32 s67, s42, 39424
  buffer_load_dwordx4 v33, s[20:23], s67 offen  lds
  s_add_u32 m0, s63, 12288
  s_add_u32 s67, s42, 43008
  buffer_load_dwordx4 v32, s[20:23], s67 offen  lds
  s_add_u32 m0, s63, 13312
  s_add_u32 s67, s42, 46592
  buffer_load_dwordx4 v33, s[20:23], s67 offen  lds
  s_add_u32 m0, s63, 14336
  s_add_u32 s67, s42, 50176
  buffer_load_dwordx4 v32, s[20:23], s67 offen  lds
  s_add_u32 m0, s63, 15360
  s_add_u32 s67, s42, 53760
  buffer_load_dwordx4 v33, s[20:23], s67 offen  lds
  s_waitcnt vmcnt(16)
  s_barrier
  s_add_u32 m0, s62, 32768
  s_add_u32 s67, s39, 131072
  buffer_load_dwordx4 v46, s[12:15], s67 offen nt lds
  s_add_u32 m0, s62, 33792
  s_add_u32 s67, s39, 135168
  buffer_load_dwordx4 v46, s[12:15], s67 offen nt lds
  s_add_u32 m0, s62, 34816
  s_add_u32 s67, s39, 139264
  buffer_load_dwordx4 v46, s[12:15], s67 offen nt lds
  s_add_u32 m0, s62, 35840
  s_add_u32 s67, s39, 143360
  buffer_load_dwordx4 v46, s[12:15], s67 offen nt lds
  s_add_u32 m0, s62, 36864
  s_add_u32 s67, s39, 147456
  buffer_load_dwordx4 v46, s[12:15], s67 offen nt lds
  s_add_u32 m0, s62, 37888
  s_add_u32 s67, s39, 151552
  buffer_load_dwordx4 v46, s[12:15], s67 offen nt lds
  s_add_u32 m0, s62, 38912
  s_add_u32 s67, s39, 155648
  buffer_load_dwordx4 v46, s[12:15], s67 offen nt lds
  s_add_u32 m0, s62, 39936
  s_add_u32 s67, s39, 159744
  buffer_load_dwordx4 v46, s[12:15], s67 offen nt lds
  ds_read_b128 v[160:163], v42 offset:0
  ds_read_b128 v[164:167], v42 offset:2048
  ds_read_b128 v[168:171], v42 offset:4096
  s_waitcnt vmcnt(16)
  ds_read_b64_tr_b16 v[0:1], v34 offset:0
  ds_read_b64_tr_b16 v[2:3], v34 offset:4096
  ds_read_b64_tr_b16 v[4:5], v35 offset:0
  ds_read_b64_tr_b16 v[6:7], v35 offset:4096
  ds_read_b64_tr_b16 v[8:9], v36 offset:0
  ds_read_b64_tr_b16 v[10:11], v36 offset:4096
  ds_read_b64_tr_b16 v[12:13], v37 offset:0
  ds_read_b64_tr_b16 v[14:15], v37 offset:4096
  ds_read_b64_tr_b16 v[16:17], v38 offset:0
  ds_read_b64_tr_b16 v[18:19], v38 offset:4096
  ds_read_b128 v[172:175], v43 offset:0
  ds_read_b128 v[176:179], v43 offset:2048
  s_waitcnt lgkmcnt(14)
  ds_read_b128 v[180:183], v43 offset:4096
  s_waitcnt lgkmcnt(11)
  v_mfma_f32_16x16x32_bf16 v[64:67], v[0:3], v[160:163], v[64:67]
  v_mfma_f32_16x16x32_bf16 v[68:71], v[0:3], v[164:167], v[68:71]
  v_mfma_f32_16x16x32_bf16 v[72:75], v[0:3], v[168:171], v[72:75]
  ds_read_b64_tr_b16 v[0:1], v39 offset:0
  ds_read_b64_tr_b16 v[2:3], v39 offset:4096
  ds_read_b128 v[184:187], v42 offset:6144
  ds_read_b128 v[188:191], v42 offset:8192
  s_waitcnt lgkmcnt(14)
  ds_read_b128 v[192:195], v42 offset:10240
  s_waitcnt lgkmcnt(14)
  v_mfma_f32_16x16x32_bf16 v[76:79], v[4:7], v[160:163], v[76:79]
  v_mfma_f32_16x16x32_bf16 v[80:83], v[4:7], v[164:167], v[80:83]
  v_mfma_f32_16x16x32_bf16 v[84:87], v[4:7], v[168:171], v[84:87]
  s_waitcnt lgkmcnt(13)
  ds_read_b64_tr_b16 v[4:5], v40 offset:0
  ds_read_b64_tr_b16 v[6:7], v40 offset:4096
  s_waitcnt lgkmcnt(14)
  ds_read_b128 v[196:199], v43 offset:6144
  s_waitcnt lgkmcnt(14)
  ds_read_b128 v[200:203], v43 offset:8192
  s_waitcnt lgkmcnt(14)
  ds_read_b128 v[204:207], v43 offset:10240
  v_mfma_f32_16x16x32_bf16 v[88:91], v[8:11], v[160:163], v[88:91]
  v_mfma_f32_16x16x32_bf16 v[92:95], v[8:11], v[164:167], v[92:95]
  v_mfma_f32_16x16x32_bf16 v[96:99], v[8:11], v[168:171], v[96:99]
  s_waitcnt lgkmcnt(13)
  ds_read_b64_tr_b16 v[8:9], v41 offset:0
  ds_read_b64_tr_b16 v[10:11], v41 offset:4096
  v_mfma_f32_16x16x32_bf16 v[100:103], v[12:15], v[160:163], v[100:103]
  v_mfma_f32_16x16x32_bf16 v[104:107], v[12:15], v[164:167], v[104:107]
  v_mfma_f32_16x16x32_bf16 v[108:111], v[12:15], v[168:171], v[108:111]
  s_waitcnt vmcnt(8)
  s_waitcnt lgkmcnt(13)
  ds_read_b64_tr_b16 v[12:13], v34 offset:8192
  ds_read_b64_tr_b16 v[14:15], v34 offset:12288
  v_mfma_f32_16x16x32_bf16 v[112:115], v[16:19], v[160:163], v[112:115]
  v_mfma_f32_16x16x32_bf16 v[116:119], v[16:19], v[164:167], v[116:119]
  v_mfma_f32_16x16x32_bf16 v[120:123], v[16:19], v[168:171], v[120:123]
  s_waitcnt lgkmcnt(13)
  ds_read_b64_tr_b16 v[16:17], v35 offset:8192
  ds_read_b64_tr_b16 v[18:19], v35 offset:12288
  s_waitcnt lgkmcnt(14)
  v_mfma_f32_16x16x32_bf16 v[124:127], v[0:3], v[160:163], v[124:127]
  v_mfma_f32_16x16x32_bf16 v[128:131], v[0:3], v[164:167], v[128:131]
  v_mfma_f32_16x16x32_bf16 v[132:135], v[0:3], v[168:171], v[132:135]
  s_waitcnt lgkmcnt(13)
  ds_read_b64_tr_b16 v[0:1], v36 offset:8192
  ds_read_b64_tr_b16 v[2:3], v36 offset:12288
  s_waitcnt lgkmcnt(11)
  v_mfma_f32_16x16x32_bf16 v[136:139], v[4:7], v[160:163], v[136:139]
  v_mfma_f32_16x16x32_bf16 v[140:143], v[4:7], v[164:167], v[140:143]
  v_mfma_f32_16x16x32_bf16 v[144:147], v[4:7], v[168:171], v[144:147]
  ds_read_b64_tr_b16 v[4:5], v37 offset:8192
  ds_read_b64_tr_b16 v[6:7], v37 offset:12288
  s_waitcnt lgkmcnt(8)
  v_mfma_f32_16x16x32_bf16 v[148:151], v[8:11], v[160:163], v[148:151]
  v_mfma_f32_16x16x32_bf16 v[152:155], v[8:11], v[164:167], v[152:155]
  v_mfma_f32_16x16x32_bf16 v[156:159], v[8:11], v[168:171], v[156:159]
  ds_read_b64_tr_b16 v[8:9], v38 offset:8192
  ds_read_b64_tr_b16 v[10:11], v38 offset:12288
  s_waitcnt lgkmcnt(8)
  v_mfma_f32_16x16x32_bf16 v[64:67], v[12:15], v[172:175], v[64:67]
  v_mfma_f32_16x16x32_bf16 v[68:71], v[12:15], v[176:179], v[68:71]
  v_mfma_f32_16x16x32_bf16 v[72:75], v[12:15], v[180:183], v[72:75]
  ds_read_b64_tr_b16 v[12:13], v39 offset:8192
  ds_read_b64_tr_b16 v[14:15], v39 offset:12288
  s_waitcnt lgkmcnt(8)
  v_mfma_f32_16x16x32_bf16 v[76:79], v[16:19], v[172:175], v[76:79]
  v_mfma_f32_16x16x32_bf16 v[80:83], v[16:19], v[176:179], v[80:83]
  v_mfma_f32_16x16x32_bf16 v[84:87], v[16:19], v[180:183], v[84:87]
  ds_read_b64_tr_b16 v[16:17], v40 offset:8192
  ds_read_b64_tr_b16 v[18:19], v40 offset:12288
  s_waitcnt lgkmcnt(8)
  v_mfma_f32_16x16x32_bf16 v[88:91], v[0:3], v[172:175], v[88:91]
  v_mfma_f32_16x16x32_bf16 v[92:95], v[0:3], v[176:179], v[92:95]
  v_mfma_f32_16x16x32_bf16 v[96:99], v[0:3], v[180:183], v[96:99]
  ds_read_b64_tr_b16 v[0:1], v41 offset:8192
  ds_read_b64_tr_b16 v[2:3], v41 offset:12288
  s_waitcnt lgkmcnt(8)
  v_mfma_f32_16x16x32_bf16 v[100:103], v[4:7], v[172:175], v[100:103]
  v_mfma_f32_16x16x32_bf16 v[104:107], v[4:7], v[176:179], v[104:107]
  v_mfma_f32_16x16x32_bf16 v[108:111], v[4:7], v[180:183], v[108:111]
  s_waitcnt lgkmcnt(6)
  v_mfma_f32_16x16x32_bf16 v[112:115], v[8:11], v[172:175], v[112:115]
  v_mfma_f32_16x16x32_bf16 v[116:119], v[8:11], v[176:179], v[116:119]
  v_mfma_f32_16x16x32_bf16 v[120:123], v[8:11], v[180:183], v[120:123]
  s_waitcnt lgkmcnt(4)
  v_mfma_f32_16x16x32_bf16 v[124:127], v[12:15], v[172:175], v[124:127]
  v_mfma_f32_16x16x32_bf16 v[128:131], v[12:15], v[176:179], v[128:131]
  v_mfma_f32_16x16x32_bf16 v[132:135], v[12:15], v[180:183], v[132:135]
  s_waitcnt lgkmcnt(2)
  v_mfma_f32_16x16x32_bf16 v[136:139], v[16:19], v[172:175], v[136:139]
  v_mfma_f32_16x16x32_bf16 v[140:143], v[16:19], v[176:179], v[140:143]
  v_mfma_f32_16x16x32_bf16 v[144:147], v[16:19], v[180:183], v[144:147]
  s_waitcnt lgkmcnt(0)
  v_mfma_f32_16x16x32_bf16 v[148:151], v[0:3], v[172:175], v[148:151]
  v_mfma_f32_16x16x32_bf16 v[152:155], v[0:3], v[176:179], v[152:155]
  v_mfma_f32_16x16x32_bf16 v[156:159], v[0:3], v[180:183], v[156:159]
  s_add_u32 m0, s63, 0
  s_add_u32 s67, s42, 229376
  buffer_load_dwordx4 v32, s[20:23], s67 offen  lds
  s_add_u32 m0, s63, 1024
  s_add_u32 s67, s42, 232960
  buffer_load_dwordx4 v33, s[20:23], s67 offen  lds
  s_add_u32 m0, s63, 2048
  s_add_u32 s67, s42, 236544
  buffer_load_dwordx4 v32, s[20:23], s67 offen  lds
  s_add_u32 m0, s63, 3072
  s_add_u32 s67, s42, 240128
  buffer_load_dwordx4 v33, s[20:23], s67 offen  lds
  s_add_u32 m0, s63, 4096
  s_add_u32 s67, s42, 243712
  buffer_load_dwordx4 v32, s[20:23], s67 offen  lds
  s_add_u32 m0, s63, 5120
  s_add_u32 s67, s42, 247296
  buffer_load_dwordx4 v33, s[20:23], s67 offen  lds
  s_add_u32 m0, s63, 6144
  s_add_u32 s67, s42, 250880
  buffer_load_dwordx4 v32, s[20:23], s67 offen  lds
  s_add_u32 m0, s63, 7168
  s_add_u32 s67, s42, 254464
  buffer_load_dwordx4 v33, s[20:23], s67 offen  lds
  s_add_u32 m0, s63, 8192
  s_add_u32 s67, s42, 258048
  buffer_load_dwordx4 v32, s[20:23], s67 offen  lds
  s_add_u32 m0, s63, 9216
  s_add_u32 s67, s42, 261632
  buffer_load_dwordx4 v33, s[20:23], s67 offen  lds
  s_add_u32 m0, s63, 10240
  s_add_u32 s67, s42, 265216
  buffer_load_dwordx4 v32, s[20:23], s67 offen  lds
  s_add_u32 m0, s63, 11264
  s_add_u32 s67, s42, 268800
  buffer_load_dwordx4 v33, s[20:23], s67 offen  lds
  s_add_u32 m0, s63, 12288
  s_add_u32 s67, s42, 272384
  buffer_load_dwordx4 v32, s[20:23], s67 offen  lds
  s_add_u32 m0, s63, 13312
  s_add_u32 s67, s42, 275968
  buffer_load_dwordx4 v33, s[20:23], s67 offen  lds
  s_add_u32 m0, s63, 14336
  s_add_u32 s67, s42, 279552
  buffer_load_dwordx4 v32, s[20:23], s67 offen  lds
  s_add_u32 m0, s63, 15360
  s_add_u32 s67, s42, 283136
  buffer_load_dwordx4 v33, s[20:23], s67 offen  lds
  s_waitcnt vmcnt(16)
  s_barrier
  s_waitcnt vmcnt(8)
  ds_read_b64_tr_b16 v[0:1], v34 offset:0
  ds_read_b64_tr_b16 v[2:3], v34 offset:4096
  ds_read_b64_tr_b16 v[4:5], v35 offset:0
  ds_read_b64_tr_b16 v[6:7], v35 offset:4096
  ds_read_b64_tr_b16 v[8:9], v36 offset:0
  ds_read_b64_tr_b16 v[10:11], v36 offset:4096
  ds_read_b64_tr_b16 v[12:13], v37 offset:0
  ds_read_b64_tr_b16 v[14:15], v37 offset:4096
  ds_read_b64_tr_b16 v[16:17], v38 offset:0
  ds_read_b64_tr_b16 v[18:19], v38 offset:4096
  s_add_u32 m0, s62, 0
  s_add_u32 s67, s43, 229376
  buffer_load_dwordx4 v32, s[20:23], s67 offen  lds
  s_waitcnt lgkmcnt(8)
  v_mfma_f32_16x16x32_bf16 v[64:67], v[0:3], v[184:187], v[64:67]
  v_mfma_f32_16x16x32_bf16 v[68:71], v[0:3], v[188:191], v[68:71]
  v_mfma_f32_16x16x32_bf16 v[72:75], v[0:3], v[192:195], v[72:75]
  ds_read_b64_tr_b16 v[0:1], v39 offset:0
  ds_read_b64_tr_b16 v[2:3], v39 offset:4096
  s_add_u32 m0, s62, 1024
  s_add_u32 s67, s43, 232960
  buffer_load_dwordx4 v33, s[20:23], s67 offen  lds
  s_waitcnt lgkmcnt(8)
  v_mfma_f32_16x16x32_bf16 v[76:79], v[4:7], v[184:187], v[76:79]
  v_mfma_f32_16x16x32_bf16 v[80:83], v[4:7], v[188:191], v[80:83]
  v_mfma_f32_16x16x32_bf16 v[84:87], v[4:7], v[192:195], v[84:87]
  ds_read_b64_tr_b16 v[4:5], v40 offset:0
  ds_read_b64_tr_b16 v[6:7], v40 offset:4096
  s_add_u32 m0, s62, 2048
  s_add_u32 s67, s43, 236544
  buffer_load_dwordx4 v32, s[20:23], s67 offen  lds
  s_waitcnt lgkmcnt(8)
  v_mfma_f32_16x16x32_bf16 v[88:91], v[8:11], v[184:187], v[88:91]
  v_mfma_f32_16x16x32_bf16 v[92:95], v[8:11], v[188:191], v[92:95]
  v_mfma_f32_16x16x32_bf16 v[96:99], v[8:11], v[192:195], v[96:99]
  ds_read_b64_tr_b16 v[8:9], v41 offset:0
  ds_read_b64_tr_b16 v[10:11], v41 offset:4096
  s_add_u32 m0, s62, 3072
  s_add_u32 s67, s43, 240128
  buffer_load_dwordx4 v33, s[20:23], s67 offen  lds
  s_waitcnt lgkmcnt(8)
  v_mfma_f32_16x16x32_bf16 v[100:103], v[12:15], v[184:187], v[100:103]
  v_mfma_f32_16x16x32_bf16 v[104:107], v[12:15], v[188:191], v[104:107]
  v_mfma_f32_16x16x32_bf16 v[108:111], v[12:15], v[192:195], v[108:111]
  s_waitcnt vmcnt(4)
  ds_read_b64_tr_b16 v[12:13], v34 offset:8192
  ds_read_b64_tr_b16 v[14:15], v34 offset:12288
  s_add_u32 m0, s62, 4096
  s_add_u32 s67, s43, 243712
  buffer_load_dwordx4 v32, s[20:23], s67 offen  lds
  s_waitcnt lgkmcnt(8)
  v_mfma_f32_16x16x32_bf16 v[112:115], v[16:19], v[184:187], v[112:115]
  v_mfma_f32_16x16x32_bf16 v[116:119], v[16:19], v[188:191], v[116:119]
  v_mfma_f32_16x16x32_bf16 v[120:123], v[16:19], v[192:195], v[120:123]
  ds_read_b64_tr_b16 v[16:17], v35 offset:8192
  ds_read_b64_tr_b16 v[18:19], v35 offset:12288
  s_add_u32 m0, s62, 5120
  s_add_u32 s67, s43, 247296
  buffer_load_dwordx4 v33, s[20:23], s67 offen  lds
  s_waitcnt lgkmcnt(8)
  v_mfma_f32_16x16x32_bf16 v[124:127], v[0:3], v[184:187], v[124:127]
  v_mfma_f32_16x16x32_bf16 v[128:131], v[0:3], v[188:191], v[128:131]
  v_mfma_f32_16x16x32_bf16 v[132:135], v[0:3], v[192:195], v[132:135]
  ds_read_b64_tr_b16 v[0:1], v36 offset:8192
  ds_read_b64_tr_b16 v[2:3], v36 offset:12288
  s_add_u32 m0, s62, 6144
  s_add_u32 s67, s43, 250880
  buffer_load_dwordx4 v32, s[20:23], s67 offen  lds
  s_waitcnt lgkmcnt(8)
  v_mfma_f32_16x16x32_bf16 v[136:139], v[4:7], v[184:187], v[136:139]
  v_mfma_f32_16x16x32_bf16 v[140:143], v[4:7], v[188:191], v[140:143]
  v_mfma_f32_16x16x32_bf16 v[144:147], v[4:7], v[192:195], v[144:147]
  ds_read_b64_tr_b16 v[4:5], v37 offset:8192
  ds_read_b64_tr_b16 v[6:7], v37 offset:12288
  s_add_u32 m0, s62, 7168
  s_add_u32 s67, s43, 254464
  buffer_load_dwordx4 v33, s[20:23], s67 offen  lds
  s_waitcnt lgkmcnt(8)
  v_mfma_f32_16x16x32_bf16 v[148:151], v[8:11], v[184:187], v[148:151]
  v_mfma_f32_16x16x32_bf16 v[152:155], v[8:11], v[188:191], v[152:155]
  v_mfma_f32_16x16x32_bf16 v[156:159], v[8:11], v[192:195], v[156:159]
  ds_read_b64_tr_b16 v[8:9], v38 offset:8192
  ds_read_b64_tr_b16 v[10:11], v38 offset:12288
  s_add_u32 m0, s63, 0
  s_add_u32 s67, s43, 0
  buffer_load_dwordx4 v32, s[20:23], s67 offen  lds
  s_waitcnt lgkmcnt(8)
  v_mfma_f32_16x16x32_bf16 v[64:67], v[12:15], v[196:199], v[64:67]
  v_mfma_f32_16x16x32_bf16 v[68:71], v[12:15], v[200:203], v[68:71]
  v_mfma_f32_16x16x32_bf16 v[72:75], v[12:15], v[204:207], v[72:75]
  ds_read_b64_tr_b16 v[12:13], v39 offset:8192
  ds_read_b64_tr_b16 v[14:15], v39 offset:12288
  s_add_u32 m0, s63, 1024
  s_add_u32 s67, s43, 3584
  buffer_load_dwordx4 v33, s[20:23], s67 offen  lds
  s_waitcnt lgkmcnt(8)
  v_mfma_f32_16x16x32_bf16 v[76:79], v[16:19], v[196:199], v[76:79]
  v_mfma_f32_16x16x32_bf16 v[80:83], v[16:19], v[200:203], v[80:83]
  v_mfma_f32_16x16x32_bf16 v[84:87], v[16:19], v[204:207], v[84:87]
  ds_read_b64_tr_b16 v[16:17], v40 offset:8192
  ds_read_b64_tr_b16 v[18:19], v40 offset:12288
  s_add_u32 m0, s63, 2048
  s_add_u32 s67, s43, 7168
  buffer_load_dwordx4 v32, s[20:23], s67 offen  lds
  s_waitcnt lgkmcnt(8)
  v_mfma_f32_16x16x32_bf16 v[88:91], v[0:3], v[196:199], v[88:91]
  v_mfma_f32_16x16x32_bf16 v[92:95], v[0:3], v[200:203], v[92:95]
  v_mfma_f32_16x16x32_bf16 v[96:99], v[0:3], v[204:207], v[96:99]
  ds_read_b64_tr_b16 v[0:1], v41 offset:8192
  ds_read_b64_tr_b16 v[2:3], v41 offset:12288
  s_add_u32 m0, s63, 3072
  s_add_u32 s67, s43, 10752
  buffer_load_dwordx4 v33, s[20:23], s67 offen  lds
  s_waitcnt lgkmcnt(8)
  v_mfma_f32_16x16x32_bf16 v[100:103], v[4:7], v[196:199], v[100:103]
  v_mfma_f32_16x16x32_bf16 v[104:107], v[4:7], v[200:203], v[104:107]
  v_mfma_f32_16x16x32_bf16 v[108:111], v[4:7], v[204:207], v[108:111]
  s_add_u32 m0, s63, 4096
  s_add_u32 s67, s43, 14336
  buffer_load_dwordx4 v32, s[20:23], s67 offen  lds
  s_waitcnt lgkmcnt(6)
  v_mfma_f32_16x16x32_bf16 v[112:115], v[8:11], v[196:199], v[112:115]
  v_mfma_f32_16x16x32_bf16 v[116:119], v[8:11], v[200:203], v[116:119]
  v_mfma_f32_16x16x32_bf16 v[120:123], v[8:11], v[204:207], v[120:123]
  s_add_u32 m0, s63, 5120
  s_add_u32 s67, s43, 17920
  buffer_load_dwordx4 v33, s[20:23], s67 offen  lds
  s_waitcnt lgkmcnt(4)
  v_mfma_f32_16x16x32_bf16 v[124:127], v[12:15], v[196:199], v[124:127]
  v_mfma_f32_16x16x32_bf16 v[128:131], v[12:15], v[200:203], v[128:131]
  v_mfma_f32_16x16x32_bf16 v[132:135], v[12:15], v[204:207], v[132:135]
  s_add_u32 m0, s63, 6144
  s_add_u32 s67, s43, 21504
  buffer_load_dwordx4 v32, s[20:23], s67 offen  lds
  s_waitcnt lgkmcnt(2)
  v_mfma_f32_16x16x32_bf16 v[136:139], v[16:19], v[196:199], v[136:139]
  v_mfma_f32_16x16x32_bf16 v[140:143], v[16:19], v[200:203], v[140:143]
  v_mfma_f32_16x16x32_bf16 v[144:147], v[16:19], v[204:207], v[144:147]
  s_add_u32 m0, s63, 7168
  s_add_u32 s67, s43, 25088
  buffer_load_dwordx4 v33, s[20:23], s67 offen  lds
  s_waitcnt lgkmcnt(0)
  v_mfma_f32_16x16x32_bf16 v[148:151], v[0:3], v[196:199], v[148:151]
  v_mfma_f32_16x16x32_bf16 v[152:155], v[0:3], v[200:203], v[152:155]
  v_mfma_f32_16x16x32_bf16 v[156:159], v[0:3], v[204:207], v[156:159]
  s_add_u32 m0, s63, 8192
  s_add_u32 s67, s43, 28672
  buffer_load_dwordx4 v32, s[20:23], s67 offen  lds
  s_add_u32 m0, s63, 9216
  s_add_u32 s67, s43, 32256
  buffer_load_dwordx4 v33, s[20:23], s67 offen  lds
  s_add_u32 m0, s63, 10240
  s_add_u32 s67, s43, 35840
  buffer_load_dwordx4 v32, s[20:23], s67 offen  lds
  s_add_u32 m0, s63, 11264
  s_add_u32 s67, s43, 39424
  buffer_load_dwordx4 v33, s[20:23], s67 offen  lds
  s_add_u32 m0, s63, 12288
  s_add_u32 s67, s43, 43008
  buffer_load_dwordx4 v32, s[20:23], s67 offen  lds
  s_add_u32 m0, s63, 13312
  s_add_u32 s67, s43, 46592
  buffer_load_dwordx4 v33, s[20:23], s67 offen  lds
  s_add_u32 m0, s63, 14336
  s_add_u32 s67, s43, 50176
  buffer_load_dwordx4 v32, s[20:23], s67 offen  lds
  s_add_u32 m0, s63, 15360
  s_add_u32 s67, s43, 53760
  buffer_load_dwordx4 v33, s[20:23], s67 offen  lds
  s_barrier
  ds_read_b128 v[160:163], v42 offset:0
  ds_read_b128 v[164:167], v42 offset:2048
  ds_read_b128 v[168:171], v42 offset:4096
  s_waitcnt vmcnt(8)
  ds_read_b64_tr_b16 v[0:1], v34 offset:0
  ds_read_b64_tr_b16 v[2:3], v34 offset:4096
  ds_read_b64_tr_b16 v[4:5], v35 offset:0
  ds_read_b64_tr_b16 v[6:7], v35 offset:4096
  ds_read_b64_tr_b16 v[8:9], v36 offset:0
  ds_read_b64_tr_b16 v[10:11], v36 offset:4096
  ds_read_b64_tr_b16 v[12:13], v37 offset:0
  ds_read_b64_tr_b16 v[14:15], v37 offset:4096
  ds_read_b64_tr_b16 v[16:17], v38 offset:0
  ds_read_b64_tr_b16 v[18:19], v38 offset:4096
  ds_read_b128 v[172:175], v43 offset:0
  ds_read_b128 v[176:179], v43 offset:2048
  s_waitcnt lgkmcnt(14)
  ds_read_b128 v[180:183], v43 offset:4096
  s_add_u32 m0, s62, 32768
  s_add_u32 s67, s43, 258048
  buffer_load_dwordx4 v32, s[20:23], s67 offen  lds
  s_waitcnt lgkmcnt(11)
  v_mfma_f32_16x16x32_bf16 v[64:67], v[0:3], v[160:163], v[64:67]
  v_mfma_f32_16x16x32_bf16 v[68:71], v[0:3], v[164:167], v[68:71]
  v_mfma_f32_16x16x32_bf16 v[72:75], v[0:3], v[168:171], v[72:75]
  ds_read_b64_tr_b16 v[0:1], v39 offset:0
  ds_read_b64_tr_b16 v[2:3], v39 offset:4096
  ds_read_b128 v[184:187], v42 offset:6144
  ds_read_b128 v[188:191], v42 offset:8192
  s_waitcnt lgkmcnt(14)
  ds_read_b128 v[192:195], v42 offset:10240
  s_add_u32 m0, s62, 33792
  s_add_u32 s67, s43, 261632
  buffer_load_dwordx4 v33, s[20:23], s67 offen  lds
  s_waitcnt lgkmcnt(14)
  v_mfma_f32_16x16x32_bf16 v[76:79], v[4:7], v[160:163], v[76:79]
  v_mfma_f32_16x16x32_bf16 v[80:83], v[4:7], v[164:167], v[80:83]
  v_mfma_f32_16x16x32_bf16 v[84:87], v[4:7], v[168:171], v[84:87]
  s_waitcnt lgkmcnt(13)
  ds_read_b64_tr_b16 v[4:5], v40 offset:0
  ds_read_b64_tr_b16 v[6:7], v40 offset:4096
  s_waitcnt lgkmcnt(14)
  ds_read_b128 v[196:199], v43 offset:6144
  s_waitcnt lgkmcnt(14)
  ds_read_b128 v[200:203], v43 offset:8192
  s_waitcnt lgkmcnt(14)
  ds_read_b128 v[204:207], v43 offset:10240
  s_add_u32 m0, s62, 34816
  s_add_u32 s67, s43, 265216
  buffer_load_dwordx4 v32, s[20:23], s67 offen  lds
  v_mfma_f32_16x16x32_bf16 v[88:91], v[8:11], v[160:163], v[88:91]
  v_mfma_f32_16x16x32_bf16 v[92:95], v[8:11], v[164:167], v[92:95]
  v_mfma_f32_16x16x32_bf16 v[96:99], v[8:11], v[168:171], v[96:99]
  s_waitcnt lgkmcnt(13)
  ds_read_b64_tr_b16 v[8:9], v41 offset:0
  ds_read_b64_tr_b16 v[10:11], v41 offset:4096
  s_add_u32 m0, s62, 35840
  s_add_u32 s67, s43, 268800
  buffer_load_dwordx4 v33, s[20:23], s67 offen  lds
  v_mfma_f32_16x16x32_bf16 v[100:103], v[12:15], v[160:163], v[100:103]
  v_mfma_f32_16x16x32_bf16 v[104:107], v[12:15], v[164:167], v[104:107]
  v_mfma_f32_16x16x32_bf16 v[108:111], v[12:15], v[168:171], v[108:111]
  s_waitcnt vmcnt(4)
  s_waitcnt lgkmcnt(13)
  ds_read_b64_tr_b16 v[12:13], v34 offset:8192
  ds_read_b64_tr_b16 v[14:15], v34 offset:12288
  s_add_u32 m0, s62, 36864
  s_add_u32 s67, s43, 272384
  buffer_load_dwordx4 v32, s[20:23], s67 offen  lds
  v_mfma_f32_16x16x32_bf16 v[112:115], v[16:19], v[160:163], v[112:115]
  v_mfma_f32_16x16x32_bf16 v[116:119], v[16:19], v[164:167], v[116:119]
  v_mfma_f32_16x16x32_bf16 v[120:123], v[16:19], v[168:171], v[120:123]
  s_waitcnt lgkmcnt(13)
  ds_read_b64_tr_b16 v[16:17], v35 offset:8192
  ds_read_b64_tr_b16 v[18:19], v35 offset:12288
  s_add_u32 m0, s62, 37888
  s_add_u32 s67, s43, 275968
  buffer_load_dwordx4 v33, s[20:23], s67 offen  lds
  s_waitcnt lgkmcnt(14)
  v_mfma_f32_16x16x32_bf16 v[124:127], v[0:3], v[160:163], v[124:127]
  v_mfma_f32_16x16x32_bf16 v[128:131], v[0:3], v[164:167], v[128:131]
  v_mfma_f32_16x16x32_bf16 v[132:135], v[0:3], v[168:171], v[132:135]
  s_waitcnt lgkmcnt(13)
  ds_read_b64_tr_b16 v[0:1], v36 offset:8192
  ds_read_b64_tr_b16 v[2:3], v36 offset:12288
  s_add_u32 m0, s62, 38912
  s_add_u32 s67, s43, 279552
  buffer_load_dwordx4 v32, s[20:23], s67 offen  lds
  s_waitcnt lgkmcnt(11)
  v_mfma_f32_16x16x32_bf16 v[136:139], v[4:7], v[160:163], v[136:139]
  v_mfma_f32_16x16x32_bf16 v[140:143], v[4:7], v[164:167], v[140:143]
  v_mfma_f32_16x16x32_bf16 v[144:147], v[4:7], v[168:171], v[144:147]
  ds_read_b64_tr_b16 v[4:5], v37 offset:8192
  ds_read_b64_tr_b16 v[6:7], v37 offset:12288
  s_add_u32 m0, s62, 39936
  s_add_u32 s67, s43, 283136
  buffer_load_dwordx4 v33, s[20:23], s67 offen  lds
  s_waitcnt lgkmcnt(8)
  v_mfma_f32_16x16x32_bf16 v[148:151], v[8:11], v[160:163], v[148:151]
  v_mfma_f32_16x16x32_bf16 v[152:155], v[8:11], v[164:167], v[152:155]
  v_mfma_f32_16x16x32_bf16 v[156:159], v[8:11], v[168:171], v[156:159]
  ds_read_b64_tr_b16 v[8:9], v38 offset:8192
  ds_read_b64_tr_b16 v[10:11], v38 offset:12288
  s_waitcnt lgkmcnt(8)
  v_mfma_f32_16x16x32_bf16 v[64:67], v[12:15], v[172:175], v[64:67]
  v_mfma_f32_16x16x32_bf16 v[68:71], v[12:15], v[176:179], v[68:71]
  v_mfma_f32_16x16x32_bf16 v[72:75], v[12:15], v[180:183], v[72:75]
  ds_read_b64_tr_b16 v[12:13], v39 offset:8192
  ds_read_b64_tr_b16 v[14:15], v39 offset:12288
  s_waitcnt lgkmcnt(8)
  v_mfma_f32_16x16x32_bf16 v[76:79], v[16:19], v[172:175], v[76:79]
  v_mfma_f32_16x16x32_bf16 v[80:83], v[16:19], v[176:179], v[80:83]
  v_mfma_f32_16x16x32_bf16 v[84:87], v[16:19], v[180:183], v[84:87]
  ds_read_b64_tr_b16 v[16:17], v40 offset:8192
  ds_read_b64_tr_b16 v[18:19], v40 offset:12288
  s_waitcnt lgkmcnt(8)
  v_mfma_f32_16x16x32_bf16 v[88:91], v[0:3], v[172:175], v[88:91]
  v_mfma_f32_16x16x32_bf16 v[92:95], v[0:3], v[176:179], v[92:95]
  v_mfma_f32_16x16x32_bf16 v[96:99], v[0:3], v[180:183], v[96:99]
  ds_read_b64_tr_b16 v[0:1], v41 offset:8192
  ds_read_b64_tr_b16 v[2:3], v41 offset:12288
  s_waitcnt lgkmcnt(8)
  v_mfma_f32_16x16x32_bf16 v[100:103], v[4:7], v[172:175], v[100:103]
  v_mfma_f32_16x16x32_bf16 v[104:107], v[4:7], v[176:179], v[104:107]
  v_mfma_f32_16x16x32_bf16 v[108:111], v[4:7], v[180:183], v[108:111]
  s_waitcnt lgkmcnt(6)
  v_mfma_f32_16x16x32_bf16 v[112:115], v[8:11], v[172:175], v[112:115]
  v_mfma_f32_16x16x32_bf16 v[116:119], v[8:11], v[176:179], v[116:119]
  v_mfma_f32_16x16x32_bf16 v[120:123], v[8:11], v[180:183], v[120:123]
  s_waitcnt lgkmcnt(4)
  v_mfma_f32_16x16x32_bf16 v[124:127], v[12:15], v[172:175], v[124:127]
  v_mfma_f32_16x16x32_bf16 v[128:131], v[12:15], v[176:179], v[128:131]
  v_mfma_f32_16x16x32_bf16 v[132:135], v[12:15], v[180:183], v[132:135]
  s_waitcnt lgkmcnt(2)
  v_mfma_f32_16x16x32_bf16 v[136:139], v[16:19], v[172:175], v[136:139]
  v_mfma_f32_16x16x32_bf16 v[140:143], v[16:19], v[176:179], v[140:143]
  v_mfma_f32_16x16x32_bf16 v[144:147], v[16:19], v[180:183], v[144:147]
  s_waitcnt lgkmcnt(0)
  v_mfma_f32_16x16x32_bf16 v[148:151], v[0:3], v[172:175], v[148:151]
  v_mfma_f32_16x16x32_bf16 v[152:155], v[0:3], v[176:179], v[152:155]
  v_mfma_f32_16x16x32_bf16 v[156:159], v[0:3], v[180:183], v[156:159]
  v_mbcnt_lo_u32_b32 v48, -1, 0
  v_mbcnt_hi_u32_b32 v48, -1, v48
  v_lshlrev_b32 v48, 4, v48
  s_mul_i32 s68, s2, 43008
  s_mul_i32 s69, s4, 12288
  s_add_u32 s68, s68, s69
  s_waitcnt vmcnt(0)
  ds_read_b64_tr_b16 v[0:1], v208 offset:0
  ds_read_b64_tr_b16 v[2:3], v208 offset:4096
  ds_read_b64_tr_b16 v[4:5], v209 offset:0
  ds_read_b64_tr_b16 v[6:7], v209 offset:4096
  ds_read_b64_tr_b16 v[8:9], v208 offset:32768
  ds_read_b64_tr_b16 v[10:11], v208 offset:36864
  ds_read_b64_tr_b16 v[12:13], v209 offset:32768
  ds_read_b64_tr_b16 v[14:15], v209 offset:36864
  ds_read_b64_tr_b16 v[16:17], v210 offset:0
  ds_read_b64_tr_b16 v[18:19], v210 offset:4096
  s_waitcnt lgkmcnt(8)
  v_mfma_f32_16x16x32_bf16 v[64:67], v[0:3], v[184:187], v[64:67]
  v_mfma_f32_16x16x32_bf16 v[68:71], v[0:3], v[188:191], v[68:71]
  v_mfma_f32_16x16x32_bf16 v[72:75], v[0:3], v[192:195], v[72:75]
  ds_read_b64_tr_b16 v[0:1], v211 offset:0
  ds_read_b64_tr_b16 v[2:3], v211 offset:4096
  s_waitcnt lgkmcnt(8)
  v_mfma_f32_16x16x32_bf16 v[76:79], v[4:7], v[184:187], v[76:79]
  v_mfma_f32_16x16x32_bf16 v[80:83], v[4:7], v[188:191], v[80:83]
  v_mfma_f32_16x16x32_bf16 v[84:87], v[4:7], v[192:195], v[84:87]
  ds_read_b64_tr_b16 v[4:5], v210 offset:32768
  ds_read_b64_tr_b16 v[6:7], v210 offset:36864
  s_waitcnt lgkmcnt(8)
  v_mfma_f32_16x16x32_bf16 v[64:67], v[8:11], v[196:199], v[64:67]
  v_mfma_f32_16x16x32_bf16 v[68:71], v[8:11], v[200:203], v[68:71]
  v_mfma_f32_16x16x32_bf16 v[72:75], v[8:11], v[204:207], v[72:75]
  ds_read_b64_tr_b16 v[8:9], v211 offset:32768
  ds_read_b64_tr_b16 v[10:11], v211 offset:36864
  s_waitcnt lgkmcnt(8)
  v_mfma_f32_16x16x32_bf16 v[76:79], v[12:15], v[196:199], v[76:79]
  v_mfma_f32_16x16x32_bf16 v[80:83], v[12:15], v[200:203], v[80:83]
  v_mfma_f32_16x16x32_bf16 v[84:87], v[12:15], v[204:207], v[84:87]
  ds_read_b64_tr_b16 v[12:13], v212 offset:0
  ds_read_b64_tr_b16 v[14:15], v212 offset:4096
  s_waitcnt lgkmcnt(8)
  v_mfma_f32_16x16x32_bf16 v[88:91], v[16:19], v[184:187], v[88:91]
  v_mfma_f32_16x16x32_bf16 v[92:95], v[16:19], v[188:191], v[92:95]
  v_mfma_f32_16x16x32_bf16 v[96:99], v[16:19], v[192:195], v[96:99]
  ds_read_b64_tr_b16 v[16:17], v213 offset:0
  ds_read_b64_tr_b16 v[18:19], v213 offset:4096
  s_waitcnt lgkmcnt(8)
  v_mfma_f32_16x16x32_bf16 v[100:103], v[0:3], v[184:187], v[100:103]
  v_mfma_f32_16x16x32_bf16 v[104:107], v[0:3], v[188:191], v[104:107]
  v_mfma_f32_16x16x32_bf16 v[108:111], v[0:3], v[192:195], v[108:111]
  v_cvt_pk_bf16_f32 v216, v64, v65
  v_cvt_pk_bf16_f32 v217, v66, v67
  v_cvt_pk_bf16_f32 v218, v76, v77
  v_cvt_pk_bf16_f32 v219, v78, v79
  s_add_u32 s67, s68, 0
  buffer_store_dwordx4 v[216:219], v48, s[32:35], s67 offen sc0 sc1
  v_cvt_pk_bf16_f32 v220, v68, v69
  v_cvt_pk_bf16_f32 v221, v70, v71
  v_cvt_pk_bf16_f32 v222, v80, v81
  v_cvt_pk_bf16_f32 v223, v82, v83
  s_add_u32 s67, s68, 1024
  buffer_store_dwordx4 v[220:223], v48, s[32:35], s67 offen sc0 sc1
  v_cvt_pk_bf16_f32 v224, v72, v73
  v_cvt_pk_bf16_f32 v225, v74, v75
  v_cvt_pk_bf16_f32 v226, v84, v85
  v_cvt_pk_bf16_f32 v227, v86, v87
  s_add_u32 s67, s68, 2048
  buffer_store_dwordx4 v[224:227], v48, s[32:35], s67 offen sc0 sc1
  ds_read_b64_tr_b16 v[0:1], v212 offset:32768
  ds_read_b64_tr_b16 v[2:3], v212 offset:36864
  s_waitcnt lgkmcnt(8)
  v_mfma_f32_16x16x32_bf16 v[88:91], v[4:7], v[196:199], v[88:91]
  v_mfma_f32_16x16x32_bf16 v[92:95], v[4:7], v[200:203], v[92:95]
  v_mfma_f32_16x16x32_bf16 v[96:99], v[4:7], v[204:207], v[96:99]
  ds_read_b64_tr_b16 v[4:5], v213 offset:32768
  ds_read_b64_tr_b16 v[6:7], v213 offset:36864
  s_waitcnt lgkmcnt(8)
  v_mfma_f32_16x16x32_bf16 v[100:103], v[8:11], v[196:199], v[100:103]
  v_mfma_f32_16x16x32_bf16 v[104:107], v[8:11], v[200:203], v[104:107]
  v_mfma_f32_16x16x32_bf16 v[108:111], v[8:11], v[204:207], v[108:111]
  ds_read_b64_tr_b16 v[8:9], v214 offset:0
  ds_read_b64_tr_b16 v[10:11], v214 offset:4096
  s_waitcnt lgkmcnt(8)
  v_mfma_f32_16x16x32_bf16 v[112:115], v[12:15], v[184:187], v[112:115]
  v_mfma_f32_16x16x32_bf16 v[116:119], v[12:15], v[188:191], v[116:119]
  v_mfma_f32_16x16x32_bf16 v[120:123], v[12:15], v[192:195], v[120:123]
  ds_read_b64_tr_b16 v[12:13], v215 offset:0
  ds_read_b64_tr_b16 v[14:15], v215 offset:4096
  s_waitcnt lgkmcnt(8)
  v_mfma_f32_16x16x32_bf16 v[124:127], v[16:19], v[184:187], v[124:127]
  v_mfma_f32_16x16x32_bf16 v[128:131], v[16:19], v[188:191], v[128:131]
  v_mfma_f32_16x16x32_bf16 v[132:135], v[16:19], v[192:195], v[132:135]
  v_cvt_pk_bf16_f32 v228, v88, v89
  v_cvt_pk_bf16_f32 v229, v90, v91
  v_cvt_pk_bf16_f32 v230, v100, v101
  v_cvt_pk_bf16_f32 v231, v102, v103
  s_add_u32 s67, s68, 3072
  buffer_store_dwordx4 v[228:231], v48, s[32:35], s67 offen sc0 sc1
  v_cvt_pk_bf16_f32 v232, v92, v93
  v_cvt_pk_bf16_f32 v233, v94, v95
  v_cvt_pk_bf16_f32 v234, v104, v105
  v_cvt_pk_bf16_f32 v235, v106, v107
  s_add_u32 s67, s68, 4096
  buffer_store_dwordx4 v[232:235], v48, s[32:35], s67 offen sc0 sc1
  v_cvt_pk_bf16_f32 v236, v96, v97
  v_cvt_pk_bf16_f32 v237, v98, v99
  v_cvt_pk_bf16_f32 v238, v108, v109
  v_cvt_pk_bf16_f32 v239, v110, v111
  s_add_u32 s67, s68, 5120
  buffer_store_dwordx4 v[236:239], v48, s[32:35], s67 offen sc0 sc1
  ds_read_b64_tr_b16 v[16:17], v214 offset:32768
  ds_read_b64_tr_b16 v[18:19], v214 offset:36864
  s_waitcnt lgkmcnt(8)
  v_mfma_f32_16x16x32_bf16 v[112:115], v[0:3], v[196:199], v[112:115]
  v_mfma_f32_16x16x32_bf16 v[116:119], v[0:3], v[200:203], v[116:119]
  v_mfma_f32_16x16x32_bf16 v[120:123], v[0:3], v[204:207], v[120:123]
  ds_read_b64_tr_b16 v[0:1], v215 offset:32768
  ds_read_b64_tr_b16 v[2:3], v215 offset:36864
  s_waitcnt lgkmcnt(8)
  v_mfma_f32_16x16x32_bf16 v[124:127], v[4:7], v[196:199], v[124:127]
  v_mfma_f32_16x16x32_bf16 v[128:131], v[4:7], v[200:203], v[128:131]
  v_mfma_f32_16x16x32_bf16 v[132:135], v[4:7], v[204:207], v[132:135]
  s_waitcnt lgkmcnt(6)
  v_mfma_f32_16x16x32_bf16 v[136:139], v[8:11], v[184:187], v[136:139]
  v_mfma_f32_16x16x32_bf16 v[140:143], v[8:11], v[188:191], v[140:143]
  v_mfma_f32_16x16x32_bf16 v[144:147], v[8:11], v[192:195], v[144:147]
  s_waitcnt lgkmcnt(4)
  v_mfma_f32_16x16x32_bf16 v[148:151], v[12:15], v[184:187], v[148:151]
  v_mfma_f32_16x16x32_bf16 v[152:155], v[12:15], v[188:191], v[152:155]
  v_mfma_f32_16x16x32_bf16 v[156:159], v[12:15], v[192:195], v[156:159]
  v_cvt_pk_bf16_f32 v240, v112, v113
  v_cvt_pk_bf16_f32 v241, v114, v115
  v_cvt_pk_bf16_f32 v242, v124, v125
  v_cvt_pk_bf16_f32 v243, v126, v127
  s_add_u32 s67, s68, 6144
  buffer_store_dwordx4 v[240:243], v48, s[32:35], s67 offen sc0 sc1
  v_cvt_pk_bf16_f32 v244, v116, v117
  v_cvt_pk_bf16_f32 v245, v118, v119
  v_cvt_pk_bf16_f32 v246, v128, v129
  v_cvt_pk_bf16_f32 v247, v130, v131
  s_add_u32 s67, s68, 7168
  buffer_store_dwordx4 v[244:247], v48, s[32:35], s67 offen sc0 sc1
  v_cvt_pk_bf16_f32 v248, v120, v121
  v_cvt_pk_bf16_f32 v249, v122, v123
  v_cvt_pk_bf16_f32 v250, v132, v133
  v_cvt_pk_bf16_f32 v251, v134, v135
  s_add_u32 s67, s68, 8192
  buffer_store_dwordx4 v[248:251], v48, s[32:35], s67 offen sc0 sc1
  s_waitcnt lgkmcnt(2)
  v_mfma_f32_16x16x32_bf16 v[136:139], v[16:19], v[196:199], v[136:139]
  v_mfma_f32_16x16x32_bf16 v[140:143], v[16:19], v[200:203], v[140:143]
  v_mfma_f32_16x16x32_bf16 v[144:147], v[16:19], v[204:207], v[144:147]
  s_waitcnt lgkmcnt(0)
  v_mfma_f32_16x16x32_bf16 v[148:151], v[0:3], v[196:199], v[148:151]
  v_mfma_f32_16x16x32_bf16 v[152:155], v[0:3], v[200:203], v[152:155]
  v_mfma_f32_16x16x32_bf16 v[156:159], v[0:3], v[204:207], v[156:159]
  s_nop 1
  v_cvt_pk_bf16_f32 v252, v136, v137
  v_cvt_pk_bf16_f32 v253, v138, v139
  s_nop 1
  v_cvt_pk_bf16_f32 v254, v148, v149
  v_cvt_pk_bf16_f32 v255, v150, v151
  s_add_u32 s67, s68, 9216
  buffer_store_dwordx4 v[252:255], v48, s[32:35], s67 offen sc0 sc1
  v_cvt_pk_bf16_f32 v20, v140, v141
  v_cvt_pk_bf16_f32 v21, v142, v143
  v_cvt_pk_bf16_f32 v22, v152, v153
  v_cvt_pk_bf16_f32 v23, v154, v155
  s_add_u32 s67, s68, 10240
  buffer_store_dwordx4 v[20:23], v48, s[32:35], s67 offen sc0 sc1
  v_cvt_pk_bf16_f32 v24, v144, v145
  v_cvt_pk_bf16_f32 v25, v146, v147
  v_cvt_pk_bf16_f32 v26, v156, v157
  v_cvt_pk_bf16_f32 v27, v158, v159
  s_add_u32 s67, s68, 11264
  buffer_store_dwordx4 v[24:27], v48, s[32:35], s67 offen sc0 sc1
  s_waitcnt vmcnt(0)
  s_mul_i32 s66, s76, 8448
  s_add_u32 s66, s66, 16777216
  s_lshl_b32 s67, s5, 2
  s_add_u32 s67, s67, s4
  s_lshl_b32 s67, s67, 2
  v_mov_b32 v2, s67
  v_mov_b32 v1, 1
  s_mov_b64 s[70:71], exec
  s_mov_b64 exec, 1
  buffer_store_dword v1, v2, s[32:35], s66 offen sc0 sc1
  s_mov_b64 exec, s[70:71]
  s_branch L_tail
L_P3:
  s_lshl_b32 s62, s4, 13
  v_mbcnt_lo_u32_b32 v48, -1, 0
  v_mbcnt_hi_u32_b32 v48, -1, v48
  v_lshrrev_b32 v50, 4, v48
  v_lshrrev_b32 v51, 3, v48
  v_lshlrev_b32 v51, 9, v51
  s_lshl_b32 s67, s4, 15
  v_add_u32 v51, s67, v51
  v_and_b32 v52, 7, v48
  v_xor_b32 v53, v52, v50
  v_lshl_add_u32 v44, v53, 4, v51
  v_xor_b32 v53, 4, v53
  v_lshl_add_u32 v45, v53, 4, v51
  v_lshrrev_b32 v53, 1, v52
  v_xor_b32 v53, v53, v50
  v_lshl_add_u32 v53, v53, 5, v51
  v_and_b32 v52, 1, v48
  v_lshl_add_u32 v46, v52, 4, v53
  v_lshlrev_b32 v56, 7, v48
  s_add_u32 m0, s62, 65536
  s_add_u32 s67, s39, 0
  buffer_load_dwordx4 v44, s[8:11], s67 offen nt lds
  s_add_u32 m0, s62, 66560
  s_add_u32 s67, s39, 4096
  buffer_load_dwordx4 v45, s[8:11], s67 offen nt lds
  s_add_u32 m0, s62, 67584
  s_add_u32 s67, s39, 8192
  buffer_load_dwordx4 v44, s[8:11], s67 offen nt lds
  s_add_u32 m0, s62, 68608
  s_add_u32 s67, s39, 12288
  buffer_load_dwordx4 v45, s[8:11], s67 offen nt lds
  s_add_u32 m0, s62, 69632
  s_add_u32 s67, s39, 16384
  buffer_load_dwordx4 v44, s[8:11], s67 offen nt lds
  s_add_u32 m0, s62, 70656
  s_add_u32 s67, s39, 20480
  buffer_load_dwordx4 v45, s[8:11], s67 offen nt lds
  s_add_u32 m0, s62, 71680
  s_add_u32 s67, s39, 24576
  buffer_load_dwordx4 v44, s[8:11], s67 offen nt lds
  s_add_u32 m0, s62, 72704
  s_add_u32 s67, s39, 28672
  buffer_load_dwordx4 v45, s[8:11], s67 offen nt lds
  v_mbcnt_lo_u32_b32 v48, -1, 0
  v_mbcnt_hi_u32_b32 v48, -1, v48
  v_and_b32 v49, 15, v48
  v_lshrrev_b32 v50, 4, v48
  s_lshl_b32 s66, s4, 8
  v_lshrrev_b32 v51, 3, v48
  s_mov_b32 s67, 896
  v_mul_lo_u32 v52, s67, v51
  v_bfe_u32 v51, v48, 1, 2
  v_xor_b32 v51, v51, v50
  v_lshl_add_u32 v52, v51, 5, v52
  v_and_b32 v53, 1, v48
  v_lshl_add_u32 v52, v53, 4, v52
  v_add_u32 v32, s66, v52
  v_lshrrev_b32 v51, 2, v48
  v_lshrrev_b32 v52, 1, v51
  v_and_b32 v52, 3, v52
  v_lshlrev_b32 v53, 7, v51
  v_and_b32 v54, 3, v48
  v_lshl_add_u32 v53, v54, 3, v53
  s_lshl_b32 s67, s4, 13
  v_xor_b32 v54, 0, v52
  v_lshl_add_u32 v55, v54, 5, v53
  v_add_u32 v34, s63, v55
  v_add_u32 v208, s67, v55
  v_xor_b32 v54, 1, v52
  v_lshl_add_u32 v55, v54, 5, v53
  v_add_u32 v35, s63, v55
  v_add_u32 v209, s67, v55
  v_xor_b32 v54, 2, v52
  v_lshl_add_u32 v55, v54, 5, v53
  v_add_u32 v36, s63, v55
  v_add_u32 v210, s67, v55
  v_xor_b32 v54, 3, v52
  v_lshl_add_u32 v55, v54, 5, v53
  v_add_u32 v37, s63, v55
  v_add_u32 v211, s67, v55
  v_lshrrev_b32 v51, 1, v49
  v_xor_b32 v51, v50, v51
  v_lshlrev_b32 v52, 7, v49
  v_add_u32 v52, 122880, v52
  v_lshl_add_u32 v42, v51, 4, v52
  v_xor_b32 v51, 4, v51
  v_lshl_add_u32 v43, v51, 4, v52
  s_lshl_b32 s62, s4, 13
  s_barrier
  s_add_u32 m0, s62, 98304
  s_add_u32 s67, s39, 131072
  buffer_load_dwordx4 v44, s[8:11], s67 offen nt lds
  s_add_u32 m0, s62, 99328
  s_add_u32 s67, s39, 135168
  buffer_load_dwordx4 v45, s[8:11], s67 offen nt lds
  s_add_u32 m0, s62, 100352
  s_add_u32 s67, s39, 139264
  buffer_load_dwordx4 v44, s[8:11], s67 offen nt lds
  s_add_u32 m0, s62, 101376
  s_add_u32 s67, s39, 143360
  buffer_load_dwordx4 v45, s[8:11], s67 offen nt lds
  s_add_u32 m0, s62, 102400
  s_add_u32 s67, s39, 147456
  buffer_load_dwordx4 v44, s[8:11], s67 offen nt lds
  s_add_u32 m0, s62, 103424
  s_add_u32 s67, s39, 151552
  buffer_load_dwordx4 v45, s[8:11], s67 offen nt lds
  s_add_u32 m0, s62, 104448
  s_add_u32 s67, s39, 155648
  buffer_load_dwordx4 v44, s[8:11], s67 offen nt lds
  s_add_u32 m0, s62, 105472
  s_add_u32 s67, s39, 159744
  buffer_load_dwordx4 v45, s[8:11], s67 offen nt lds
  s_waitcnt vmcnt(8)
  s_barrier
  s_add_u32 m0, s62, 0
  s_add_u32 s67, s36, 0
  buffer_load_dwordx4 v46, s[12:15], s67 offen nt lds
  s_add_u32 m0, s62, 1024
  s_add_u32 s67, s36, 4096
  buffer_load_dwordx4 v46, s[12:15], s67 offen nt lds
  s_add_u32 m0, s62, 2048
  s_add_u32 s67, s36, 8192
  buffer_load_dwordx4 v46, s[12:15], s67 offen nt lds
  s_add_u32 m0, s62, 3072
  s_add_u32 s67, s36, 12288
  buffer_load_dwordx4 v46, s[12:15], s67 offen nt lds
  s_add_u32 m0, s62, 4096
  s_add_u32 s67, s36, 16384
  buffer_load_dwordx4 v46, s[12:15], s67 offen nt lds
  s_add_u32 m0, s62, 5120
  s_add_u32 s67, s36, 20480
  buffer_load_dwordx4 v46, s[12:15], s67 offen nt lds
  s_add_u32 m0, s62, 6144
  s_add_u32 s67, s36, 24576
  buffer_load_dwordx4 v46, s[12:15], s67 offen nt lds
  s_add_u32 m0, s62, 7168
  s_add_u32 s67, s36, 28672
  buffer_load_dwordx4 v46, s[12:15], s67 offen nt lds
  s_waitcnt vmcnt(8)
  s_barrier
  s_add_u32 m0, s62, 32768
  s_add_u32 s67, s36, 131072
  buffer_load_dwordx4 v46, s[12:15], s67 offen nt lds
  s_add_u32 m0, s62, 33792
  s_add_u32 s67, s36, 135168
  buffer_load_dwordx4 v46, s[12:15], s67 offen nt lds
  s_add_u32 m0, s62, 34816
  s_add_u32 s67, s36, 139264
  buffer_load_dwordx4 v46, s[12:15], s67 offen nt lds
  s_add_u32 m0, s62, 35840
  s_add_u32 s67, s36, 143360
  buffer_load_dwordx4 v46, s[12:15], s67 offen nt lds
  s_add_u32 m0, s62, 36864
  s_add_u32 s67, s36, 147456
  buffer_load_dwordx4 v46, s[12:15], s67 offen nt lds
  s_add_u32 m0, s62, 37888
  s_add_u32 s67, s36, 151552
  buffer_load_dwordx4 v46, s[12:15], s67 offen nt lds
  s_add_u32 m0, s62, 38912
  s_add_u32 s67, s36, 155648
  buffer_load_dwordx4 v46, s[12:15], s67 offen nt lds
  s_add_u32 m0, s62, 39936
  s_add_u32 s67, s36, 159744
  buffer_load_dwordx4 v46, s[12:15], s67 offen nt lds
  s_mul_i32 s68, s6, 28672
  s_lshl_b32 s69, s4, 13
  s_add_u32 s68, s68, s69
  s_cmp_eq_u32 s4, 3
  s_cselect_b32 exec_hi, 0, -1
  buffer_load_dword v57, v56, s[20:23], s68 offen
  s_mov_b32 exec_hi, -1
  s_lshl_b32 s66, s6, 4
  s_lshl_b32 s67, s7, 2
  s_add_u32 s66, s66, s67
  s_mul_i32 s66, s66, 43008
  v_mov_b32 v58, s66
  s_add_u32 s67, s66, 516092
  v_writelane_b32 v58, s67, 1
  s_mul_i32 s67, s2, 43008
  v_writelane_b32 v58, s67, 2
  s_mul_i32 s67, s76, 8448
  s_add_u32 s67, s67, 16777216
  v_writelane_b32 v58, s67, 3
  s_mul_i32 s68, s6, 86016
  s_mov_b64 s[70:71], exec
  s_mov_b64 exec, 0xf
  buffer_load_dword v59, v58, s[32:35], 0 offen sc0 sc1
  s_mov_b64 exec, 1
  v_mov_b32 v60, 0
  buffer_load_dword v59, v60, s[28:31], s68 offen sc0 sc1
  s_mov_b64 exec, s[70:71]
  s_waitcnt vmcnt(11)
  s_barrier
  s_waitcnt vmcnt(3)
  s_barrier
  s_add_u32 m0, s62, 0
  s_add_u32 s67, s37, 0
  buffer_load_dwordx4 v46, s[12:15], s67 offen nt lds
  s_add_u32 m0, s62, 1024
  s_add_u32 s67, s37, 4096
  buffer_load_dwordx4 v46, s[12:15], s67 offen nt lds
  s_add_u32 m0, s62, 2048
  s_add_u32 s67, s37, 8192
  buffer_load_dwordx4 v46, s[12:15], s67 offen nt lds
  s_add_u32 m0, s62, 3072
  s_add_u32 s67, s37, 12288
  buffer_load_dwordx4 v46, s[12:15], s67 offen nt lds
  s_add_u32 m0, s62, 4096
  s_add_u32 s67, s37, 16384
  buffer_load_dwordx4 v46, s[12:15], s67 offen nt lds
  s_add_u32 m0, s62, 5120
  s_add_u32 s67, s37, 20480
  buffer_load_dwordx4 v46, s[12:15], s67 offen nt lds
  s_add_u32 m0, s62, 6144
  s_add_u32 s67, s37, 24576
  buffer_load_dwordx4 v46, s[12:15], s67 offen nt lds
  s_add_u32 m0, s62, 7168
  s_add_u32 s67, s37, 28672
  buffer_load_dwordx4 v46, s[12:15], s67 offen nt lds
  s_add_u32 m0, s63, 0
  s_add_u32 s67, s40, 0
  buffer_load_dwordx4 v32, s[20:23], s67 offen  lds
  s_add_u32 m0, s63, 1024
  s_add_u32 s67, s40, 7168
  buffer_load_dwordx4 v32, s[20:23], s67 offen  lds
  s_add_u32 m0, s63, 2048
  s_add_u32 s67, s40, 14336
  buffer_load_dwordx4 v32, s[20:23], s67 offen  lds
  s_add_u32 m0, s63, 3072
  s_add_u32 s67, s40, 21504
  buffer_load_dwordx4 v32, s[20:23], s67 offen  lds
  s_add_u32 m0, s63, 4096
  s_add_u32 s67, s40, 28672
  buffer_load_dwordx4 v32, s[20:23], s67 offen  lds
  s_add_u32 m0, s63, 5120
  s_add_u32 s67, s40, 35840
  buffer_load_dwordx4 v32, s[20:23], s67 offen  lds
  s_add_u32 m0, s63, 6144
  s_add_u32 s67, s40, 43008
  buffer_load_dwordx4 v32, s[20:23], s67 offen  lds
  s_add_u32 m0, s63, 7168
  s_add_u32 s67, s40, 50176
  buffer_load_dwordx4 v32, s[20:23], s67 offen  lds
  s_waitcnt vmcnt(8)
  s_barrier
  s_add_u32 m0, s62, 32768
  s_add_u32 s67, s37, 131072
  buffer_load_dwordx4 v46, s[12:15], s67 offen nt lds
  s_add_u32 m0, s62, 33792
  s_add_u32 s67, s37, 135168
  buffer_load_dwordx4 v46, s[12:15], s67 offen nt lds
  s_add_u32 m0, s62, 34816
  s_add_u32 s67, s37, 139264
  buffer_load_dwordx4 v46, s[12:15], s67 offen nt lds
  s_add_u32 m0, s62, 35840
  s_add_u32 s67, s37, 143360
  buffer_load_dwordx4 v46, s[12:15], s67 offen nt lds
  s_add_u32 m0, s62, 36864
  s_add_u32 s67, s37, 147456
  buffer_load_dwordx4 v46, s[12:15], s67 offen nt lds
  s_add_u32 m0, s62, 37888
  s_add_u32 s67, s37, 151552
  buffer_load_dwordx4 v46, s[12:15], s67 offen nt lds
  s_add_u32 m0, s62, 38912
  s_add_u32 s67, s37, 155648
  buffer_load_dwordx4 v46, s[12:15], s67 offen nt lds
  s_add_u32 m0, s62, 39936
  s_add_u32 s67, s37, 159744
  buffer_load_dwordx4 v46, s[12:15], s67 offen nt lds
  s_setprio 1
  ds_read_b128 v[160:163], v42 offset:0
  ds_read_b128 v[164:167], v42 offset:2048
  ds_read_b128 v[168:171], v42 offset:4096
  s_waitcnt vmcnt(12)
  ds_read_b64_tr_b16 v[0:1], v34 offset:0
  ds_read_b64_tr_b16 v[2:3], v34 offset:2048
  ds_read_b64_tr_b16 v[4:5], v35 offset:0
  ds_read_b64_tr_b16 v[6:7], v35 offset:2048
  ds_read_b64_tr_b16 v[8:9], v36 offset:0
  ds_read_b64_tr_b16 v[10:11], v36 offset:2048
  ds_read_b64_tr_b16 v[12:13], v37 offset:0
  ds_read_b64_tr_b16 v[14:15], v37 offset:2048
  s_waitcnt vmcnt(8)
  ds_read_b64_tr_b16 v[16:17], v34 offset:4096
  ds_read_b64_tr_b16 v[18:19], v34 offset:6144
  ds_read_b128 v[172:175], v43 offset:0
  ds_read_b128 v[176:179], v43 offset:2048
  s_waitcnt lgkmcnt(14)
  ds_read_b128 v[180:183], v43 offset:4096
  s_waitcnt lgkmcnt(11)
  v_mfma_f32_16x16x32_bf16 v[64:67], v[0:3], v[160:163], 0
  v_mfma_f32_16x16x32_bf16 v[68:71], v[0:3], v[164:167], 0
  v_mfma_f32_16x16x32_bf16 v[72:75], v[0:3], v[168:171], 0
  ds_read_b64_tr_b16 v[0:1], v35 offset:4096
  ds_read_b64_tr_b16 v[2:3], v35 offset:6144
  ds_read_b128 v[184:187], v42 offset:6144
  ds_read_b128 v[188:191], v42 offset:8192
  s_waitcnt lgkmcnt(14)
  ds_read_b128 v[192:195], v42 offset:10240
  s_waitcnt lgkmcnt(14)
  v_mfma_f32_16x16x32_bf16 v[76:79], v[4:7], v[160:163], 0
  v_mfma_f32_16x16x32_bf16 v[80:83], v[4:7], v[164:167], 0
  v_mfma_f32_16x16x32_bf16 v[84:87], v[4:7], v[168:171], 0
  s_waitcnt lgkmcnt(13)
  ds_read_b64_tr_b16 v[4:5], v36 offset:4096
  ds_read_b64_tr_b16 v[6:7], v36 offset:6144
  s_waitcnt lgkmcnt(14)
  ds_read_b128 v[196:199], v43 offset:6144
  s_waitcnt lgkmcnt(14)
  ds_read_b128 v[200:203], v43 offset:8192
  s_waitcnt lgkmcnt(14)
  ds_read_b128 v[204:207], v43 offset:10240
  v_mfma_f32_16x16x32_bf16 v[88:91], v[8:11], v[160:163], 0
  v_mfma_f32_16x16x32_bf16 v[92:95], v[8:11], v[164:167], 0
  v_mfma_f32_16x16x32_bf16 v[96:99], v[8:11], v[168:171], 0
  s_waitcnt lgkmcnt(13)
  ds_read_b64_tr_b16 v[8:9], v37 offset:4096
  ds_read_b64_tr_b16 v[10:11], v37 offset:6144
  v_mfma_f32_16x16x32_bf16 v[100:103], v[12:15], v[160:163], 0
  v_mfma_f32_16x16x32_bf16 v[104:107], v[12:15], v[164:167], 0
  v_mfma_f32_16x16x32_bf16 v[108:111], v[12:15], v[168:171], 0
  s_waitcnt lgkmcnt(12)
  v_mfma_f32_16x16x32_bf16 v[64:67], v[16:19], v[172:175], v[64:67]
  v_mfma_f32_16x16x32_bf16 v[68:71], v[16:19], v[176:179], v[68:71]
  v_mfma_f32_16x16x32_bf16 v[72:75], v[16:19], v[180:183], v[72:75]
  s_waitcnt lgkmcnt(10)
  v_mfma_f32_16x16x32_bf16 v[76:79], v[0:3], v[172:175], v[76:79]
  v_mfma_f32_16x16x32_bf16 v[80:83], v[0:3], v[176:179], v[80:83]
  v_mfma_f32_16x16x32_bf16 v[84:87], v[0:3], v[180:183], v[84:87]
  s_waitcnt lgkmcnt(5)
  v_mfma_f32_16x16x32_bf16 v[88:91], v[4:7], v[172:175], v[88:91]
  v_mfma_f32_16x16x32_bf16 v[92:95], v[4:7], v[176:179], v[92:95]
  v_mfma_f32_16x16x32_bf16 v[96:99], v[4:7], v[180:183], v[96:99]
  s_waitcnt lgkmcnt(0)
  v_mfma_f32_16x16x32_bf16 v[100:103], v[8:11], v[172:175], v[100:103]
  v_mfma_f32_16x16x32_bf16 v[104:107], v[8:11], v[176:179], v[104:107]
  v_mfma_f32_16x16x32_bf16 v[108:111], v[8:11], v[180:183], v[108:111]
  s_add_u32 m0, s63, 0
  s_add_u32 s67, s40, 229376
  buffer_load_dwordx4 v32, s[20:23], s67 offen  lds
  s_add_u32 m0, s63, 1024
  s_add_u32 s67, s40, 236544
  buffer_load_dwordx4 v32, s[20:23], s67 offen  lds
  s_add_u32 m0, s63, 2048
  s_add_u32 s67, s40, 243712
  buffer_load_dwordx4 v32, s[20:23], s67 offen  lds
  s_add_u32 m0, s63, 3072
  s_add_u32 s67, s40, 250880
  buffer_load_dwordx4 v32, s[20:23], s67 offen  lds
  s_add_u32 m0, s63, 4096
  s_add_u32 s67, s40, 258048
  buffer_load_dwordx4 v32, s[20:23], s67 offen  lds
  s_add_u32 m0, s63, 5120
  s_add_u32 s67, s40, 265216
  buffer_load_dwordx4 v32, s[20:23], s67 offen  lds
  s_add_u32 m0, s63, 6144
  s_add_u32 s67, s40, 272384
  buffer_load_dwordx4 v32, s[20:23], s67 offen  lds
  s_add_u32 m0, s63, 7168
  s_add_u32 s67, s40, 279552
  buffer_load_dwordx4 v32, s[20:23], s67 offen  lds
  s_waitcnt vmcnt(8)
  s_barrier
  s_add_u32 m0, s62, 0
  s_add_u32 s67, s38, 0
  buffer_load_dwordx4 v46, s[12:15], s67 offen nt lds
  s_add_u32 m0, s62, 1024
  s_add_u32 s67, s38, 4096
  buffer_load_dwordx4 v46, s[12:15], s67 offen nt lds
  s_add_u32 m0, s62, 2048
  s_add_u32 s67, s38, 8192
  buffer_load_dwordx4 v46, s[12:15], s67 offen nt lds
  s_add_u32 m0, s62, 3072
  s_add_u32 s67, s38, 12288
  buffer_load_dwordx4 v46, s[12:15], s67 offen nt lds
  s_add_u32 m0, s62, 4096
  s_add_u32 s67, s38, 16384
  buffer_load_dwordx4 v46, s[12:15], s67 offen nt lds
  s_add_u32 m0, s62, 5120
  s_add_u32 s67, s38, 20480
  buffer_load_dwordx4 v46, s[12:15], s67 offen nt lds
  s_add_u32 m0, s62, 6144
  s_add_u32 s67, s38, 24576
  buffer_load_dwordx4 v46, s[12:15], s67 offen nt lds
  s_add_u32 m0, s62, 7168
  s_add_u32 s67, s38, 28672
  buffer_load_dwordx4 v46, s[12:15], s67 offen nt lds
  s_waitcnt vmcnt(12)
  ds_read_b64_tr_b16 v[0:1], v34 offset:0
  ds_read_b64_tr_b16 v[2:3], v34 offset:2048
  ds_read_b64_tr_b16 v[4:5], v35 offset:0
  ds_read_b64_tr_b16 v[6:7], v35 offset:2048
  ds_read_b64_tr_b16 v[8:9], v36 offset:0
  ds_read_b64_tr_b16 v[10:11], v36 offset:2048
  ds_read_b64_tr_b16 v[12:13], v37 offset:0
  ds_read_b64_tr_b16 v[14:15], v37 offset:2048
  s_waitcnt vmcnt(8)
  ds_read_b64_tr_b16 v[16:17], v34 offset:4096
  ds_read_b64_tr_b16 v[18:19], v34 offset:6144
  s_waitcnt lgkmcnt(8)
  v_mfma_f32_16x16x32_bf16 v[64:67], v[0:3], v[184:187], v[64:67]
  v_mfma_f32_16x16x32_bf16 v[68:71], v[0:3], v[188:191], v[68:71]
  v_mfma_f32_16x16x32_bf16 v[72:75], v[0:3], v[192:195], v[72:75]
  ds_read_b64_tr_b16 v[0:1], v35 offset:4096
  ds_read_b64_tr_b16 v[2:3], v35 offset:6144
  s_waitcnt lgkmcnt(8)
  v_mfma_f32_16x16x32_bf16 v[76:79], v[4:7], v[184:187], v[76:79]
  v_mfma_f32_16x16x32_bf16 v[80:83], v[4:7], v[188:191], v[80:83]
  v_mfma_f32_16x16x32_bf16 v[84:87], v[4:7], v[192:195], v[84:87]
  ds_read_b64_tr_b16 v[4:5], v36 offset:4096
  ds_read_b64_tr_b16 v[6:7], v36 offset:6144
  s_waitcnt lgkmcnt(8)
  v_mfma_f32_16x16x32_bf16 v[88:91], v[8:11], v[184:187], v[88:91]
  v_mfma_f32_16x16x32_bf16 v[92:95], v[8:11], v[188:191], v[92:95]
  v_mfma_f32_16x16x32_bf16 v[96:99], v[8:11], v[192:195], v[96:99]
  ds_read_b64_tr_b16 v[8:9], v37 offset:4096
  ds_read_b64_tr_b16 v[10:11], v37 offset:6144
  s_waitcnt lgkmcnt(8)
  v_mfma_f32_16x16x32_bf16 v[100:103], v[12:15], v[184:187], v[100:103]
  v_mfma_f32_16x16x32_bf16 v[104:107], v[12:15], v[188:191], v[104:107]
  v_mfma_f32_16x16x32_bf16 v[108:111], v[12:15], v[192:195], v[108:111]
  s_waitcnt lgkmcnt(6)
  v_mfma_f32_16x16x32_bf16 v[64:67], v[16:19], v[196:199], v[64:67]
  v_mfma_f32_16x16x32_bf16 v[68:71], v[16:19], v[200:203], v[68:71]
  v_mfma_f32_16x16x32_bf16 v[72:75], v[16:19], v[204:207], v[72:75]
  s_waitcnt lgkmcnt(4)
  v_mfma_f32_16x16x32_bf16 v[76:79], v[0:3], v[196:199], v[76:79]
  v_mfma_f32_16x16x32_bf16 v[80:83], v[0:3], v[200:203], v[80:83]
  v_mfma_f32_16x16x32_bf16 v[84:87], v[0:3], v[204:207], v[84:87]
  s_waitcnt lgkmcnt(2)
  v_mfma_f32_16x16x32_bf16 v[88:91], v[4:7], v[196:199], v[88:91]
  v_mfma_f32_16x16x32_bf16 v[92:95], v[4:7], v[200:203], v[92:95]
  v_mfma_f32_16x16x32_bf16 v[96:99], v[4:7], v[204:207], v[96:99]
  s_waitcnt lgkmcnt(0)
  v_mfma_f32_16x16x32_bf16 v[100:103], v[8:11], v[196:199], v[100:103]
  v_mfma_f32_16x16x32_bf16 v[104:107], v[8:11], v[200:203], v[104:107]
  v_mfma_f32_16x16x32_bf16 v[108:111], v[8:11], v[204:207], v[108:111]
  s_add_u32 m0, s63, 0
  s_add_u32 s67, s41, 0
  buffer_load_dwordx4 v32, s[20:23], s67 offen  lds
  s_add_u32 m0, s63, 1024
  s_add_u32 s67, s41, 7168
  buffer_load_dwordx4 v32, s[20:23], s67 offen  lds
  s_add_u32 m0, s63, 2048
  s_add_u32 s67, s41, 14336
  buffer_load_dwordx4 v32, s[20:23], s67 offen  lds
  s_add_u32 m0, s63, 3072
  s_add_u32 s67, s41, 21504
  buffer_load_dwordx4 v32, s[20:23], s67 offen  lds
  s_add_u32 m0, s63, 4096
  s_add_u32 s67, s41, 28672
  buffer_load_dwordx4 v32, s[20:23], s67 offen  lds
  s_add_u32 m0, s63, 5120
  s_add_u32 s67, s41, 35840
  buffer_load_dwordx4 v32, s[20:23], s67 offen  lds
  s_add_u32 m0, s63, 6144
  s_add_u32 s67, s41, 43008
  buffer_load_dwordx4 v32, s[20:23], s67 offen  lds
  s_add_u32 m0, s63, 7168
  s_add_u32 s67, s41, 50176
  buffer_load_dwordx4 v32, s[20:23], s67 offen  lds
  s_waitcnt vmcnt(8)
  s_barrier
  s_add_u32 m0, s62, 32768
  s_add_u32 s67, s38, 131072
  buffer_load_dwordx4 v46, s[12:15], s67 offen nt lds
  s_add_u32 m0, s62, 33792
  s_add_u32 s67, s38, 135168
  buffer_load_dwordx4 v46, s[12:15], s67 offen nt lds
  s_add_u32 m0, s62, 34816
  s_add_u32 s67, s38, 139264
  buffer_load_dwordx4 v46, s[12:15], s67 offen nt lds
  s_add_u32 m0, s62, 35840
  s_add_u32 s67, s38, 143360
  buffer_load_dwordx4 v46, s[12:15], s67 offen nt lds
  s_add_u32 m0, s62, 36864
  s_add_u32 s67, s38, 147456
  buffer_load_dwordx4 v46, s[12:15], s67 offen nt lds
  s_add_u32 m0, s62, 37888
  s_add_u32 s67, s38, 151552
  buffer_load_dwordx4 v46, s[12:15], s67 offen nt lds
  s_add_u32 m0, s62, 38912
  s_add_u32 s67, s38, 155648
  buffer_load_dwordx4 v46, s[12:15], s67 offen nt lds
  s_add_u32 m0, s62, 39936
  s_add_u32 s67, s38, 159744
  buffer_load_dwordx4 v46, s[12:15], s67 offen nt lds
  ds_read_b128 v[160:163], v42 offset:0
  ds_read_b128 v[164:167], v42 offset:2048
  ds_read_b128 v[168:171], v42 offset:4096
  s_waitcnt vmcnt(12)
  ds_read_b64_tr_b16 v[0:1], v34 offset:0
  ds_read_b64_tr_b16 v[2:3], v34 offset:2048
  ds_read_b64_tr_b16 v[4:5], v35 offset:0
  ds_read_b64_tr_b16 v[6:7], v35 offset:2048
  ds_read_b64_tr_b16 v[8:9], v36 offset:0
  ds_read_b64_tr_b16 v[10:11], v36 offset:2048
  ds_read_b64_tr_b16 v[12:13], v37 offset:0
  ds_read_b64_tr_b16 v[14:15], v37 offset:2048
  s_waitcnt vmcnt(8)
  ds_read_b64_tr_b16 v[16:17], v34 offset:4096
  ds_read_b64_tr_b16 v[18:19], v34 offset:6144
  ds_read_b128 v[172:175], v43 offset:0
  ds_read_b128 v[176:179], v43 offset:2048
  s_waitcnt lgkmcnt(14)
  ds_read_b128 v[180:183], v43 offset:4096
  s_waitcnt lgkmcnt(11)
  v_mfma_f32_16x16x32_bf16 v[64:67], v[0:3], v[160:163], v[64:67]
  v_mfma_f32_16x16x32_bf16 v[68:71], v[0:3], v[164:167], v[68:71]
  v_mfma_f32_16x16x32_bf16 v[72:75], v[0:3], v[168:171], v[72:75]
  ds_read_b64_tr_b16 v[0:1], v35 offset:4096
  ds_read_b64_tr_b16 v[2:3], v35 offset:6144
  ds_read_b128 v[184:187], v42 offset:6144
  ds_read_b128 v[188:191], v42 offset:8192
  s_waitcnt lgkmcnt(14)
  ds_read_b128 v[192:195], v42 offset:10240
  s_waitcnt lgkmcnt(14)
  v_mfma_f32_16x16x32_bf16 v[76:79], v[4:7], v[160:163], v[76:79]
  v_mfma_f32_16x16x32_bf16 v[80:83], v[4:7], v[164:167], v[80:83]
  v_mfma_f32_16x16x32_bf16 v[84:87], v[4:7], v[168:171], v[84:87]
  s_waitcnt lgkmcnt(13)
  ds_read_b64_tr_b16 v[4:5], v36 offset:4096
  ds_read_b64_tr_b16 v[6:7], v36 offset:6144
  s_waitcnt lgkmcnt(14)
  ds_read_b128 v[196:199], v43 offset:6144
  s_waitcnt lgkmcnt(14)
  ds_read_b128 v[200:203], v43 offset:8192
  s_waitcnt lgkmcnt(14)
  ds_read_b128 v[204:207], v43 offset:10240
  v_mfma_f32_16x16x32_bf16 v[88:91], v[8:11], v[160:163], v[88:91]
  v_mfma_f32_16x16x32_bf16 v[92:95], v[8:11], v[164:167], v[92:95]
  v_mfma_f32_16x16x32_bf16 v[96:99], v[8:11], v[168:171], v[96:99]
  s_waitcnt lgkmcnt(13)
  ds_read_b64_tr_b16 v[8:9], v37 offset:4096
  ds_read_b64_tr_b16 v[10:11], v37 offset:6144
  v_mfma_f32_16x16x32_bf16 v[100:103], v[12:15], v[160:163], v[100:103]
  v_mfma_f32_16x16x32_bf16 v[104:107], v[12:15], v[164:167], v[104:107]
  v_mfma_f32_16x16x32_bf16 v[108:111], v[12:15], v[168:171], v[108:111]
  s_waitcnt lgkmcnt(12)
  v_mfma_f32_16x16x32_bf16 v[64:67], v[16:19], v[172:175], v[64:67]
  v_mfma_f32_16x16x32_bf16 v[68:71], v[16:19], v[176:179], v[68:71]
  v_mfma_f32_16x16x32_bf16 v[72:75], v[16:19], v[180:183], v[72:75]
  s_waitcnt lgkmcnt(10)
  v_mfma_f32_16x16x32_bf16 v[76:79], v[0:3], v[172:175], v[76:79]
  v_mfma_f32_16x16x32_bf16 v[80:83], v[0:3], v[176:179], v[80:83]
  v_mfma_f32_16x16x32_bf16 v[84:87], v[0:3], v[180:183], v[84:87]
  s_waitcnt lgkmcnt(5)
  v_mfma_f32_16x16x32_bf16 v[88:91], v[4:7], v[172:175], v[88:91]
  v_mfma_f32_16x16x32_bf16 v[92:95], v[4:7], v[176:179], v[92:95]
  v_mfma_f32_16x16x32_bf16 v[96:99], v[4:7], v[180:183], v[96:99]
  s_waitcnt lgkmcnt(0)
  v_mfma_f32_16x16x32_bf16 v[100:103], v[8:11], v[172:175], v[100:103]
  v_mfma_f32_16x16x32_bf16 v[104:107], v[8:11], v[176:179], v[104:107]
  v_mfma_f32_16x16x32_bf16 v[108:111], v[8:11], v[180:183], v[108:111]
  s_add_u32 m0, s63, 0
  s_add_u32 s67, s41, 229376
  buffer_load_dwordx4 v32, s[20:23], s67 offen  lds
  s_add_u32 m0, s63, 1024
  s_add_u32 s67, s41, 236544
  buffer_load_dwordx4 v32, s[20:23], s67 offen  lds
  s_add_u32 m0, s63, 2048
  s_add_u32 s67, s41, 243712
  buffer_load_dwordx4 v32, s[20:23], s67 offen  lds
  s_add_u32 m0, s63, 3072
  s_add_u32 s67, s41, 250880
  buffer_load_dwordx4 v32, s[20:23], s67 offen  lds
  s_add_u32 m0, s63, 4096
  s_add_u32 s67, s41, 258048
  buffer_load_dwordx4 v32, s[20:23], s67 offen  lds
  s_add_u32 m0, s63, 5120
  s_add_u32 s67, s41, 265216
  buffer_load_dwordx4 v32, s[20:23], s67 offen  lds
  s_add_u32 m0, s63, 6144
  s_add_u32 s67, s41, 272384
  buffer_load_dwordx4 v32, s[20:23], s67 offen  lds
  s_add_u32 m0, s63, 7168
  s_add_u32 s67, s41, 279552
  buffer_load_dwordx4 v32, s[20:23], s67 offen  lds
  s_waitcnt vmcnt(8)
  s_barrier
  s_add_u32 m0, s62, 0
  s_add_u32 s67, s39, 0
  buffer_load_dwordx4 v46, s[12:15], s67 offen nt lds
  s_add_u32 m0, s62, 1024
  s_add_u32 s67, s39, 4096
  buffer_load_dwordx4 v46, s[12:15], s67 offen nt lds
  s_add_u32 m0, s62, 2048
  s_add_u32 s67, s39, 8192
  buffer_load_dwordx4 v46, s[12:15], s67 offen nt lds
  s_add_u32 m0, s62, 3072
  s_add_u32 s67, s39, 12288
  buffer_load_dwordx4 v46, s[12:15], s67 offen nt lds
  s_add_u32 m0, s62, 4096
  s_add_u32 s67, s39, 16384
  buffer_load_dwordx4 v46, s[12:15], s67 offen nt lds
  s_add_u32 m0, s62, 5120
  s_add_u32 s67, s39, 20480
  buffer_load_dwordx4 v46, s[12:15], s67 offen nt lds
  s_add_u32 m0, s62, 6144
  s_add_u32 s67, s39, 24576
  buffer_load_dwordx4 v46, s[12:15], s67 offen nt lds
  s_add_u32 m0, s62, 7168
  s_add_u32 s67, s39, 28672
  buffer_load_dwordx4 v46, s[12:15], s67 offen nt lds
  s_waitcnt vmcnt(12)
  ds_read_b64_tr_b16 v[0:1], v34 offset:0
  ds_read_b64_tr_b16 v[2:3], v34 offset:2048
  ds_read_b64_tr_b16 v[4:5], v35 offset:0
  ds_read_b64_tr_b16 v[6:7], v35 offset:2048
  ds_read_b64_tr_b16 v[8:9], v36 offset:0
  ds_read_b64_tr_b16 v[10:11], v36 offset:2048
  ds_read_b64_tr_b16 v[12:13], v37 offset:0
  ds_read_b64_tr_b16 v[14:15], v37 offset:2048
  s_waitcnt vmcnt(8)
  ds_read_b64_tr_b16 v[16:17], v34 offset:4096
  ds_read_b64_tr_b16 v[18:19], v34 offset:6144
  s_waitcnt lgkmcnt(8)
  v_mfma_f32_16x16x32_bf16 v[64:67], v[0:3], v[184:187], v[64:67]
  v_mfma_f32_16x16x32_bf16 v[68:71], v[0:3], v[188:191], v[68:71]
  v_mfma_f32_16x16x32_bf16 v[72:75], v[0:3], v[192:195], v[72:75]
  ds_read_b64_tr_b16 v[0:1], v35 offset:4096
  ds_read_b64_tr_b16 v[2:3], v35 offset:6144
  s_waitcnt lgkmcnt(8)
  v_mfma_f32_16x16x32_bf16 v[76:79], v[4:7], v[184:187], v[76:79]
  v_mfma_f32_16x16x32_bf16 v[80:83], v[4:7], v[188:191], v[80:83]
  v_mfma_f32_16x16x32_bf16 v[84:87], v[4:7], v[192:195], v[84:87]
  ds_read_b64_tr_b16 v[4:5], v36 offset:4096
  ds_read_b64_tr_b16 v[6:7], v36 offset:6144
  s_waitcnt lgkmcnt(8)
  v_mfma_f32_16x16x32_bf16 v[88:91], v[8:11], v[184:187], v[88:91]
  v_mfma_f32_16x16x32_bf16 v[92:95], v[8:11], v[188:191], v[92:95]
  v_mfma_f32_16x16x32_bf16 v[96:99], v[8:11], v[192:195], v[96:99]
  ds_read_b64_tr_b16 v[8:9], v37 offset:4096
  ds_read_b64_tr_b16 v[10:11], v37 offset:6144
  s_waitcnt lgkmcnt(8)
  v_mfma_f32_16x16x32_bf16 v[100:103], v[12:15], v[184:187], v[100:103]
  v_mfma_f32_16x16x32_bf16 v[104:107], v[12:15], v[188:191], v[104:107]
  v_mfma_f32_16x16x32_bf16 v[108:111], v[12:15], v[192:195], v[108:111]
  s_waitcnt lgkmcnt(6)
  v_mfma_f32_16x16x32_bf16 v[64:67], v[16:19], v[196:199], v[64:67]
  v_mfma_f32_16x16x32_bf16 v[68:71], v[16:19], v[200:203], v[68:71]
  v_mfma_f32_16x16x32_bf16 v[72:75], v[16:19], v[204:207], v[72:75]
  s_waitcnt lgkmcnt(4)
  v_mfma_f32_16x16x32_bf16 v[76:79], v[0:3], v[196:199], v[76:79]
  v_mfma_f32_16x16x32_bf16 v[80:83], v[0:3], v[200:203], v[80:83]
  v_mfma_f32_16x16x32_bf16 v[84:87], v[0:3], v[204:207], v[84:87]
  s_waitcnt lgkmcnt(2)
  v_mfma_f32_16x16x32_bf16 v[88:91], v[4:7], v[196:199], v[88:91]
  v_mfma_f32_16x16x32_bf16 v[92:95], v[4:7], v[200:203], v[92:95]
  v_mfma_f32_16x16x32_bf16 v[96:99], v[4:7], v[204:207], v[96:99]
  s_waitcnt lgkmcnt(0)
  v_mfma_f32_16x16x32_bf16 v[100:103], v[8:11], v[196:199], v[100:103]
  v_mfma_f32_16x16x32_bf16 v[104:107], v[8:11], v[200:203], v[104:107]
  v_mfma_f32_16x16x32_bf16 v[108:111], v[8:11], v[204:207], v[108:111]
  s_add_u32 m0, s63, 0
  s_add_u32 s67, s42, 0
  buffer_load_dwordx4 v32, s[20:23], s67 offen  lds
  s_add_u32 m0, s63, 1024
  s_add_u32 s67, s42, 7168
  buffer_load_dwordx4 v32, s[20:23], s67 offen  lds
  s_add_u32 m0, s63, 2048
  s_add_u32 s67, s42, 14336
  buffer_load_dwordx4 v32, s[20:23], s67 offen  lds
  s_add_u32 m0, s63, 3072
  s_add_u32 s67, s42, 21504
  buffer_load_dwordx4 v32, s[20:23], s67 offen  lds
  s_add_u32 m0, s63, 4096
  s_add_u32 s67, s42, 28672
  buffer_load_dwordx4 v32, s[20:23], s67 offen  lds
  s_add_u32 m0, s63, 5120
  s_add_u32 s67, s42, 35840
  buffer_load_dwordx4 v32, s[20:23], s67 offen  lds
  s_add_u32 m0, s63, 6144
  s_add_u32 s67, s42, 43008
  buffer_load_dwordx4 v32, s[20:23], s67 offen  lds
  s_add_u32 m0, s63, 7168
  s_add_u32 s67, s42, 50176
  buffer_load_dwordx4 v32, s[20:23], s67 offen  lds
  s_waitcnt vmcnt(8)
  s_barrier
  s_add_u32 m0, s62, 32768
  s_add_u32 s67, s39, 131072
  buffer_load_dwordx4 v46, s[12:15], s67 offen nt lds
  s_add_u32 m0, s62, 33792
  s_add_u32 s67, s39, 135168
  buffer_load_dwordx4 v46, s[12:15], s67 offen nt lds
  s_add_u32 m0, s62, 34816
  s_add_u32 s67, s39, 139264
  buffer_load_dwordx4 v46, s[12:15], s67 offen nt lds
  s_add_u32 m0, s62, 35840
  s_add_u32 s67, s39, 143360
  buffer_load_dwordx4 v46, s[12:15], s67 offen nt lds
  s_add_u32 m0, s62, 36864
  s_add_u32 s67, s39, 147456
  buffer_load_dwordx4 v46, s[12:15], s67 offen nt lds
  s_add_u32 m0, s62, 37888
  s_add_u32 s67, s39, 151552
  buffer_load_dwordx4 v46, s[12:15], s67 offen nt lds
  s_add_u32 m0, s62, 38912
  s_add_u32 s67, s39, 155648
  buffer_load_dwordx4 v46, s[12:15], s67 offen nt lds
  s_add_u32 m0, s62, 39936
  s_add_u32 s67, s39, 159744
  buffer_load_dwordx4 v46, s[12:15], s67 offen nt lds
  ds_read_b128 v[160:163], v42 offset:0
  ds_read_b128 v[164:167], v42 offset:2048
  ds_read_b128 v[168:171], v42 offset:4096
  s_waitcnt vmcnt(12)
  ds_read_b64_tr_b16 v[0:1], v34 offset:0
  ds_read_b64_tr_b16 v[2:3], v34 offset:2048
  ds_read_b64_tr_b16 v[4:5], v35 offset:0
  ds_read_b64_tr_b16 v[6:7], v35 offset:2048
  ds_read_b64_tr_b16 v[8:9], v36 offset:0
  ds_read_b64_tr_b16 v[10:11], v36 offset:2048
  ds_read_b64_tr_b16 v[12:13], v37 offset:0
  ds_read_b64_tr_b16 v[14:15], v37 offset:2048
  s_waitcnt vmcnt(8)
  ds_read_b64_tr_b16 v[16:17], v34 offset:4096
  ds_read_b64_tr_b16 v[18:19], v34 offset:6144
  ds_read_b128 v[172:175], v43 offset:0
  ds_read_b128 v[176:179], v43 offset:2048
  s_waitcnt lgkmcnt(14)
  ds_read_b128 v[180:183], v43 offset:4096
  s_waitcnt lgkmcnt(11)
  v_mfma_f32_16x16x32_bf16 v[64:67], v[0:3], v[160:163], v[64:67]
  v_mfma_f32_16x16x32_bf16 v[68:71], v[0:3], v[164:167], v[68:71]
  v_mfma_f32_16x16x32_bf16 v[72:75], v[0:3], v[168:171], v[72:75]
  ds_read_b64_tr_b16 v[0:1], v35 offset:4096
  ds_read_b64_tr_b16 v[2:3], v35 offset:6144
  ds_read_b128 v[184:187], v42 offset:6144
  ds_read_b128 v[188:191], v42 offset:8192
  s_waitcnt lgkmcnt(14)
  ds_read_b128 v[192:195], v42 offset:10240
  s_waitcnt lgkmcnt(14)
  v_mfma_f32_16x16x32_bf16 v[76:79], v[4:7], v[160:163], v[76:79]
  v_mfma_f32_16x16x32_bf16 v[80:83], v[4:7], v[164:167], v[80:83]
  v_mfma_f32_16x16x32_bf16 v[84:87], v[4:7], v[168:171], v[84:87]
  s_waitcnt lgkmcnt(13)
  ds_read_b64_tr_b16 v[4:5], v36 offset:4096
  ds_read_b64_tr_b16 v[6:7], v36 offset:6144
  s_waitcnt lgkmcnt(14)
  ds_read_b128 v[196:199], v43 offset:6144
  s_waitcnt lgkmcnt(14)
  ds_read_b128 v[200:203], v43 offset:8192
  s_waitcnt lgkmcnt(14)
  ds_read_b128 v[204:207], v43 offset:10240
  v_mfma_f32_16x16x32_bf16 v[88:91], v[8:11], v[160:163], v[88:91]
  v_mfma_f32_16x16x32_bf16 v[92:95], v[8:11], v[164:167], v[92:95]
  v_mfma_f32_16x16x32_bf16 v[96:99], v[8:11], v[168:171], v[96:99]
  s_waitcnt lgkmcnt(13)
  ds_read_b64_tr_b16 v[8:9], v37 offset:4096
  ds_read_b64_tr_b16 v[10:11], v37 offset:6144
  v_mfma_f32_16x16x32_bf16 v[100:103], v[12:15], v[160:163], v[100:103]
  v_mfma_f32_16x16x32_bf16 v[104:107], v[12:15], v[164:167], v[104:107]
  v_mfma_f32_16x16x32_bf16 v[108:111], v[12:15], v[168:171], v[108:111]
  s_waitcnt lgkmcnt(12)
  v_mfma_f32_16x16x32_bf16 v[64:67], v[16:19], v[172:175], v[64:67]
  v_mfma_f32_16x16x32_bf16 v[68:71], v[16:19], v[176:179], v[68:71]
  v_mfma_f32_16x16x32_bf16 v[72:75], v[16:19], v[180:183], v[72:75]
  s_waitcnt lgkmcnt(10)
  v_mfma_f32_16x16x32_bf16 v[76:79], v[0:3], v[172:175], v[76:79]
  v_mfma_f32_16x16x32_bf16 v[80:83], v[0:3], v[176:179], v[80:83]
  v_mfma_f32_16x16x32_bf16 v[84:87], v[0:3], v[180:183], v[84:87]
  s_waitcnt lgkmcnt(5)
  v_mfma_f32_16x16x32_bf16 v[88:91], v[4:7], v[172:175], v[88:91]
  v_mfma_f32_16x16x32_bf16 v[92:95], v[4:7], v[176:179], v[92:95]
  v_mfma_f32_16x16x32_bf16 v[96:99], v[4:7], v[180:183], v[96:99]
  s_waitcnt lgkmcnt(0)
  v_mfma_f32_16x16x32_bf16 v[100:103], v[8:11], v[172:175], v[100:103]
  v_mfma_f32_16x16x32_bf16 v[104:107], v[8:11], v[176:179], v[104:107]
  v_mfma_f32_16x16x32_bf16 v[108:111], v[8:11], v[180:183], v[108:111]
  s_add_u32 m0, s63, 0
  s_add_u32 s67, s42, 229376
  buffer_load_dwordx4 v32, s[20:23], s67 offen  lds
  s_add_u32 m0, s63, 1024
  s_add_u32 s67, s42, 236544
  buffer_load_dwordx4 v32, s[20:23], s67 offen  lds
  s_add_u32 m0, s63, 2048
  s_add_u32 s67, s42, 243712
  buffer_load_dwordx4 v32, s[20:23], s67 offen  lds
  s_add_u32 m0, s63, 3072
  s_add_u32 s67, s42, 250880
  buffer_load_dwordx4 v32, s[20:23], s67 offen  lds
  s_add_u32 m0, s63, 4096
  s_add_u32 s67, s42, 258048
  buffer_load_dwordx4 v32, s[20:23], s67 offen  lds
  s_add_u32 m0, s63, 5120
  s_add_u32 s67, s42, 265216
  buffer_load_dwordx4 v32, s[20:23], s67 offen  lds
  s_add_u32 m0, s63, 6144
  s_add_u32 s67, s42, 272384
  buffer_load_dwordx4 v32, s[20:23], s67 offen  lds
  s_add_u32 m0, s63, 7168
  s_add_u32 s67, s42, 279552
  buffer_load_dwordx4 v32, s[20:23], s67 offen  lds
  s_waitcnt vmcnt(8)
  s_barrier
  s_waitcnt vmcnt(4)
  ds_read_b64_tr_b16 v[0:1], v34 offset:0
  ds_read_b64_tr_b16 v[2:3], v34 offset:2048
  ds_read_b64_tr_b16 v[4:5], v35 offset:0
  ds_read_b64_tr_b16 v[6:7], v35 offset:2048
  ds_read_b64_tr_b16 v[8:9], v36 offset:0
  ds_read_b64_tr_b16 v[10:11], v36 offset:2048
  ds_read_b64_tr_b16 v[12:13], v37 offset:0
  ds_read_b64_tr_b16 v[14:15], v37 offset:2048
  s_waitcnt vmcnt(0)
  ds_read_b64_tr_b16 v[16:17], v34 offset:4096
  ds_read_b64_tr_b16 v[18:19], v34 offset:6144
  s_add_u32 m0, s62, 0
  s_add_u32 s67, s43, 229376
  buffer_load_dwordx4 v32, s[20:23], s67 offen  lds
  s_waitcnt lgkmcnt(8)
  v_mfma_f32_16x16x32_bf16 v[64:67], v[0:3], v[184:187], v[64:67]
  v_mfma_f32_16x16x32_bf16 v[68:71], v[0:3], v[188:191], v[68:71]
  v_mfma_f32_16x16x32_bf16 v[72:75], v[0:3], v[192:195], v[72:75]
  ds_read_b64_tr_b16 v[0:1], v35 offset:4096
  ds_read_b64_tr_b16 v[2:3], v35 offset:6144
  s_add_u32 m0, s62, 1024
  s_add_u32 s67, s43, 236544
  buffer_load_dwordx4 v32, s[20:23], s67 offen  lds
  s_waitcnt lgkmcnt(8)
  v_mfma_f32_16x16x32_bf16 v[76:79], v[4:7], v[184:187], v[76:79]
  v_mfma_f32_16x16x32_bf16 v[80:83], v[4:7], v[188:191], v[80:83]
  v_mfma_f32_16x16x32_bf16 v[84:87], v[4:7], v[192:195], v[84:87]
  ds_read_b64_tr_b16 v[4:5], v36 offset:4096
  ds_read_b64_tr_b16 v[6:7], v36 offset:6144
  s_add_u32 m0, s62, 2048
  s_add_u32 s67, s43, 243712
  buffer_load_dwordx4 v32, s[20:23], s67 offen  lds
  s_waitcnt lgkmcnt(8)
  v_mfma_f32_16x16x32_bf16 v[88:91], v[8:11], v[184:187], v[88:91]
  v_mfma_f32_16x16x32_bf16 v[92:95], v[8:11], v[188:191], v[92:95]
  v_mfma_f32_16x16x32_bf16 v[96:99], v[8:11], v[192:195], v[96:99]
  ds_read_b64_tr_b16 v[8:9], v37 offset:4096
  ds_read_b64_tr_b16 v[10:11], v37 offset:6144
  s_add_u32 m0, s62, 3072
  s_add_u32 s67, s43, 250880
  buffer_load_dwordx4 v32, s[20:23], s67 offen  lds
  s_waitcnt lgkmcnt(8)
  v_mfma_f32_16x16x32_bf16 v[100:103], v[12:15], v[184:187], v[100:103]
  v_mfma_f32_16x16x32_bf16 v[104:107], v[12:15], v[188:191], v[104:107]
  v_mfma_f32_16x16x32_bf16 v[108:111], v[12:15], v[192:195], v[108:111]
  s_add_u32 m0, s63, 0
  s_add_u32 s67, s43, 0
  buffer_load_dwordx4 v32, s[20:23], s67 offen  lds
  s_waitcnt lgkmcnt(6)
  v_mfma_f32_16x16x32_bf16 v[64:67], v[16:19], v[196:199], v[64:67]
  v_mfma_f32_16x16x32_bf16 v[68:71], v[16:19], v[200:203], v[68:71]
  v_mfma_f32_16x16x32_bf16 v[72:75], v[16:19], v[204:207], v[72:75]
  s_add_u32 m0, s63, 1024
  s_add_u32 s67, s43, 7168
  buffer_load_dwordx4 v32, s[20:23], s67 offen  lds
  s_waitcnt lgkmcnt(4)
  v_mfma_f32_16x16x32_bf16 v[76:79], v[0:3], v[196:199], v[76:79]
  v_mfma_f32_16x16x32_bf16 v[80:83], v[0:3], v[200:203], v[80:83]
  v_mfma_f32_16x16x32_bf16 v[84:87], v[0:3], v[204:207], v[84:87]
  s_add_u32 m0, s63, 2048
  s_add_u32 s67, s43, 14336
  buffer_load_dwordx4 v32, s[20:23], s67 offen  lds
  s_waitcnt lgkmcnt(2)
  v_mfma_f32_16x16x32_bf16 v[88:91], v[4:7], v[196:199], v[88:91]
  v_mfma_f32_16x16x32_bf16 v[92:95], v[4:7], v[200:203], v[92:95]
  v_mfma_f32_16x16x32_bf16 v[96:99], v[4:7], v[204:207], v[96:99]
  s_add_u32 m0, s63, 3072
  s_add_u32 s67, s43, 21504
  buffer_load_dwordx4 v32, s[20:23], s67 offen  lds
  s_waitcnt lgkmcnt(0)
  v_mfma_f32_16x16x32_bf16 v[100:103], v[8:11], v[196:199], v[100:103]
  v_mfma_f32_16x16x32_bf16 v[104:107], v[8:11], v[200:203], v[104:107]
  v_mfma_f32_16x16x32_bf16 v[108:111], v[8:11], v[204:207], v[108:111]
  s_add_u32 m0, s63, 4096
  s_add_u32 s67, s43, 28672
  buffer_load_dwordx4 v32, s[20:23], s67 offen  lds
  s_add_u32 m0, s63, 5120
  s_add_u32 s67, s43, 35840
  buffer_load_dwordx4 v32, s[20:23], s67 offen  lds
  s_add_u32 m0, s63, 6144
  s_add_u32 s67, s43, 43008
  buffer_load_dwordx4 v32, s[20:23], s67 offen  lds
  s_add_u32 m0, s63, 7168
  s_add_u32 s67, s43, 50176
  buffer_load_dwordx4 v32, s[20:23], s67 offen  lds
  s_barrier
  ds_read_b128 v[160:163], v42 offset:0
  ds_read_b128 v[164:167], v42 offset:2048
  ds_read_b128 v[168:171], v42 offset:4096
  s_waitcnt vmcnt(4)
  ds_read_b64_tr_b16 v[0:1], v34 offset:0
  ds_read_b64_tr_b16 v[2:3], v34 offset:2048
  ds_read_b64_tr_b16 v[4:5], v35 offset:0
  ds_read_b64_tr_b16 v[6:7], v35 offset:2048
  ds_read_b64_tr_b16 v[8:9], v36 offset:0
  ds_read_b64_tr_b16 v[10:11], v36 offset:2048
  ds_read_b64_tr_b16 v[12:13], v37 offset:0
  ds_read_b64_tr_b16 v[14:15], v37 offset:2048
  s_waitcnt vmcnt(0)
  ds_read_b64_tr_b16 v[16:17], v34 offset:4096
  ds_read_b64_tr_b16 v[18:19], v34 offset:6144
  ds_read_b128 v[172:175], v43 offset:0
  ds_read_b128 v[176:179], v43 offset:2048
  s_waitcnt lgkmcnt(14)
  ds_read_b128 v[180:183], v43 offset:4096
  s_add_u32 m0, s62, 32768
  s_add_u32 s67, s43, 258048
  buffer_load_dwordx4 v32, s[20:23], s67 offen  lds
  s_waitcnt lgkmcnt(11)
  v_mfma_f32_16x16x32_bf16 v[64:67], v[0:3], v[160:163], v[64:67]
  v_mfma_f32_16x16x32_bf16 v[68:71], v[0:3], v[164:167], v[68:71]
  v_mfma_f32_16x16x32_bf16 v[72:75], v[0:3], v[168:171], v[72:75]
  ds_read_b64_tr_b16 v[0:1], v35 offset:4096
  ds_read_b64_tr_b16 v[2:3], v35 offset:6144
  ds_read_b128 v[184:187], v42 offset:6144
  ds_read_b128 v[188:191], v42 offset:8192
  s_waitcnt lgkmcnt(14)
  ds_read_b128 v[192:195], v42 offset:10240
  s_add_u32 m0, s62, 33792
  s_add_u32 s67, s43, 265216
  buffer_load_dwordx4 v32, s[20:23], s67 offen  lds
  s_waitcnt lgkmcnt(14)
  v_mfma_f32_16x16x32_bf16 v[76:79], v[4:7], v[160:163], v[76:79]
  v_mfma_f32_16x16x32_bf16 v[80:83], v[4:7], v[164:167], v[80:83]
  v_mfma_f32_16x16x32_bf16 v[84:87], v[4:7], v[168:171], v[84:87]
  s_waitcnt lgkmcnt(13)
  ds_read_b64_tr_b16 v[4:5], v36 offset:4096
  ds_read_b64_tr_b16 v[6:7], v36 offset:6144
  s_waitcnt lgkmcnt(14)
  ds_read_b128 v[196:199], v43 offset:6144
  s_waitcnt lgkmcnt(14)
  ds_read_b128 v[200:203], v43 offset:8192
  s_waitcnt lgkmcnt(14)
  ds_read_b128 v[204:207], v43 offset:10240
  s_add_u32 m0, s62, 34816
  s_add_u32 s67, s43, 272384
  buffer_load_dwordx4 v32, s[20:23], s67 offen  lds
  v_mfma_f32_16x16x32_bf16 v[88:91], v[8:11], v[160:163], v[88:91]
  v_mfma_f32_16x16x32_bf16 v[92:95], v[8:11], v[164:167], v[92:95]
  v_mfma_f32_16x16x32_bf16 v[96:99], v[8:11], v[168:171], v[96:99]
  s_waitcnt lgkmcnt(13)
  ds_read_b64_tr_b16 v[8:9], v37 offset:4096
  ds_read_b64_tr_b16 v[10:11], v37 offset:6144
  s_add_u32 m0, s62, 35840
  s_add_u32 s67, s43, 279552
  buffer_load_dwordx4 v32, s[20:23], s67 offen  lds
  v_mfma_f32_16x16x32_bf16 v[100:103], v[12:15], v[160:163], v[100:103]
  v_mfma_f32_16x16x32_bf16 v[104:107], v[12:15], v[164:167], v[104:107]
  v_mfma_f32_16x16x32_bf16 v[108:111], v[12:15], v[168:171], v[108:111]
  s_waitcnt lgkmcnt(12)
  v_mfma_f32_16x16x32_bf16 v[64:67], v[16:19], v[172:175], v[64:67]
  v_mfma_f32_16x16x32_bf16 v[68:71], v[16:19], v[176:179], v[68:71]
  v_mfma_f32_16x16x32_bf16 v[72:75], v[16:19], v[180:183], v[72:75]
  s_waitcnt lgkmcnt(10)
  v_mfma_f32_16x16x32_bf16 v[76:79], v[0:3], v[172:175], v[76:79]
  v_mfma_f32_16x16x32_bf16 v[80:83], v[0:3], v[176:179], v[80:83]
  v_mfma_f32_16x16x32_bf16 v[84:87], v[0:3], v[180:183], v[84:87]
  s_waitcnt lgkmcnt(5)
  v_mfma_f32_16x16x32_bf16 v[88:91], v[4:7], v[172:175], v[88:91]
  v_mfma_f32_16x16x32_bf16 v[92:95], v[4:7], v[176:179], v[92:95]
  v_mfma_f32_16x16x32_bf16 v[96:99], v[4:7], v[180:183], v[96:99]
  s_waitcnt lgkmcnt(0)
  v_mfma_f32_16x16x32_bf16 v[100:103], v[8:11], v[172:175], v[100:103]
  v_mfma_f32_16x16x32_bf16 v[104:107], v[8:11], v[176:179], v[104:107]
  v_mfma_f32_16x16x32_bf16 v[108:111], v[8:11], v[180:183], v[108:111]
  v_mbcnt_lo_u32_b32 v48, -1, 0
  v_mbcnt_hi_u32_b32 v48, -1, v48
  v_lshlrev_b32 v48, 4, v48
  s_mul_i32 s68, s2, 43008
  s_mul_i32 s69, s4, 12288
  s_add_u32 s68, s68, s69
  s_waitcnt vmcnt(0)
  ds_read_b64_tr_b16 v[0:1], v208 offset:0
  ds_read_b64_tr_b16 v[2:3], v208 offset:2048
  ds_read_b64_tr_b16 v[4:5], v209 offset:0
  ds_read_b64_tr_b16 v[6:7], v209 offset:2048
  ds_read_b64_tr_b16 v[8:9], v208 offset:32768
  ds_read_b64_tr_b16 v[10:11], v208 offset:34816
  ds_read_b64_tr_b16 v[12:13], v209 offset:32768
  ds_read_b64_tr_b16 v[14:15], v209 offset:34816
  ds_read_b64_tr_b16 v[16:17], v210 offset:0
  ds_read_b64_tr_b16 v[18:19], v210 offset:2048
  s_waitcnt lgkmcnt(8)
  v_mfma_f32_16x16x32_bf16 v[64:67], v[0:3], v[184:187], v[64:67]
  v_mfma_f32_16x16x32_bf16 v[68:71], v[0:3], v[188:191], v[68:71]
  v_mfma_f32_16x16x32_bf16 v[72:75], v[0:3], v[192:195], v[72:75]
  ds_read_b64_tr_b16 v[0:1], v211 offset:0
  ds_read_b64_tr_b16 v[2:3], v211 offset:2048
  s_waitcnt lgkmcnt(8)
  v_mfma_f32_16x16x32_bf16 v[76:79], v[4:7], v[184:187], v[76:79]
  v_mfma_f32_16x16x32_bf16 v[80:83], v[4:7], v[188:191], v[80:83]
  v_mfma_f32_16x16x32_bf16 v[84:87], v[4:7], v[192:195], v[84:87]
  ds_read_b64_tr_b16 v[4:5], v210 offset:32768
  ds_read_b64_tr_b16 v[6:7], v210 offset:34816
  s_waitcnt lgkmcnt(8)
  v_mfma_f32_16x16x32_bf16 v[64:67], v[8:11], v[196:199], v[64:67]
  v_mfma_f32_16x16x32_bf16 v[68:71], v[8:11], v[200:203], v[68:71]
  v_mfma_f32_16x16x32_bf16 v[72:75], v[8:11], v[204:207], v[72:75]
  ds_read_b64_tr_b16 v[8:9], v211 offset:32768
  ds_read_b64_tr_b16 v[10:11], v211 offset:34816
  s_waitcnt lgkmcnt(8)
  v_mfma_f32_16x16x32_bf16 v[76:79], v[12:15], v[196:199], v[76:79]
  v_mfma_f32_16x16x32_bf16 v[80:83], v[12:15], v[200:203], v[80:83]
  v_mfma_f32_16x16x32_bf16 v[84:87], v[12:15], v[204:207], v[84:87]
  s_waitcnt lgkmcnt(6)
  v_mfma_f32_16x16x32_bf16 v[88:91], v[16:19], v[184:187], v[88:91]
  v_mfma_f32_16x16x32_bf16 v[92:95], v[16:19], v[188:191], v[92:95]
  v_mfma_f32_16x16x32_bf16 v[96:99], v[16:19], v[192:195], v[96:99]
  s_waitcnt lgkmcnt(4)
  v_mfma_f32_16x16x32_bf16 v[100:103], v[0:3], v[184:187], v[100:103]
  v_mfma_f32_16x16x32_bf16 v[104:107], v[0:3], v[188:191], v[104:107]
  v_mfma_f32_16x16x32_bf16 v[108:111], v[0:3], v[192:195], v[108:111]
  v_cvt_pk_bf16_f32 v216, v64, v65
  v_cvt_pk_bf16_f32 v217, v66, v67
  v_cvt_pk_bf16_f32 v218, v76, v77
  v_cvt_pk_bf16_f32 v219, v78, v79
  s_add_u32 s67, s68, 0
  buffer_store_dwordx4 v[216:219], v48, s[32:35], s67 offen sc0 sc1
  v_cvt_pk_bf16_f32 v220, v68, v69
  v_cvt_pk_bf16_f32 v221, v70, v71
  v_cvt_pk_bf16_f32 v222, v80, v81
  v_cvt_pk_bf16_f32 v223, v82, v83
  s_add_u32 s67, s68, 1024
  buffer_store_dwordx4 v[220:223], v48, s[32:35], s67 offen sc0 sc1
  v_cvt_pk_bf16_f32 v224, v72, v73
  v_cvt_pk_bf16_f32 v225, v74, v75
  v_cvt_pk_bf16_f32 v226, v84, v85
  v_cvt_pk_bf16_f32 v227, v86, v87
  s_add_u32 s67, s68, 2048
  buffer_store_dwordx4 v[224:227], v48, s[32:35], s67 offen sc0 sc1
  s_waitcnt lgkmcnt(2)
  v_mfma_f32_16x16x32_bf16 v[88:91], v[4:7], v[196:199], v[88:91]
  v_mfma_f32_16x16x32_bf16 v[92:95], v[4:7], v[200:203], v[92:95]
  v_mfma_f32_16x16x32_bf16 v[96:99], v[4:7], v[204:207], v[96:99]
  s_waitcnt lgkmcnt(0)
  v_mfma_f32_16x16x32_bf16 v[100:103], v[8:11], v[196:199], v[100:103]
  v_mfma_f32_16x16x32_bf16 v[104:107], v[8:11], v[200:203], v[104:107]
  v_mfma_f32_16x16x32_bf16 v[108:111], v[8:11], v[204:207], v[108:111]
  s_nop 1
  v_cvt_pk_bf16_f32 v228, v88, v89
  v_cvt_pk_bf16_f32 v229, v90, v91
  s_nop 1
  v_cvt_pk_bf16_f32 v230, v100, v101
  v_cvt_pk_bf16_f32 v231, v102, v103
  s_add_u32 s67, s68, 3072
  buffer_store_dwordx4 v[228:231], v48, s[32:35], s67 offen sc0 sc1
  v_cvt_pk_bf16_f32 v232, v92, v93
  v_cvt_pk_bf16_f32 v233, v94, v95
  v_cvt_pk_bf16_f32 v234, v104, v105
  v_cvt_pk_bf16_f32 v235, v106, v107
  s_add_u32 s67, s68, 4096
  buffer_store_dwordx4 v[232:235], v48, s[32:35], s67 offen sc0 sc1
  v_cvt_pk_bf16_f32 v236, v96, v97
  v_cvt_pk_bf16_f32 v237, v98, v99
  v_cvt_pk_bf16_f32 v238, v108, v109
  v_cvt_pk_bf16_f32 v239, v110, v111
  s_add_u32 s67, s68, 5120
  buffer_store_dwordx4 v[236:239], v48, s[32:35], s67 offen sc0 sc1
  s_waitcnt vmcnt(0)
  s_mul_i32 s66, s76, 8448
  s_add_u32 s66, s66, 16777216
  s_lshl_b32 s67, s5, 2
  s_add_u32 s67, s67, s4
  s_lshl_b32 s67, s67, 2
  v_mov_b32 v2, s67
  v_mov_b32 v1, 1
  s_mov_b64 s[70:71], exec
  s_mov_b64 exec, 1
  buffer_store_dword v1, v2, s[32:35], s66 offen sc0 sc1
  s_mov_b64 exec, s[70:71]
L_tail:
  s_min_u32 s66, s5, 2
  s_mul_i32 s67, s5, 5
  s_add_u32 s66, s66, s67
  s_cmp_lt_u32 s5, 2
  s_cselect_b32 s67, 6, 5
  s_mov_b32 s80, s67
  s_add_u32 s66, s66, s3
  v_mbcnt_lo_u32_b32 v3, -1, 0
  v_mbcnt_hi_u32_b32 v3, -1, v3
  v_lshlrev_b32 v6, 4, v3
  v_lshlrev_b32 v0, 2, v3
  s_mul_i32 s68, s66, 171
  s_lshr_b32 s68, s68, 9
  s_mul_i32 s69, s68, 3
  s_sub_u32 s69, s66, s69
  s_lshl_b32 s69, s69, 4
  s_mul_i32 s67, s6, 48
  s_add_u32 s69, s69, s67
  s_mul_i32 s69, s69, 1792
  s_lshl_b32 s68, s68, 6
  s_add_u32 s69, s69, s68
  s_mul_i32 s67, s7, 896
  s_add_u32 s78, s69, s67
  v_and_b32 v7, 15, v3
  s_mov_b32 s67, 1792
  v_mul_lo_u32 v7, s67, v7
  v_bfe_u32 v8, v3, 4, 1
  v_lshl_add_u32 v7, v8, 5, v7
  v_lshrrev_b32 v8, 5, v3
  v_lshl_add_u32 v7, v8, 4, v7
  s_lshl_b32 s67, s6, 4
  s_lshl_b32 s68, s7, 2
  s_add_u32 s67, s67, s68
  s_mul_i32 s67, s67, 43008
  s_lshl_b32 s68, s66, 10
  s_add_u32 s69, s67, s68
  s_barrier
  s_cmp_lg_u32 s3, 0
  s_cbranch_scc1 L_nopoll
  s_mul_i32 s66, s76, 8448
  s_add_u32 s66, s66, 16777216
  s_mov_b64 s[70:71], exec
  s_mov_b32 exec_hi, 0
  s_mov_b32 s68, 0
L_poll:
  buffer_load_dword v4, v0, s[32:35], s66 offen sc0 sc1
  s_waitcnt vmcnt(0)
  v_cmp_eq_u32 vcc, 1, v4
  s_nop 1
  s_cmp_eq_u32 vcc_lo, -1
  s_cbranch_scc1 L_poll_done
  s_add_u32 s68, s68, 1
  s_cmp_ge_u32 s68, 400000
  s_cbranch_scc1 L_poll_done
  s_branch L_poll
L_poll_done:
  s_mov_b64 exec, s[70:71]
L_nopoll:
  s_barrier
  s_cmp_ge_u32 s3, s80
  s_cbranch_scc1 L_end
  s_add_u32 s68, s69, 0
  buffer_load_dwordx4 v[64:67], v6, s[32:35], s68 offen sc0 sc1
  s_add_u32 s68, s69, 43008
  buffer_load_dwordx4 v[68:71], v6, s[32:35], s68 offen sc0 sc1
  s_add_u32 s68, s69, 86016
  buffer_load_dwordx4 v[72:75], v6, s[32:35], s68 offen sc0 sc1
  s_add_u32 s68, s69, 129024
  buffer_load_dwordx4 v[76:79], v6, s[32:35], s68 offen sc0 sc1
  s_add_u32 s68, s69, 344064
  buffer_load_dwordx4 v[80:83], v6, s[32:35], s68 offen sc0 sc1
  s_add_u32 s68, s69, 387072
  buffer_load_dwordx4 v[84:87], v6, s[32:35], s68 offen sc0 sc1
  s_add_u32 s68, s69, 430080
  buffer_load_dwordx4 v[88:91], v6, s[32:35], s68 offen sc0 sc1
  s_add_u32 s68, s69, 473088
  buffer_load_dwordx4 v[92:95], v6, s[32:35], s68 offen sc0 sc1
  s_waitcnt vmcnt(7)
  v_lshlrev_b32 v16, 16, v64
  v_and_b32 v17, 0xffff0000, v64
  v_lshlrev_b32 v18, 16, v65
  v_and_b32 v19, 0xffff0000, v65
  v_lshlrev_b32 v20, 16, v66
  v_and_b32 v21, 0xffff0000, v66
  v_lshlrev_b32 v22, 16, v67
  v_and_b32 v23, 0xffff0000, v67
  s_waitcnt vmcnt(6)
  v_lshlrev_b32 v10, 16, v68
  v_and_b32 v11, 0xffff0000, v68
  v_pk_add_f32 v[16:17], v[16:17], v[10:11]
  v_lshlrev_b32 v12, 16, v69
  v_and_b32 v13, 0xffff0000, v69
  v_pk_add_f32 v[18:19], v[18:19], v[12:13]
  v_lshlrev_b32 v10, 16, v70
  v_and_b32 v11, 0xffff0000, v70
  v_pk_add_f32 v[20:21], v[20:21], v[10:11]
  v_lshlrev_b32 v12, 16, v71
  v_and_b32 v13, 0xffff0000, v71
  v_pk_add_f32 v[22:23], v[22:23], v[12:13]
  s_waitcnt vmcnt(5)
  v_lshlrev_b32 v10, 16, v72
  v_and_b32 v11, 0xffff0000, v72
  v_pk_add_f32 v[16:17], v[16:17], v[10:11]
  v_lshlrev_b32 v12, 16, v73
  v_and_b32 v13, 0xffff0000, v73
  v_pk_add_f32 v[18:19], v[18:19], v[12:13]
  v_lshlrev_b32 v10, 16, v74
  v_and_b32 v11, 0xffff0000, v74
  v_pk_add_f32 v[20:21], v[20:21], v[10:11]
  v_lshlrev_b32 v12, 16, v75
  v_and_b32 v13, 0xffff0000, v75
  v_pk_add_f32 v[22:23], v[22:23], v[12:13]
  s_waitcnt vmcnt(4)
  v_lshlrev_b32 v10, 16, v76
  v_and_b32 v11, 0xffff0000, v76
  v_pk_add_f32 v[16:17], v[16:17], v[10:11]
  v_lshlrev_b32 v12, 16, v77
  v_and_b32 v13, 0xffff0000, v77
  v_pk_add_f32 v[18:19], v[18:19], v[12:13]
  v_lshlrev_b32 v10, 16, v78
  v_and_b32 v11, 0xffff0000, v78
  v_pk_add_f32 v[20:21], v[20:21], v[10:11]
  v_lshlrev_b32 v12, 16, v79
  v_and_b32 v13, 0xffff0000, v79
  v_pk_add_f32 v[22:23], v[22:23], v[12:13]
  s_waitcnt vmcnt(3)
  v_lshlrev_b32 v10, 16, v80
  v_and_b32 v11, 0xffff0000, v80
  v_pk_add_f32 v[16:17], v[16:17], v[10:11]
  v_lshlrev_b32 v12, 16, v81
  v_and_b32 v13, 0xffff0000, v81
  v_pk_add_f32 v[18:19], v[18:19], v[12:13]
  v_lshlrev_b32 v10, 16, v82
  v_and_b32 v11, 0xffff0000, v82
  v_pk_add_f32 v[20:21], v[20:21], v[10:11]
  v_lshlrev_b32 v12, 16, v83
  v_and_b32 v13, 0xffff0000, v83
  v_pk_add_f32 v[22:23], v[22:23], v[12:13]
  s_waitcnt vmcnt(2)
  v_lshlrev_b32 v10, 16, v84
  v_and_b32 v11, 0xffff0000, v84
  v_pk_add_f32 v[16:17], v[16:17], v[10:11]
  v_lshlrev_b32 v12, 16, v85
  v_and_b32 v13, 0xffff0000, v85
  v_pk_add_f32 v[18:19], v[18:19], v[12:13]
  v_lshlrev_b32 v10, 16, v86
  v_and_b32 v11, 0xffff0000, v86
  v_pk_add_f32 v[20:21], v[20:21], v[10:11]
  v_lshlrev_b32 v12, 16, v87
  v_and_b32 v13, 0xffff0000, v87
  v_pk_add_f32 v[22:23], v[22:23], v[12:13]
  s_waitcnt vmcnt(1)
  v_lshlrev_b32 v10, 16, v88
  v_and_b32 v11, 0xffff0000, v88
  v_pk_add_f32 v[16:17], v[16:17], v[10:11]
  v_lshlrev_b32 v12, 16, v89
  v_and_b32 v13, 0xffff0000, v89
  v_pk_add_f32 v[18:19], v[18:19], v[12:13]
  v_lshlrev_b32 v10, 16, v90
  v_and_b32 v11, 0xffff0000, v90
  v_pk_add_f32 v[20:21], v[20:21], v[10:11]
  v_lshlrev_b32 v12, 16, v91
  v_and_b32 v13, 0xffff0000, v91
  v_pk_add_f32 v[22:23], v[22:23], v[12:13]
  s_waitcnt vmcnt(0)
  v_lshlrev_b32 v10, 16, v92
  v_and_b32 v11, 0xffff0000, v92
  v_pk_add_f32 v[16:17], v[16:17], v[10:11]
  v_lshlrev_b32 v12, 16, v93
  v_and_b32 v13, 0xffff0000, v93
  v_pk_add_f32 v[18:19], v[18:19], v[12:13]
  v_lshlrev_b32 v10, 16, v94
  v_and_b32 v11, 0xffff0000, v94
  v_pk_add_f32 v[20:21], v[20:21], v[10:11]
  v_lshlrev_b32 v12, 16, v95
  v_and_b32 v13, 0xffff0000, v95
  v_pk_add_f32 v[22:23], v[22:23], v[12:13]
  v_cvt_pk_bf16_f32 v12, v16, v17
  v_cvt_pk_bf16_f32 v13, v18, v19
  v_cvt_pk_bf16_f32 v14, v20, v21
  v_cvt_pk_bf16_f32 v15, v22, v23
  s_nop 0
  v_permlane16_swap_b32 v12, v14
  v_permlane16_swap_b32 v13, v15
  buffer_store_dwordx4 v[12:15], v7, s[28:31], s78 offen
L_end:
  s_endpgm
L_code_end:
.section .rodata,"a"
.p2align 6
.amdhsa_kernel concat_heads__gqa_block_cached__gqa_block_cached__near_ridge_kernel
  .amdhsa_next_free_vgpr 256
  .amdhsa_next_free_sgpr 102
  .amdhsa_accum_offset 256
  .amdhsa_group_segment_fixed_size 0
  .amdhsa_kernarg_size 104
  .amdhsa_user_sgpr_count 2
  .amdhsa_user_sgpr_kernarg_segment_ptr 1
  .amdhsa_system_sgpr_workgroup_id_x 1
.end_amdhsa_kernel
```
